```python
import torch

def _softmax(x, axis=-1):
    return torch.softmax(x, dim=axis)

def _gelu(x):
    return torch.nn.functional.gelu(x, approximate='tanh')

def _silu(x):
    return torch.nn.functional.silu(x)

def _sigmoid(x):
    return torch.sigmoid(x)

def _layernorm(x, axis=-1, eps=1e-05):
    m = x.mean(dim=axis, keepdim=True)
    v = x.var(dim=axis, keepdim=True, unbiased=False)
    return (x - m) / torch.sqrt(v + eps)

def _scatter_add(tgt, idx, src, axis=0):
    return tgt.clone().index_add_(axis, idx, src)

def _segment_sum(src, seg, n):
    out = torch.zeros((n,) + src.shape[1:], dtype=src.dtype)
    return out.index_add_(0, seg, src)

def _pad(x, pw):
    flat = tuple((v for pair in reversed(pw) for v in pair))
    return torch.nn.functional.pad(x, flat)
kernel_name = 'adaLN_cond__mha_block_cached__mixer_gmlp__prompt'

def setup_inputs():

    _w = lambda a: (lambda t: t.to(torch.bfloat16) if t.is_floating_point() else t)(torch.as_tensor(a))

    def _A_setup():
        B, Sq, D = (1, 2048, 512)
        H, Sk, Dh = (32, 2048, 128)
        return {'x': _w((lambda *s: torch.randn(*s, dtype=torch.bfloat16) * 0.05)(B, Sq, D)), 'k_cache': _w((lambda *s: torch.randn(*s, dtype=torch.bfloat16) * 3.2)(B, H, Sk, Dh)), 'v_cache': _w((lambda *s: torch.randn(*s, dtype=torch.bfloat16) * 0.4)(B, H, Sk, Dh)), 'wq': _w((lambda *s: torch.randn(*s, dtype=torch.bfloat16) * 3.2)(D, H * Dh) * D ** (-0.5)), 'wo': _w((lambda *s: torch.randn(*s, dtype=torch.bfloat16) * 0.4)(H * Dh, D) * (H * Dh) ** (-0.5))}
    _A_in = _A_setup()

    def _B_setup():
        B, S, D, F = (1, 2048, 512, 1792)
        Fh = F // 2
        return {'x': _w((lambda *s: torch.randn(*s, dtype=torch.bfloat16) * 0.05)(B, S, D)), 'w_in': _w((lambda *s: torch.randn(*s, dtype=torch.bfloat16) * 0.8)(D, 2 * Fh)), 'w_sp': _w(0.01 * (lambda *s: torch.randn(*s, dtype=torch.bfloat16) * 0.8)(S, S)), 'b_sp': _w(1.0 + 0.01 * (lambda *s: torch.randn(*s, dtype=torch.bfloat16) * 0.05)(S)), 'w_out': _w((lambda *s: torch.randn(*s, dtype=torch.bfloat16) * 0.05)(Fh, D))}
    _B_in = _B_setup()
    return {'A_x': _A_in['x'], 'A_k_cache': _A_in['k_cache'], 'A_v_cache': _A_in['v_cache'], 'A_wq': _A_in['wq'], 'A_wo': _A_in['wo'], 'B_x': _B_in['x'], 'B_w_in': _B_in['w_in'], 'B_w_sp': _B_in['w_sp'], 'B_b_sp': _B_in['b_sp'], 'B_w_out': _B_in['w_out'], 'c': _w((lambda *s: torch.randn(*s, dtype=torch.bfloat16) * 0.1)(1, 512) * 8.0), 'w_mod': _w((lambda *s: torch.randn(*s, dtype=torch.bfloat16) * 0.1)(512, 6 * 512) * 512 ** (-0.5) * 8.0)}

def reference(A_x, A_k_cache, A_v_cache, A_wq, A_wo, B_x, B_w_in, B_w_sp, B_b_sp, B_w_out, c, w_mod):

    def _A_ref(x, k_cache, v_cache, wq, wo):
        B, Sq, D = x.shape
        H, Dh = (32, 128)
        q = (lambda x, *d: x.permute(*d))((x @ wq).reshape(B, Sq, H, Dh), 0, 2, 1, 3)
        scores = torch.einsum('bhqd,bhkd->bhqk', q, k_cache) * Dh ** (-0.5)
        p = _softmax(scores, axis=-1)
        o = torch.einsum('bhqk,bhkd->bhqd', p, v_cache)
        return (lambda x, *d: x.permute(*d))(o, 0, 2, 1, 3).reshape(B, Sq, H * Dh) @ wo

    def _B_ref(x, w_in, w_sp, b_sp, w_out):
        B, S, D = x.shape
        F = w_in.shape[-1]
        Fh = F // 2
        z = _gelu(torch.einsum('bsd,df->bsf', x, w_in))
        z1 = z[..., :Fh].clone()
        z2 = _layernorm(z[..., Fh:], axis=-1)
        g = torch.einsum('ts,bsf->btf', w_sp, z2) + b_sp[None, :, None]
        return torch.einsum('bsf,fd->bsd', z1 * g, w_out)
    x = A_x
    mod = (_silu(c) @ w_mod).reshape(c.shape[0], 6, 1, -1)
    sa, ca, ga, sb, cb, gb = (mod[:, 0].clone(), mod[:, 1].clone(), mod[:, 2].clone(), mod[:, 3].clone(), mod[:, 4].clone(), mod[:, 5].clone())
    h = _layernorm(x, axis=-1) * (1 + ca) + sa
    x = x + ga * _A_ref(h, A_k_cache, A_v_cache, A_wq, A_wo)
    h = _layernorm(x, axis=-1) * (1 + cb) + sb
    x = x + gb * _B_ref(h, B_w_in, B_w_sp, B_b_sp, B_w_out)
    return x
```

```asm
; @launch kernel=mod_kernel grid=(24,1,1) block=(256,1,1) lds=4096
; @launch kernel=ln1_kernel grid=(512,1,1) block=(256,1,1) lds=0
; @launch kernel=gemmq_kernel grid=(256,1,1) block=(512,1,1) lds=147456
; @launch kernel=attn_kernel grid=(256,1,1) block=(512,1,1) lds=131072
; @launch kernel=gemmo_kernel grid=(256,1,1) block=(256,1,1) lds=131072
; @launch kernel=ln2_kernel grid=(512,1,1) block=(256,1,1) lds=0
; @launch kernel=gemmin_kernel grid=(224,1,1) block=(256,1,1) lds=131072
; @launch kernel=ln3_kernel grid=(512,1,1) block=(256,1,1) lds=0
; @launch kernel=gemmsp_kernel grid=(224,1,1) block=(256,1,1) lds=147456
; @launch kernel=gemmout_kernel grid=(256,1,1) block=(256,1,1) lds=131072
.amdgcn_target "amdgcn-amd-amdhsa--gfx950"
.text
.globl mod_kernel
.p2align 8
.type mod_kernel,@function
mod_kernel:
    s_cmp_ge_u32 s2, 24
    s_cbranch_scc1 .Lend_mod_kernel
    s_load_dwordx2 s[4:5], s[0:1], 80
    s_load_dwordx2 s[8:9], s[0:1], 88
    s_load_dwordx2 s[12:13], s[0:1], 112
    v_and_b32 v1, 63, v0
    v_lshrrev_b32 v2, 6, v0
    s_nop 0
    v_readfirstlane_b32 s3, v2
    s_waitcnt lgkmcnt(0)
    s_and_b32 s5, s5, 0xffff
    s_mov_b32 s6, 0x400
    s_mov_b32 s7, 0x00020000
    s_and_b32 s9, s9, 0xffff
    s_mov_b32 s10, 0x300000
    s_mov_b32 s11, 0x00020000
    s_and_b32 s13, s13, 0xffff
    s_mov_b32 s14, 0x3000
    s_mov_b32 s15, 0x00020000
    s_lshl_b32 s16, s3, 8
    v_lshlrev_b32 v3, 1, v1
    buffer_load_ushort v4, v3, s[4:7], s16 offen
    buffer_load_ushort v5, v3, s[4:7], s16 offen offset:128
    s_lshl_b32 s17, s2, 8
    v_lshlrev_b32 v6, 2, v1
    v_add_u32 v6, s17, v6
    s_mul_i32 s18, s3, 786432
    buffer_load_dword v32, v6, s[8:11], s18 offen
    s_add_u32 s18, s18, 6144
    buffer_load_dword v33, v6, s[8:11], s18 offen
    s_add_u32 s18, s18, 6144
    buffer_load_dword v34, v6, s[8:11], s18 offen
    s_add_u32 s18, s18, 6144
    buffer_load_dword v35, v6, s[8:11], s18 offen
    s_add_u32 s18, s18, 6144
    buffer_load_dword v36, v6, s[8:11], s18 offen
    s_add_u32 s18, s18, 6144
    buffer_load_dword v37, v6, s[8:11], s18 offen
    s_add_u32 s18, s18, 6144
    buffer_load_dword v38, v6, s[8:11], s18 offen
    s_add_u32 s18, s18, 6144
    buffer_load_dword v39, v6, s[8:11], s18 offen
    s_add_u32 s18, s18, 6144
    buffer_load_dword v40, v6, s[8:11], s18 offen
    s_add_u32 s18, s18, 6144
    buffer_load_dword v41, v6, s[8:11], s18 offen
    s_add_u32 s18, s18, 6144
    buffer_load_dword v42, v6, s[8:11], s18 offen
    s_add_u32 s18, s18, 6144
    buffer_load_dword v43, v6, s[8:11], s18 offen
    s_add_u32 s18, s18, 6144
    buffer_load_dword v44, v6, s[8:11], s18 offen
    s_add_u32 s18, s18, 6144
    buffer_load_dword v45, v6, s[8:11], s18 offen
    s_add_u32 s18, s18, 6144
    buffer_load_dword v46, v6, s[8:11], s18 offen
    s_add_u32 s18, s18, 6144
    buffer_load_dword v47, v6, s[8:11], s18 offen
    s_add_u32 s18, s18, 6144
    buffer_load_dword v48, v6, s[8:11], s18 offen
    s_add_u32 s18, s18, 6144
    buffer_load_dword v49, v6, s[8:11], s18 offen
    s_add_u32 s18, s18, 6144
    buffer_load_dword v50, v6, s[8:11], s18 offen
    s_add_u32 s18, s18, 6144
    buffer_load_dword v51, v6, s[8:11], s18 offen
    s_add_u32 s18, s18, 6144
    buffer_load_dword v52, v6, s[8:11], s18 offen
    s_add_u32 s18, s18, 6144
    buffer_load_dword v53, v6, s[8:11], s18 offen
    s_add_u32 s18, s18, 6144
    buffer_load_dword v54, v6, s[8:11], s18 offen
    s_add_u32 s18, s18, 6144
    buffer_load_dword v55, v6, s[8:11], s18 offen
    s_add_u32 s18, s18, 6144
    buffer_load_dword v56, v6, s[8:11], s18 offen
    s_add_u32 s18, s18, 6144
    buffer_load_dword v57, v6, s[8:11], s18 offen
    s_add_u32 s18, s18, 6144
    buffer_load_dword v58, v6, s[8:11], s18 offen
    s_add_u32 s18, s18, 6144
    buffer_load_dword v59, v6, s[8:11], s18 offen
    s_add_u32 s18, s18, 6144
    buffer_load_dword v60, v6, s[8:11], s18 offen
    s_add_u32 s18, s18, 6144
    buffer_load_dword v61, v6, s[8:11], s18 offen
    s_add_u32 s18, s18, 6144
    buffer_load_dword v62, v6, s[8:11], s18 offen
    s_add_u32 s18, s18, 6144
    buffer_load_dword v63, v6, s[8:11], s18 offen
    s_add_u32 s18, s18, 6144
    buffer_load_dword v64, v6, s[8:11], s18 offen
    s_add_u32 s18, s18, 6144
    buffer_load_dword v65, v6, s[8:11], s18 offen
    s_add_u32 s18, s18, 6144
    buffer_load_dword v66, v6, s[8:11], s18 offen
    s_add_u32 s18, s18, 6144
    buffer_load_dword v67, v6, s[8:11], s18 offen
    s_add_u32 s18, s18, 6144
    buffer_load_dword v68, v6, s[8:11], s18 offen
    s_add_u32 s18, s18, 6144
    buffer_load_dword v69, v6, s[8:11], s18 offen
    s_add_u32 s18, s18, 6144
    buffer_load_dword v70, v6, s[8:11], s18 offen
    s_add_u32 s18, s18, 6144
    buffer_load_dword v71, v6, s[8:11], s18 offen
    s_add_u32 s18, s18, 6144
    buffer_load_dword v72, v6, s[8:11], s18 offen
    s_add_u32 s18, s18, 6144
    buffer_load_dword v73, v6, s[8:11], s18 offen
    s_add_u32 s18, s18, 6144
    buffer_load_dword v74, v6, s[8:11], s18 offen
    s_add_u32 s18, s18, 6144
    buffer_load_dword v75, v6, s[8:11], s18 offen
    s_add_u32 s18, s18, 6144
    buffer_load_dword v76, v6, s[8:11], s18 offen
    s_add_u32 s18, s18, 6144
    buffer_load_dword v77, v6, s[8:11], s18 offen
    s_add_u32 s18, s18, 6144
    buffer_load_dword v78, v6, s[8:11], s18 offen
    s_add_u32 s18, s18, 6144
    buffer_load_dword v79, v6, s[8:11], s18 offen
    s_add_u32 s18, s18, 6144
    buffer_load_dword v80, v6, s[8:11], s18 offen
    s_add_u32 s18, s18, 6144
    buffer_load_dword v81, v6, s[8:11], s18 offen
    s_add_u32 s18, s18, 6144
    buffer_load_dword v82, v6, s[8:11], s18 offen
    s_add_u32 s18, s18, 6144
    buffer_load_dword v83, v6, s[8:11], s18 offen
    s_add_u32 s18, s18, 6144
    buffer_load_dword v84, v6, s[8:11], s18 offen
    s_add_u32 s18, s18, 6144
    buffer_load_dword v85, v6, s[8:11], s18 offen
    s_add_u32 s18, s18, 6144
    buffer_load_dword v86, v6, s[8:11], s18 offen
    s_add_u32 s18, s18, 6144
    buffer_load_dword v87, v6, s[8:11], s18 offen
    s_add_u32 s18, s18, 6144
    buffer_load_dword v88, v6, s[8:11], s18 offen
    s_add_u32 s18, s18, 6144
    buffer_load_dword v89, v6, s[8:11], s18 offen
    s_add_u32 s18, s18, 6144
    buffer_load_dword v90, v6, s[8:11], s18 offen
    s_add_u32 s18, s18, 6144
    buffer_load_dword v91, v6, s[8:11], s18 offen
    s_add_u32 s18, s18, 6144
    buffer_load_dword v92, v6, s[8:11], s18 offen
    s_add_u32 s18, s18, 6144
    buffer_load_dword v93, v6, s[8:11], s18 offen
    s_add_u32 s18, s18, 6144
    buffer_load_dword v94, v6, s[8:11], s18 offen
    s_add_u32 s18, s18, 6144
    buffer_load_dword v95, v6, s[8:11], s18 offen
    s_add_u32 s18, s18, 6144
    buffer_load_dword v96, v6, s[8:11], s18 offen
    s_add_u32 s18, s18, 6144
    buffer_load_dword v97, v6, s[8:11], s18 offen
    s_add_u32 s18, s18, 6144
    buffer_load_dword v98, v6, s[8:11], s18 offen
    s_add_u32 s18, s18, 6144
    buffer_load_dword v99, v6, s[8:11], s18 offen
    s_add_u32 s18, s18, 6144
    buffer_load_dword v100, v6, s[8:11], s18 offen
    s_add_u32 s18, s18, 6144
    buffer_load_dword v101, v6, s[8:11], s18 offen
    s_add_u32 s18, s18, 6144
    buffer_load_dword v102, v6, s[8:11], s18 offen
    s_add_u32 s18, s18, 6144
    buffer_load_dword v103, v6, s[8:11], s18 offen
    s_add_u32 s18, s18, 6144
    buffer_load_dword v104, v6, s[8:11], s18 offen
    s_add_u32 s18, s18, 6144
    buffer_load_dword v105, v6, s[8:11], s18 offen
    s_add_u32 s18, s18, 6144
    buffer_load_dword v106, v6, s[8:11], s18 offen
    s_add_u32 s18, s18, 6144
    buffer_load_dword v107, v6, s[8:11], s18 offen
    s_add_u32 s18, s18, 6144
    buffer_load_dword v108, v6, s[8:11], s18 offen
    s_add_u32 s18, s18, 6144
    buffer_load_dword v109, v6, s[8:11], s18 offen
    s_add_u32 s18, s18, 6144
    buffer_load_dword v110, v6, s[8:11], s18 offen
    s_add_u32 s18, s18, 6144
    buffer_load_dword v111, v6, s[8:11], s18 offen
    s_add_u32 s18, s18, 6144
    buffer_load_dword v112, v6, s[8:11], s18 offen
    s_add_u32 s18, s18, 6144
    buffer_load_dword v113, v6, s[8:11], s18 offen
    s_add_u32 s18, s18, 6144
    buffer_load_dword v114, v6, s[8:11], s18 offen
    s_add_u32 s18, s18, 6144
    buffer_load_dword v115, v6, s[8:11], s18 offen
    s_add_u32 s18, s18, 6144
    buffer_load_dword v116, v6, s[8:11], s18 offen
    s_add_u32 s18, s18, 6144
    buffer_load_dword v117, v6, s[8:11], s18 offen
    s_add_u32 s18, s18, 6144
    buffer_load_dword v118, v6, s[8:11], s18 offen
    s_add_u32 s18, s18, 6144
    buffer_load_dword v119, v6, s[8:11], s18 offen
    s_add_u32 s18, s18, 6144
    buffer_load_dword v120, v6, s[8:11], s18 offen
    s_add_u32 s18, s18, 6144
    buffer_load_dword v121, v6, s[8:11], s18 offen
    s_add_u32 s18, s18, 6144
    buffer_load_dword v122, v6, s[8:11], s18 offen
    s_add_u32 s18, s18, 6144
    buffer_load_dword v123, v6, s[8:11], s18 offen
    s_add_u32 s18, s18, 6144
    buffer_load_dword v124, v6, s[8:11], s18 offen
    s_add_u32 s18, s18, 6144
    buffer_load_dword v125, v6, s[8:11], s18 offen
    s_add_u32 s18, s18, 6144
    buffer_load_dword v126, v6, s[8:11], s18 offen
    s_add_u32 s18, s18, 6144
    buffer_load_dword v127, v6, s[8:11], s18 offen
    s_add_u32 s18, s18, 6144
    buffer_load_dword v128, v6, s[8:11], s18 offen
    s_add_u32 s18, s18, 6144
    buffer_load_dword v129, v6, s[8:11], s18 offen
    s_add_u32 s18, s18, 6144
    buffer_load_dword v130, v6, s[8:11], s18 offen
    s_add_u32 s18, s18, 6144
    buffer_load_dword v131, v6, s[8:11], s18 offen
    s_add_u32 s18, s18, 6144
    buffer_load_dword v132, v6, s[8:11], s18 offen
    s_add_u32 s18, s18, 6144
    buffer_load_dword v133, v6, s[8:11], s18 offen
    s_add_u32 s18, s18, 6144
    buffer_load_dword v134, v6, s[8:11], s18 offen
    s_add_u32 s18, s18, 6144
    buffer_load_dword v135, v6, s[8:11], s18 offen
    s_add_u32 s18, s18, 6144
    buffer_load_dword v136, v6, s[8:11], s18 offen
    s_add_u32 s18, s18, 6144
    buffer_load_dword v137, v6, s[8:11], s18 offen
    s_add_u32 s18, s18, 6144
    buffer_load_dword v138, v6, s[8:11], s18 offen
    s_add_u32 s18, s18, 6144
    buffer_load_dword v139, v6, s[8:11], s18 offen
    s_add_u32 s18, s18, 6144
    buffer_load_dword v140, v6, s[8:11], s18 offen
    s_add_u32 s18, s18, 6144
    buffer_load_dword v141, v6, s[8:11], s18 offen
    s_add_u32 s18, s18, 6144
    buffer_load_dword v142, v6, s[8:11], s18 offen
    s_add_u32 s18, s18, 6144
    buffer_load_dword v143, v6, s[8:11], s18 offen
    s_add_u32 s18, s18, 6144
    buffer_load_dword v144, v6, s[8:11], s18 offen
    s_add_u32 s18, s18, 6144
    buffer_load_dword v145, v6, s[8:11], s18 offen
    s_add_u32 s18, s18, 6144
    buffer_load_dword v146, v6, s[8:11], s18 offen
    s_add_u32 s18, s18, 6144
    buffer_load_dword v147, v6, s[8:11], s18 offen
    s_add_u32 s18, s18, 6144
    buffer_load_dword v148, v6, s[8:11], s18 offen
    s_add_u32 s18, s18, 6144
    buffer_load_dword v149, v6, s[8:11], s18 offen
    s_add_u32 s18, s18, 6144
    buffer_load_dword v150, v6, s[8:11], s18 offen
    s_add_u32 s18, s18, 6144
    buffer_load_dword v151, v6, s[8:11], s18 offen
    s_add_u32 s18, s18, 6144
    buffer_load_dword v152, v6, s[8:11], s18 offen
    s_add_u32 s18, s18, 6144
    buffer_load_dword v153, v6, s[8:11], s18 offen
    s_add_u32 s18, s18, 6144
    buffer_load_dword v154, v6, s[8:11], s18 offen
    s_add_u32 s18, s18, 6144
    buffer_load_dword v155, v6, s[8:11], s18 offen
    s_add_u32 s18, s18, 6144
    buffer_load_dword v156, v6, s[8:11], s18 offen
    s_add_u32 s18, s18, 6144
    buffer_load_dword v157, v6, s[8:11], s18 offen
    s_add_u32 s18, s18, 6144
    buffer_load_dword v158, v6, s[8:11], s18 offen
    s_add_u32 s18, s18, 6144
    buffer_load_dword v159, v6, s[8:11], s18 offen
    s_add_u32 s18, s18, 6144
    s_waitcnt vmcnt(0)
    v_lshlrev_b32 v4, 16, v4
    v_mul_f32 v7, 0xbfb8aa3b, v4
    v_exp_f32 v7, v7
    s_nop 0
    v_add_f32 v7, 1.0, v7
    v_rcp_f32 v7, v7
    s_nop 0
    v_mul_f32 v4, v4, v7
    v_cvt_pk_bf16_f32 v4, v4, v4
    v_lshlrev_b32 v4, 16, v4
    v_lshlrev_b32 v5, 16, v5
    v_mul_f32 v7, 0xbfb8aa3b, v5
    v_exp_f32 v7, v7
    s_nop 0
    v_add_f32 v7, 1.0, v7
    v_rcp_f32 v7, v7
    s_nop 0
    v_mul_f32 v5, v5, v7
    v_cvt_pk_bf16_f32 v5, v5, v5
    v_lshlrev_b32 v5, 16, v5
    v_mov_b32 v8, 0
    v_mov_b32 v9, 0
    v_readlane_b32 s20, v4, 0
    v_readlane_b32 s21, v4, 1
    v_readlane_b32 s22, v4, 2
    v_readlane_b32 s23, v4, 3
    v_readlane_b32 s24, v4, 4
    v_readlane_b32 s25, v4, 5
    v_readlane_b32 s26, v4, 6
    v_readlane_b32 s27, v4, 7
    v_readlane_b32 s28, v4, 8
    v_readlane_b32 s29, v4, 9
    v_readlane_b32 s30, v4, 10
    v_readlane_b32 s31, v4, 11
    v_readlane_b32 s32, v4, 12
    v_readlane_b32 s33, v4, 13
    v_readlane_b32 s34, v4, 14
    v_readlane_b32 s35, v4, 15
    v_lshlrev_b32 v10, 16, v32
    v_and_b32 v11, 0xffff0000, v32
    v_fmac_f32 v8, s20, v10
    v_fmac_f32 v9, s20, v11
    v_lshlrev_b32 v10, 16, v33
    v_and_b32 v11, 0xffff0000, v33
    v_fmac_f32 v8, s21, v10
    v_fmac_f32 v9, s21, v11
    v_lshlrev_b32 v10, 16, v34
    v_and_b32 v11, 0xffff0000, v34
    v_fmac_f32 v8, s22, v10
    v_fmac_f32 v9, s22, v11
    v_lshlrev_b32 v10, 16, v35
    v_and_b32 v11, 0xffff0000, v35
    v_fmac_f32 v8, s23, v10
    v_fmac_f32 v9, s23, v11
    v_lshlrev_b32 v10, 16, v36
    v_and_b32 v11, 0xffff0000, v36
    v_fmac_f32 v8, s24, v10
    v_fmac_f32 v9, s24, v11
    v_lshlrev_b32 v10, 16, v37
    v_and_b32 v11, 0xffff0000, v37
    v_fmac_f32 v8, s25, v10
    v_fmac_f32 v9, s25, v11
    v_lshlrev_b32 v10, 16, v38
    v_and_b32 v11, 0xffff0000, v38
    v_fmac_f32 v8, s26, v10
    v_fmac_f32 v9, s26, v11
    v_lshlrev_b32 v10, 16, v39
    v_and_b32 v11, 0xffff0000, v39
    v_fmac_f32 v8, s27, v10
    v_fmac_f32 v9, s27, v11
    v_lshlrev_b32 v10, 16, v40
    v_and_b32 v11, 0xffff0000, v40
    v_fmac_f32 v8, s28, v10
    v_fmac_f32 v9, s28, v11
    v_lshlrev_b32 v10, 16, v41
    v_and_b32 v11, 0xffff0000, v41
    v_fmac_f32 v8, s29, v10
    v_fmac_f32 v9, s29, v11
    v_lshlrev_b32 v10, 16, v42
    v_and_b32 v11, 0xffff0000, v42
    v_fmac_f32 v8, s30, v10
    v_fmac_f32 v9, s30, v11
    v_lshlrev_b32 v10, 16, v43
    v_and_b32 v11, 0xffff0000, v43
    v_fmac_f32 v8, s31, v10
    v_fmac_f32 v9, s31, v11
    v_lshlrev_b32 v10, 16, v44
    v_and_b32 v11, 0xffff0000, v44
    v_fmac_f32 v8, s32, v10
    v_fmac_f32 v9, s32, v11
    v_lshlrev_b32 v10, 16, v45
    v_and_b32 v11, 0xffff0000, v45
    v_fmac_f32 v8, s33, v10
    v_fmac_f32 v9, s33, v11
    v_lshlrev_b32 v10, 16, v46
    v_and_b32 v11, 0xffff0000, v46
    v_fmac_f32 v8, s34, v10
    v_fmac_f32 v9, s34, v11
    v_lshlrev_b32 v10, 16, v47
    v_and_b32 v11, 0xffff0000, v47
    v_fmac_f32 v8, s35, v10
    v_fmac_f32 v9, s35, v11
    v_readlane_b32 s20, v4, 16
    v_readlane_b32 s21, v4, 17
    v_readlane_b32 s22, v4, 18
    v_readlane_b32 s23, v4, 19
    v_readlane_b32 s24, v4, 20
    v_readlane_b32 s25, v4, 21
    v_readlane_b32 s26, v4, 22
    v_readlane_b32 s27, v4, 23
    v_readlane_b32 s28, v4, 24
    v_readlane_b32 s29, v4, 25
    v_readlane_b32 s30, v4, 26
    v_readlane_b32 s31, v4, 27
    v_readlane_b32 s32, v4, 28
    v_readlane_b32 s33, v4, 29
    v_readlane_b32 s34, v4, 30
    v_readlane_b32 s35, v4, 31
    v_lshlrev_b32 v10, 16, v48
    v_and_b32 v11, 0xffff0000, v48
    v_fmac_f32 v8, s20, v10
    v_fmac_f32 v9, s20, v11
    v_lshlrev_b32 v10, 16, v49
    v_and_b32 v11, 0xffff0000, v49
    v_fmac_f32 v8, s21, v10
    v_fmac_f32 v9, s21, v11
    v_lshlrev_b32 v10, 16, v50
    v_and_b32 v11, 0xffff0000, v50
    v_fmac_f32 v8, s22, v10
    v_fmac_f32 v9, s22, v11
    v_lshlrev_b32 v10, 16, v51
    v_and_b32 v11, 0xffff0000, v51
    v_fmac_f32 v8, s23, v10
    v_fmac_f32 v9, s23, v11
    v_lshlrev_b32 v10, 16, v52
    v_and_b32 v11, 0xffff0000, v52
    v_fmac_f32 v8, s24, v10
    v_fmac_f32 v9, s24, v11
    v_lshlrev_b32 v10, 16, v53
    v_and_b32 v11, 0xffff0000, v53
    v_fmac_f32 v8, s25, v10
    v_fmac_f32 v9, s25, v11
    v_lshlrev_b32 v10, 16, v54
    v_and_b32 v11, 0xffff0000, v54
    v_fmac_f32 v8, s26, v10
    v_fmac_f32 v9, s26, v11
    v_lshlrev_b32 v10, 16, v55
    v_and_b32 v11, 0xffff0000, v55
    v_fmac_f32 v8, s27, v10
    v_fmac_f32 v9, s27, v11
    v_lshlrev_b32 v10, 16, v56
    v_and_b32 v11, 0xffff0000, v56
    v_fmac_f32 v8, s28, v10
    v_fmac_f32 v9, s28, v11
    v_lshlrev_b32 v10, 16, v57
    v_and_b32 v11, 0xffff0000, v57
    v_fmac_f32 v8, s29, v10
    v_fmac_f32 v9, s29, v11
    v_lshlrev_b32 v10, 16, v58
    v_and_b32 v11, 0xffff0000, v58
    v_fmac_f32 v8, s30, v10
    v_fmac_f32 v9, s30, v11
    v_lshlrev_b32 v10, 16, v59
    v_and_b32 v11, 0xffff0000, v59
    v_fmac_f32 v8, s31, v10
    v_fmac_f32 v9, s31, v11
    v_lshlrev_b32 v10, 16, v60
    v_and_b32 v11, 0xffff0000, v60
    v_fmac_f32 v8, s32, v10
    v_fmac_f32 v9, s32, v11
    v_lshlrev_b32 v10, 16, v61
    v_and_b32 v11, 0xffff0000, v61
    v_fmac_f32 v8, s33, v10
    v_fmac_f32 v9, s33, v11
    v_lshlrev_b32 v10, 16, v62
    v_and_b32 v11, 0xffff0000, v62
    v_fmac_f32 v8, s34, v10
    v_fmac_f32 v9, s34, v11
    v_lshlrev_b32 v10, 16, v63
    v_and_b32 v11, 0xffff0000, v63
    v_fmac_f32 v8, s35, v10
    v_fmac_f32 v9, s35, v11
    v_readlane_b32 s20, v4, 32
    v_readlane_b32 s21, v4, 33
    v_readlane_b32 s22, v4, 34
    v_readlane_b32 s23, v4, 35
    v_readlane_b32 s24, v4, 36
    v_readlane_b32 s25, v4, 37
    v_readlane_b32 s26, v4, 38
    v_readlane_b32 s27, v4, 39
    v_readlane_b32 s28, v4, 40
    v_readlane_b32 s29, v4, 41
    v_readlane_b32 s30, v4, 42
    v_readlane_b32 s31, v4, 43
    v_readlane_b32 s32, v4, 44
    v_readlane_b32 s33, v4, 45
    v_readlane_b32 s34, v4, 46
    v_readlane_b32 s35, v4, 47
    v_lshlrev_b32 v10, 16, v64
    v_and_b32 v11, 0xffff0000, v64
    v_fmac_f32 v8, s20, v10
    v_fmac_f32 v9, s20, v11
    v_lshlrev_b32 v10, 16, v65
    v_and_b32 v11, 0xffff0000, v65
    v_fmac_f32 v8, s21, v10
    v_fmac_f32 v9, s21, v11
    v_lshlrev_b32 v10, 16, v66
    v_and_b32 v11, 0xffff0000, v66
    v_fmac_f32 v8, s22, v10
    v_fmac_f32 v9, s22, v11
    v_lshlrev_b32 v10, 16, v67
    v_and_b32 v11, 0xffff0000, v67
    v_fmac_f32 v8, s23, v10
    v_fmac_f32 v9, s23, v11
    v_lshlrev_b32 v10, 16, v68
    v_and_b32 v11, 0xffff0000, v68
    v_fmac_f32 v8, s24, v10
    v_fmac_f32 v9, s24, v11
    v_lshlrev_b32 v10, 16, v69
    v_and_b32 v11, 0xffff0000, v69
    v_fmac_f32 v8, s25, v10
    v_fmac_f32 v9, s25, v11
    v_lshlrev_b32 v10, 16, v70
    v_and_b32 v11, 0xffff0000, v70
    v_fmac_f32 v8, s26, v10
    v_fmac_f32 v9, s26, v11
    v_lshlrev_b32 v10, 16, v71
    v_and_b32 v11, 0xffff0000, v71
    v_fmac_f32 v8, s27, v10
    v_fmac_f32 v9, s27, v11
    v_lshlrev_b32 v10, 16, v72
    v_and_b32 v11, 0xffff0000, v72
    v_fmac_f32 v8, s28, v10
    v_fmac_f32 v9, s28, v11
    v_lshlrev_b32 v10, 16, v73
    v_and_b32 v11, 0xffff0000, v73
    v_fmac_f32 v8, s29, v10
    v_fmac_f32 v9, s29, v11
    v_lshlrev_b32 v10, 16, v74
    v_and_b32 v11, 0xffff0000, v74
    v_fmac_f32 v8, s30, v10
    v_fmac_f32 v9, s30, v11
    v_lshlrev_b32 v10, 16, v75
    v_and_b32 v11, 0xffff0000, v75
    v_fmac_f32 v8, s31, v10
    v_fmac_f32 v9, s31, v11
    v_lshlrev_b32 v10, 16, v76
    v_and_b32 v11, 0xffff0000, v76
    v_fmac_f32 v8, s32, v10
    v_fmac_f32 v9, s32, v11
    v_lshlrev_b32 v10, 16, v77
    v_and_b32 v11, 0xffff0000, v77
    v_fmac_f32 v8, s33, v10
    v_fmac_f32 v9, s33, v11
    v_lshlrev_b32 v10, 16, v78
    v_and_b32 v11, 0xffff0000, v78
    v_fmac_f32 v8, s34, v10
    v_fmac_f32 v9, s34, v11
    v_lshlrev_b32 v10, 16, v79
    v_and_b32 v11, 0xffff0000, v79
    v_fmac_f32 v8, s35, v10
    v_fmac_f32 v9, s35, v11
    v_readlane_b32 s20, v4, 48
    v_readlane_b32 s21, v4, 49
    v_readlane_b32 s22, v4, 50
    v_readlane_b32 s23, v4, 51
    v_readlane_b32 s24, v4, 52
    v_readlane_b32 s25, v4, 53
    v_readlane_b32 s26, v4, 54
    v_readlane_b32 s27, v4, 55
    v_readlane_b32 s28, v4, 56
    v_readlane_b32 s29, v4, 57
    v_readlane_b32 s30, v4, 58
    v_readlane_b32 s31, v4, 59
    v_readlane_b32 s32, v4, 60
    v_readlane_b32 s33, v4, 61
    v_readlane_b32 s34, v4, 62
    v_readlane_b32 s35, v4, 63
    v_lshlrev_b32 v10, 16, v80
    v_and_b32 v11, 0xffff0000, v80
    v_fmac_f32 v8, s20, v10
    v_fmac_f32 v9, s20, v11
    v_lshlrev_b32 v10, 16, v81
    v_and_b32 v11, 0xffff0000, v81
    v_fmac_f32 v8, s21, v10
    v_fmac_f32 v9, s21, v11
    v_lshlrev_b32 v10, 16, v82
    v_and_b32 v11, 0xffff0000, v82
    v_fmac_f32 v8, s22, v10
    v_fmac_f32 v9, s22, v11
    v_lshlrev_b32 v10, 16, v83
    v_and_b32 v11, 0xffff0000, v83
    v_fmac_f32 v8, s23, v10
    v_fmac_f32 v9, s23, v11
    v_lshlrev_b32 v10, 16, v84
    v_and_b32 v11, 0xffff0000, v84
    v_fmac_f32 v8, s24, v10
    v_fmac_f32 v9, s24, v11
    v_lshlrev_b32 v10, 16, v85
    v_and_b32 v11, 0xffff0000, v85
    v_fmac_f32 v8, s25, v10
    v_fmac_f32 v9, s25, v11
    v_lshlrev_b32 v10, 16, v86
    v_and_b32 v11, 0xffff0000, v86
    v_fmac_f32 v8, s26, v10
    v_fmac_f32 v9, s26, v11
    v_lshlrev_b32 v10, 16, v87
    v_and_b32 v11, 0xffff0000, v87
    v_fmac_f32 v8, s27, v10
    v_fmac_f32 v9, s27, v11
    v_lshlrev_b32 v10, 16, v88
    v_and_b32 v11, 0xffff0000, v88
    v_fmac_f32 v8, s28, v10
    v_fmac_f32 v9, s28, v11
    v_lshlrev_b32 v10, 16, v89
    v_and_b32 v11, 0xffff0000, v89
    v_fmac_f32 v8, s29, v10
    v_fmac_f32 v9, s29, v11
    v_lshlrev_b32 v10, 16, v90
    v_and_b32 v11, 0xffff0000, v90
    v_fmac_f32 v8, s30, v10
    v_fmac_f32 v9, s30, v11
    v_lshlrev_b32 v10, 16, v91
    v_and_b32 v11, 0xffff0000, v91
    v_fmac_f32 v8, s31, v10
    v_fmac_f32 v9, s31, v11
    v_lshlrev_b32 v10, 16, v92
    v_and_b32 v11, 0xffff0000, v92
    v_fmac_f32 v8, s32, v10
    v_fmac_f32 v9, s32, v11
    v_lshlrev_b32 v10, 16, v93
    v_and_b32 v11, 0xffff0000, v93
    v_fmac_f32 v8, s33, v10
    v_fmac_f32 v9, s33, v11
    v_lshlrev_b32 v10, 16, v94
    v_and_b32 v11, 0xffff0000, v94
    v_fmac_f32 v8, s34, v10
    v_fmac_f32 v9, s34, v11
    v_lshlrev_b32 v10, 16, v95
    v_and_b32 v11, 0xffff0000, v95
    v_fmac_f32 v8, s35, v10
    v_fmac_f32 v9, s35, v11
    v_readlane_b32 s20, v5, 0
    v_readlane_b32 s21, v5, 1
    v_readlane_b32 s22, v5, 2
    v_readlane_b32 s23, v5, 3
    v_readlane_b32 s24, v5, 4
    v_readlane_b32 s25, v5, 5
    v_readlane_b32 s26, v5, 6
    v_readlane_b32 s27, v5, 7
    v_readlane_b32 s28, v5, 8
    v_readlane_b32 s29, v5, 9
    v_readlane_b32 s30, v5, 10
    v_readlane_b32 s31, v5, 11
    v_readlane_b32 s32, v5, 12
    v_readlane_b32 s33, v5, 13
    v_readlane_b32 s34, v5, 14
    v_readlane_b32 s35, v5, 15
    v_lshlrev_b32 v10, 16, v96
    v_and_b32 v11, 0xffff0000, v96
    v_fmac_f32 v8, s20, v10
    v_fmac_f32 v9, s20, v11
    v_lshlrev_b32 v10, 16, v97
    v_and_b32 v11, 0xffff0000, v97
    v_fmac_f32 v8, s21, v10
    v_fmac_f32 v9, s21, v11
    v_lshlrev_b32 v10, 16, v98
    v_and_b32 v11, 0xffff0000, v98
    v_fmac_f32 v8, s22, v10
    v_fmac_f32 v9, s22, v11
    v_lshlrev_b32 v10, 16, v99
    v_and_b32 v11, 0xffff0000, v99
    v_fmac_f32 v8, s23, v10
    v_fmac_f32 v9, s23, v11
    v_lshlrev_b32 v10, 16, v100
    v_and_b32 v11, 0xffff0000, v100
    v_fmac_f32 v8, s24, v10
    v_fmac_f32 v9, s24, v11
    v_lshlrev_b32 v10, 16, v101
    v_and_b32 v11, 0xffff0000, v101
    v_fmac_f32 v8, s25, v10
    v_fmac_f32 v9, s25, v11
    v_lshlrev_b32 v10, 16, v102
    v_and_b32 v11, 0xffff0000, v102
    v_fmac_f32 v8, s26, v10
    v_fmac_f32 v9, s26, v11
    v_lshlrev_b32 v10, 16, v103
    v_and_b32 v11, 0xffff0000, v103
    v_fmac_f32 v8, s27, v10
    v_fmac_f32 v9, s27, v11
    v_lshlrev_b32 v10, 16, v104
    v_and_b32 v11, 0xffff0000, v104
    v_fmac_f32 v8, s28, v10
    v_fmac_f32 v9, s28, v11
    v_lshlrev_b32 v10, 16, v105
    v_and_b32 v11, 0xffff0000, v105
    v_fmac_f32 v8, s29, v10
    v_fmac_f32 v9, s29, v11
    v_lshlrev_b32 v10, 16, v106
    v_and_b32 v11, 0xffff0000, v106
    v_fmac_f32 v8, s30, v10
    v_fmac_f32 v9, s30, v11
    v_lshlrev_b32 v10, 16, v107
    v_and_b32 v11, 0xffff0000, v107
    v_fmac_f32 v8, s31, v10
    v_fmac_f32 v9, s31, v11
    v_lshlrev_b32 v10, 16, v108
    v_and_b32 v11, 0xffff0000, v108
    v_fmac_f32 v8, s32, v10
    v_fmac_f32 v9, s32, v11
    v_lshlrev_b32 v10, 16, v109
    v_and_b32 v11, 0xffff0000, v109
    v_fmac_f32 v8, s33, v10
    v_fmac_f32 v9, s33, v11
    v_lshlrev_b32 v10, 16, v110
    v_and_b32 v11, 0xffff0000, v110
    v_fmac_f32 v8, s34, v10
    v_fmac_f32 v9, s34, v11
    v_lshlrev_b32 v10, 16, v111
    v_and_b32 v11, 0xffff0000, v111
    v_fmac_f32 v8, s35, v10
    v_fmac_f32 v9, s35, v11
    v_readlane_b32 s20, v5, 16
    v_readlane_b32 s21, v5, 17
    v_readlane_b32 s22, v5, 18
    v_readlane_b32 s23, v5, 19
    v_readlane_b32 s24, v5, 20
    v_readlane_b32 s25, v5, 21
    v_readlane_b32 s26, v5, 22
    v_readlane_b32 s27, v5, 23
    v_readlane_b32 s28, v5, 24
    v_readlane_b32 s29, v5, 25
    v_readlane_b32 s30, v5, 26
    v_readlane_b32 s31, v5, 27
    v_readlane_b32 s32, v5, 28
    v_readlane_b32 s33, v5, 29
    v_readlane_b32 s34, v5, 30
    v_readlane_b32 s35, v5, 31
    v_lshlrev_b32 v10, 16, v112
    v_and_b32 v11, 0xffff0000, v112
    v_fmac_f32 v8, s20, v10
    v_fmac_f32 v9, s20, v11
    v_lshlrev_b32 v10, 16, v113
    v_and_b32 v11, 0xffff0000, v113
    v_fmac_f32 v8, s21, v10
    v_fmac_f32 v9, s21, v11
    v_lshlrev_b32 v10, 16, v114
    v_and_b32 v11, 0xffff0000, v114
    v_fmac_f32 v8, s22, v10
    v_fmac_f32 v9, s22, v11
    v_lshlrev_b32 v10, 16, v115
    v_and_b32 v11, 0xffff0000, v115
    v_fmac_f32 v8, s23, v10
    v_fmac_f32 v9, s23, v11
    v_lshlrev_b32 v10, 16, v116
    v_and_b32 v11, 0xffff0000, v116
    v_fmac_f32 v8, s24, v10
    v_fmac_f32 v9, s24, v11
    v_lshlrev_b32 v10, 16, v117
    v_and_b32 v11, 0xffff0000, v117
    v_fmac_f32 v8, s25, v10
    v_fmac_f32 v9, s25, v11
    v_lshlrev_b32 v10, 16, v118
    v_and_b32 v11, 0xffff0000, v118
    v_fmac_f32 v8, s26, v10
    v_fmac_f32 v9, s26, v11
    v_lshlrev_b32 v10, 16, v119
    v_and_b32 v11, 0xffff0000, v119
    v_fmac_f32 v8, s27, v10
    v_fmac_f32 v9, s27, v11
    v_lshlrev_b32 v10, 16, v120
    v_and_b32 v11, 0xffff0000, v120
    v_fmac_f32 v8, s28, v10
    v_fmac_f32 v9, s28, v11
    v_lshlrev_b32 v10, 16, v121
    v_and_b32 v11, 0xffff0000, v121
    v_fmac_f32 v8, s29, v10
    v_fmac_f32 v9, s29, v11
    v_lshlrev_b32 v10, 16, v122
    v_and_b32 v11, 0xffff0000, v122
    v_fmac_f32 v8, s30, v10
    v_fmac_f32 v9, s30, v11
    v_lshlrev_b32 v10, 16, v123
    v_and_b32 v11, 0xffff0000, v123
    v_fmac_f32 v8, s31, v10
    v_fmac_f32 v9, s31, v11
    v_lshlrev_b32 v10, 16, v124
    v_and_b32 v11, 0xffff0000, v124
    v_fmac_f32 v8, s32, v10
    v_fmac_f32 v9, s32, v11
    v_lshlrev_b32 v10, 16, v125
    v_and_b32 v11, 0xffff0000, v125
    v_fmac_f32 v8, s33, v10
    v_fmac_f32 v9, s33, v11
    v_lshlrev_b32 v10, 16, v126
    v_and_b32 v11, 0xffff0000, v126
    v_fmac_f32 v8, s34, v10
    v_fmac_f32 v9, s34, v11
    v_lshlrev_b32 v10, 16, v127
    v_and_b32 v11, 0xffff0000, v127
    v_fmac_f32 v8, s35, v10
    v_fmac_f32 v9, s35, v11
    v_readlane_b32 s20, v5, 32
    v_readlane_b32 s21, v5, 33
    v_readlane_b32 s22, v5, 34
    v_readlane_b32 s23, v5, 35
    v_readlane_b32 s24, v5, 36
    v_readlane_b32 s25, v5, 37
    v_readlane_b32 s26, v5, 38
    v_readlane_b32 s27, v5, 39
    v_readlane_b32 s28, v5, 40
    v_readlane_b32 s29, v5, 41
    v_readlane_b32 s30, v5, 42
    v_readlane_b32 s31, v5, 43
    v_readlane_b32 s32, v5, 44
    v_readlane_b32 s33, v5, 45
    v_readlane_b32 s34, v5, 46
    v_readlane_b32 s35, v5, 47
    v_lshlrev_b32 v10, 16, v128
    v_and_b32 v11, 0xffff0000, v128
    v_fmac_f32 v8, s20, v10
    v_fmac_f32 v9, s20, v11
    v_lshlrev_b32 v10, 16, v129
    v_and_b32 v11, 0xffff0000, v129
    v_fmac_f32 v8, s21, v10
    v_fmac_f32 v9, s21, v11
    v_lshlrev_b32 v10, 16, v130
    v_and_b32 v11, 0xffff0000, v130
    v_fmac_f32 v8, s22, v10
    v_fmac_f32 v9, s22, v11
    v_lshlrev_b32 v10, 16, v131
    v_and_b32 v11, 0xffff0000, v131
    v_fmac_f32 v8, s23, v10
    v_fmac_f32 v9, s23, v11
    v_lshlrev_b32 v10, 16, v132
    v_and_b32 v11, 0xffff0000, v132
    v_fmac_f32 v8, s24, v10
    v_fmac_f32 v9, s24, v11
    v_lshlrev_b32 v10, 16, v133
    v_and_b32 v11, 0xffff0000, v133
    v_fmac_f32 v8, s25, v10
    v_fmac_f32 v9, s25, v11
    v_lshlrev_b32 v10, 16, v134
    v_and_b32 v11, 0xffff0000, v134
    v_fmac_f32 v8, s26, v10
    v_fmac_f32 v9, s26, v11
    v_lshlrev_b32 v10, 16, v135
    v_and_b32 v11, 0xffff0000, v135
    v_fmac_f32 v8, s27, v10
    v_fmac_f32 v9, s27, v11
    v_lshlrev_b32 v10, 16, v136
    v_and_b32 v11, 0xffff0000, v136
    v_fmac_f32 v8, s28, v10
    v_fmac_f32 v9, s28, v11
    v_lshlrev_b32 v10, 16, v137
    v_and_b32 v11, 0xffff0000, v137
    v_fmac_f32 v8, s29, v10
    v_fmac_f32 v9, s29, v11
    v_lshlrev_b32 v10, 16, v138
    v_and_b32 v11, 0xffff0000, v138
    v_fmac_f32 v8, s30, v10
    v_fmac_f32 v9, s30, v11
    v_lshlrev_b32 v10, 16, v139
    v_and_b32 v11, 0xffff0000, v139
    v_fmac_f32 v8, s31, v10
    v_fmac_f32 v9, s31, v11
    v_lshlrev_b32 v10, 16, v140
    v_and_b32 v11, 0xffff0000, v140
    v_fmac_f32 v8, s32, v10
    v_fmac_f32 v9, s32, v11
    v_lshlrev_b32 v10, 16, v141
    v_and_b32 v11, 0xffff0000, v141
    v_fmac_f32 v8, s33, v10
    v_fmac_f32 v9, s33, v11
    v_lshlrev_b32 v10, 16, v142
    v_and_b32 v11, 0xffff0000, v142
    v_fmac_f32 v8, s34, v10
    v_fmac_f32 v9, s34, v11
    v_lshlrev_b32 v10, 16, v143
    v_and_b32 v11, 0xffff0000, v143
    v_fmac_f32 v8, s35, v10
    v_fmac_f32 v9, s35, v11
    v_readlane_b32 s20, v5, 48
    v_readlane_b32 s21, v5, 49
    v_readlane_b32 s22, v5, 50
    v_readlane_b32 s23, v5, 51
    v_readlane_b32 s24, v5, 52
    v_readlane_b32 s25, v5, 53
    v_readlane_b32 s26, v5, 54
    v_readlane_b32 s27, v5, 55
    v_readlane_b32 s28, v5, 56
    v_readlane_b32 s29, v5, 57
    v_readlane_b32 s30, v5, 58
    v_readlane_b32 s31, v5, 59
    v_readlane_b32 s32, v5, 60
    v_readlane_b32 s33, v5, 61
    v_readlane_b32 s34, v5, 62
    v_readlane_b32 s35, v5, 63
    v_lshlrev_b32 v10, 16, v144
    v_and_b32 v11, 0xffff0000, v144
    v_fmac_f32 v8, s20, v10
    v_fmac_f32 v9, s20, v11
    v_lshlrev_b32 v10, 16, v145
    v_and_b32 v11, 0xffff0000, v145
    v_fmac_f32 v8, s21, v10
    v_fmac_f32 v9, s21, v11
    v_lshlrev_b32 v10, 16, v146
    v_and_b32 v11, 0xffff0000, v146
    v_fmac_f32 v8, s22, v10
    v_fmac_f32 v9, s22, v11
    v_lshlrev_b32 v10, 16, v147
    v_and_b32 v11, 0xffff0000, v147
    v_fmac_f32 v8, s23, v10
    v_fmac_f32 v9, s23, v11
    v_lshlrev_b32 v10, 16, v148
    v_and_b32 v11, 0xffff0000, v148
    v_fmac_f32 v8, s24, v10
    v_fmac_f32 v9, s24, v11
    v_lshlrev_b32 v10, 16, v149
    v_and_b32 v11, 0xffff0000, v149
    v_fmac_f32 v8, s25, v10
    v_fmac_f32 v9, s25, v11
    v_lshlrev_b32 v10, 16, v150
    v_and_b32 v11, 0xffff0000, v150
    v_fmac_f32 v8, s26, v10
    v_fmac_f32 v9, s26, v11
    v_lshlrev_b32 v10, 16, v151
    v_and_b32 v11, 0xffff0000, v151
    v_fmac_f32 v8, s27, v10
    v_fmac_f32 v9, s27, v11
    v_lshlrev_b32 v10, 16, v152
    v_and_b32 v11, 0xffff0000, v152
    v_fmac_f32 v8, s28, v10
    v_fmac_f32 v9, s28, v11
    v_lshlrev_b32 v10, 16, v153
    v_and_b32 v11, 0xffff0000, v153
    v_fmac_f32 v8, s29, v10
    v_fmac_f32 v9, s29, v11
    v_lshlrev_b32 v10, 16, v154
    v_and_b32 v11, 0xffff0000, v154
    v_fmac_f32 v8, s30, v10
    v_fmac_f32 v9, s30, v11
    v_lshlrev_b32 v10, 16, v155
    v_and_b32 v11, 0xffff0000, v155
    v_fmac_f32 v8, s31, v10
    v_fmac_f32 v9, s31, v11
    v_lshlrev_b32 v10, 16, v156
    v_and_b32 v11, 0xffff0000, v156
    v_fmac_f32 v8, s32, v10
    v_fmac_f32 v9, s32, v11
    v_lshlrev_b32 v10, 16, v157
    v_and_b32 v11, 0xffff0000, v157
    v_fmac_f32 v8, s33, v10
    v_fmac_f32 v9, s33, v11
    v_lshlrev_b32 v10, 16, v158
    v_and_b32 v11, 0xffff0000, v158
    v_fmac_f32 v8, s34, v10
    v_fmac_f32 v9, s34, v11
    v_lshlrev_b32 v10, 16, v159
    v_and_b32 v11, 0xffff0000, v159
    v_fmac_f32 v8, s35, v10
    v_fmac_f32 v9, s35, v11
    v_lshlrev_b32 v12, 3, v0
    ds_write_b64 v12, v[8:9]
    s_waitcnt lgkmcnt(0)
    s_barrier
    s_cmp_lg_u32 s3, 0
    s_nop 0
    s_cbranch_scc1 .Lend_mod_kernel
    ds_read_b64 v[14:15], v12 offset:512
    ds_read_b64 v[16:17], v12 offset:1024
    ds_read_b64 v[18:19], v12 offset:1536
    s_waitcnt lgkmcnt(0)
    v_add_f32 v8, v8, v14
    v_add_f32 v9, v9, v15
    v_add_f32 v16, v16, v18
    v_add_f32 v17, v17, v19
    v_add_f32 v8, v8, v16
    v_add_f32 v9, v9, v17
    v_cvt_pk_bf16_f32 v8, v8, v8
    v_lshlrev_b32 v8, 16, v8
    v_cvt_pk_bf16_f32 v9, v9, v9
    v_lshlrev_b32 v9, 16, v9
    v_lshlrev_b32 v6, 1, v6
    buffer_store_dwordx2 v[8:9], v6, s[12:15], 0 offen
    s_nop 3
.Lend_mod_kernel:
    s_endpgm
.globl ln1_kernel
.p2align 8
.type ln1_kernel,@function
ln1_kernel:
    s_cmp_ge_u32 s2, 512
    s_cbranch_scc1 .Lend_ln1_kernel
    s_load_dwordx2 s[4:5], s[0:1], 0
    s_load_dwordx2 s[8:9], s[0:1], 112
    s_load_dwordx2 s[12:13], s[0:1], 112
    v_and_b32 v1, 63, v0
    v_lshrrev_b32 v2, 6, v0
    s_nop 0
    v_readfirstlane_b32 s3, v2
    s_waitcnt lgkmcnt(0)
    s_and_b32 s5, s5, 0xffff
    s_mov_b32 s6, 0x200000
    s_mov_b32 s7, 0x00020000
    s_add_u32 s8, s8, 0x100000
    s_addc_u32 s9, s9, 0
    s_and_b32 s9, s9, 0xffff
    s_mov_b32 s10, 0x200000
    s_mov_b32 s11, 0x00020000
    s_and_b32 s13, s13, 0xffff
    s_mov_b32 s14, 0x3000
    s_mov_b32 s15, 0x00020000
    s_lshl_b32 s16, s2, 2
    s_add_u32 s16, s16, s3
    s_lshl_b32 s16, s16, 10
    v_lshlrev_b32 v3, 4, v1
    buffer_load_dwordx4 v[4:7], v3, s[4:7], s16 offen
    v_lshlrev_b32 v8, 5, v1
    s_mov_b32 s17, 2048
    s_mov_b32 s18, 0
    buffer_load_dwordx4 v[40:43], v8, s[12:15], s17 offen
    buffer_load_dwordx4 v[44:47], v8, s[12:15], s17 offen offset:16
    buffer_load_dwordx4 v[48:51], v8, s[12:15], s18 offen
    buffer_load_dwordx4 v[52:55], v8, s[12:15], s18 offen offset:16
    s_waitcnt vmcnt(4)
    v_lshlrev_b32 v16, 16, v4
    v_and_b32 v17, 0xffff0000, v4
    v_lshlrev_b32 v18, 16, v5
    v_and_b32 v19, 0xffff0000, v5
    v_lshlrev_b32 v20, 16, v6
    v_and_b32 v21, 0xffff0000, v6
    v_lshlrev_b32 v22, 16, v7
    v_and_b32 v23, 0xffff0000, v7
    v_add_f32 v30, v16, v17
    v_add_f32 v30, v30, v18
    v_add_f32 v30, v30, v19
    v_add_f32 v30, v30, v20
    v_add_f32 v30, v30, v21
    v_add_f32 v30, v30, v22
    v_add_f32 v30, v30, v23
    s_nop 1
    v_add_f32_dpp v30, v30, v30 quad_perm:[1,0,3,2] row_mask:0xf bank_mask:0xf
    s_nop 1
    v_add_f32_dpp v30, v30, v30 quad_perm:[2,3,0,1] row_mask:0xf bank_mask:0xf
    s_nop 1
    v_add_f32_dpp v30, v30, v30 row_half_mirror row_mask:0xf bank_mask:0xf
    s_nop 1
    v_add_f32_dpp v30, v30, v30 row_mirror row_mask:0xf bank_mask:0xf
    s_nop 1
    v_add_f32_dpp v30, v30, v30 row_bcast:15 row_mask:0xa bank_mask:0xf
    s_nop 1
    v_add_f32_dpp v30, v30, v30 row_bcast:31 row_mask:0xc bank_mask:0xf
    s_nop 0
    v_readlane_b32 s20, v30, 63
    s_nop 1
    v_mov_b32 v31, s20
    v_mul_f32 v31, 0x3b000000, v31
    v_sub_f32 v32, v16, v31
    v_mul_f32 v30, v32, v32
    v_sub_f32 v32, v17, v31
    v_fmac_f32 v30, v32, v32
    v_sub_f32 v32, v18, v31
    v_fmac_f32 v30, v32, v32
    v_sub_f32 v32, v19, v31
    v_fmac_f32 v30, v32, v32
    v_sub_f32 v32, v20, v31
    v_fmac_f32 v30, v32, v32
    v_sub_f32 v32, v21, v31
    v_fmac_f32 v30, v32, v32
    v_sub_f32 v32, v22, v31
    v_fmac_f32 v30, v32, v32
    v_sub_f32 v32, v23, v31
    v_fmac_f32 v30, v32, v32
    s_nop 1
    v_add_f32_dpp v30, v30, v30 quad_perm:[1,0,3,2] row_mask:0xf bank_mask:0xf
    s_nop 1
    v_add_f32_dpp v30, v30, v30 quad_perm:[2,3,0,1] row_mask:0xf bank_mask:0xf
    s_nop 1
    v_add_f32_dpp v30, v30, v30 row_half_mirror row_mask:0xf bank_mask:0xf
    s_nop 1
    v_add_f32_dpp v30, v30, v30 row_mirror row_mask:0xf bank_mask:0xf
    s_nop 1
    v_add_f32_dpp v30, v30, v30 row_bcast:15 row_mask:0xa bank_mask:0xf
    s_nop 1
    v_add_f32_dpp v30, v30, v30 row_bcast:31 row_mask:0xc bank_mask:0xf
    s_nop 0
    v_readlane_b32 s21, v30, 63
    s_nop 1
    v_mov_b32 v32, s21
    v_mul_f32 v32, 0x3b000000, v32
    v_cvt_pk_bf16_f32 v31, v31, v31
    v_lshlrev_b32 v31, 16, v31
    v_cvt_pk_bf16_f32 v32, v32, v32
    v_lshlrev_b32 v32, 16, v32
    v_add_f32 v32, 0x3727c5ac, v32
    v_cvt_pk_bf16_f32 v32, v32, v32
    v_lshlrev_b32 v32, 16, v32
    v_sqrt_f32 v32, v32
    s_nop 0
    v_cvt_pk_bf16_f32 v32, v32, v32
    v_lshlrev_b32 v32, 16, v32
    v_rcp_f32 v32, v32
    v_sub_f32 v16, v16, v31
    v_cvt_pk_bf16_f32 v16, v16, v16
    v_lshlrev_b32 v16, 16, v16
    v_mul_f32 v16, v16, v32
    v_cvt_pk_bf16_f32 v16, v16, v16
    v_lshlrev_b32 v16, 16, v16
    v_sub_f32 v17, v17, v31
    v_cvt_pk_bf16_f32 v17, v17, v17
    v_lshlrev_b32 v17, 16, v17
    v_mul_f32 v17, v17, v32
    v_cvt_pk_bf16_f32 v17, v17, v17
    v_lshlrev_b32 v17, 16, v17
    v_sub_f32 v18, v18, v31
    v_cvt_pk_bf16_f32 v18, v18, v18
    v_lshlrev_b32 v18, 16, v18
    v_mul_f32 v18, v18, v32
    v_cvt_pk_bf16_f32 v18, v18, v18
    v_lshlrev_b32 v18, 16, v18
    v_sub_f32 v19, v19, v31
    v_cvt_pk_bf16_f32 v19, v19, v19
    v_lshlrev_b32 v19, 16, v19
    v_mul_f32 v19, v19, v32
    v_cvt_pk_bf16_f32 v19, v19, v19
    v_lshlrev_b32 v19, 16, v19
    v_sub_f32 v20, v20, v31
    v_cvt_pk_bf16_f32 v20, v20, v20
    v_lshlrev_b32 v20, 16, v20
    v_mul_f32 v20, v20, v32
    v_cvt_pk_bf16_f32 v20, v20, v20
    v_lshlrev_b32 v20, 16, v20
    v_sub_f32 v21, v21, v31
    v_cvt_pk_bf16_f32 v21, v21, v21
    v_lshlrev_b32 v21, 16, v21
    v_mul_f32 v21, v21, v32
    v_cvt_pk_bf16_f32 v21, v21, v21
    v_lshlrev_b32 v21, 16, v21
    v_sub_f32 v22, v22, v31
    v_cvt_pk_bf16_f32 v22, v22, v22
    v_lshlrev_b32 v22, 16, v22
    v_mul_f32 v22, v22, v32
    v_cvt_pk_bf16_f32 v22, v22, v22
    v_lshlrev_b32 v22, 16, v22
    v_sub_f32 v23, v23, v31
    v_cvt_pk_bf16_f32 v23, v23, v23
    v_lshlrev_b32 v23, 16, v23
    v_mul_f32 v23, v23, v32
    v_cvt_pk_bf16_f32 v23, v23, v23
    v_lshlrev_b32 v23, 16, v23
    s_waitcnt vmcnt(0)
    v_add_f32 v40, 1.0, v40
    v_cvt_pk_bf16_f32 v40, v40, v40
    v_lshlrev_b32 v40, 16, v40
    v_add_f32 v41, 1.0, v41
    v_cvt_pk_bf16_f32 v41, v41, v41
    v_lshlrev_b32 v41, 16, v41
    v_add_f32 v42, 1.0, v42
    v_cvt_pk_bf16_f32 v42, v42, v42
    v_lshlrev_b32 v42, 16, v42
    v_add_f32 v43, 1.0, v43
    v_cvt_pk_bf16_f32 v43, v43, v43
    v_lshlrev_b32 v43, 16, v43
    v_add_f32 v44, 1.0, v44
    v_cvt_pk_bf16_f32 v44, v44, v44
    v_lshlrev_b32 v44, 16, v44
    v_add_f32 v45, 1.0, v45
    v_cvt_pk_bf16_f32 v45, v45, v45
    v_lshlrev_b32 v45, 16, v45
    v_add_f32 v46, 1.0, v46
    v_cvt_pk_bf16_f32 v46, v46, v46
    v_lshlrev_b32 v46, 16, v46
    v_add_f32 v47, 1.0, v47
    v_cvt_pk_bf16_f32 v47, v47, v47
    v_lshlrev_b32 v47, 16, v47
    v_mul_f32 v16, v16, v40
    v_cvt_pk_bf16_f32 v16, v16, v16
    v_lshlrev_b32 v16, 16, v16
    v_add_f32 v16, v16, v48
    v_mul_f32 v17, v17, v41
    v_cvt_pk_bf16_f32 v17, v17, v17
    v_lshlrev_b32 v17, 16, v17
    v_add_f32 v17, v17, v49
    v_mul_f32 v18, v18, v42
    v_cvt_pk_bf16_f32 v18, v18, v18
    v_lshlrev_b32 v18, 16, v18
    v_add_f32 v18, v18, v50
    v_mul_f32 v19, v19, v43
    v_cvt_pk_bf16_f32 v19, v19, v19
    v_lshlrev_b32 v19, 16, v19
    v_add_f32 v19, v19, v51
    v_mul_f32 v20, v20, v44
    v_cvt_pk_bf16_f32 v20, v20, v20
    v_lshlrev_b32 v20, 16, v20
    v_add_f32 v20, v20, v52
    v_mul_f32 v21, v21, v45
    v_cvt_pk_bf16_f32 v21, v21, v21
    v_lshlrev_b32 v21, 16, v21
    v_add_f32 v21, v21, v53
    v_mul_f32 v22, v22, v46
    v_cvt_pk_bf16_f32 v22, v22, v22
    v_lshlrev_b32 v22, 16, v22
    v_add_f32 v22, v22, v54
    v_mul_f32 v23, v23, v47
    v_cvt_pk_bf16_f32 v23, v23, v23
    v_lshlrev_b32 v23, 16, v23
    v_add_f32 v23, v23, v55
    v_cvt_pk_bf16_f32 v4, v16, v17
    v_cvt_pk_bf16_f32 v5, v18, v19
    v_cvt_pk_bf16_f32 v6, v20, v21
    v_cvt_pk_bf16_f32 v7, v22, v23
    buffer_store_dwordx4 v[4:7], v3, s[8:11], s16 offen
    s_nop 3
.Lend_ln1_kernel:
    s_endpgm
.globl gemmq_kernel
.p2align 8
.type gemmq_kernel,@function
gemmq_kernel:
    s_cmp_ge_u32 s2, 256
    s_cbranch_scc1 .Lend_gemmq_kernel
    s_load_dwordx2 s[4:5], s[0:1], 112
    s_load_dwordx2 s[8:9], s[0:1], 24
    v_and_b32 v1, 63, v0
    v_lshrrev_b32 v12, 6, v0
    s_nop 0
    v_readfirstlane_b32 s3, v12
    s_mov_b32 s29, 0
    s_mov_b32 s16, s2
    s_mul_hi_u32 s17, s16, 0x8000001
    s_mul_i32 s18, s17, 32
    s_sub_u32 s18, s16, s18
    s_mul_i32 s19, s17, 256
    s_mul_i32 s20, s18, 128
    s_and_b32 s21, s3, 3
    s_lshr_b32 s22, s3, 2
    s_waitcnt lgkmcnt(0)
    s_add_u32 s4, s4, 0x100000
    s_addc_u32 s5, s5, 0
    s_and_b32 s5, s5, 0xffff
    s_mov_b32 s6, 0x200000
    s_mov_b32 s7, 0x00020000
    s_and_b32 s9, s9, 0xffff
    s_mov_b32 s10, 0x400000
    s_mov_b32 s11, 0x00020000
    v_lshrrev_b32 v12, 3, v1
    v_mul_u32_u24 v10, 1024, v12
    v_lshrrev_b32 v13, 4, v1
    s_and_b32 s23, s3, 1
    s_lshl_b32 s23, s23, 2
    v_add_u32 v13, s23, v13
    v_and_b32 v13, 7, v13
    v_and_b32 v14, 7, v1
    v_xor_b32 v14, v14, v13
    v_lshlrev_b32 v14, 4, v14
    v_add_u32 v10, v10, v14
    v_lshrrev_b32 v12, 4, v1
    v_mul_u32_u24 v11, 8192, v12
    v_and_b32 v13, 3, v12
    v_lshlrev_b32 v13, 2, v13
    v_and_b32 v14, 15, v1
    v_xor_b32 v14, v14, v13
    v_lshlrev_b32 v14, 4, v14
    v_add_u32 v11, v11, v14
    s_lshl_b32 s23, s3, 3
    s_add_u32 s23, s23, s19
    s_mul_i32 s24, s23, 1024
    s_mul_i32 s25, s3, 32768
    s_lshl_b32 s23, s20, 1
    s_add_u32 s25, s25, s23
    s_lshl_b32 s27, s3, 10
    s_add_u32 m0, s27, 0
    s_add_u32 s26, s24, 0
    buffer_load_dwordx4 v10, s[4:7], s26 offen lds
    s_add_u32 m0, s27, 8192
    s_add_u32 s26, s24, 65536
    buffer_load_dwordx4 v10, s[4:7], s26 offen lds
    s_add_u32 m0, s27, 16384
    s_add_u32 s26, s24, 131072
    buffer_load_dwordx4 v10, s[4:7], s26 offen lds
    s_add_u32 m0, s27, 24576
    s_add_u32 s26, s24, 196608
    buffer_load_dwordx4 v10, s[4:7], s26 offen lds
    s_add_u32 m0, s27, 32768
    s_add_u32 s26, s25, 0
    buffer_load_dwordx4 v11, s[8:11], s26 offen lds
    s_add_u32 m0, s27, 40960
    s_add_u32 s26, s25, 262144
    buffer_load_dwordx4 v11, s[8:11], s26 offen lds
    s_add_u32 s24, s24, 128
    s_add_u32 s25, s25, 524288
    s_add_u32 m0, s27, 49152
    s_add_u32 s26, s24, 0
    buffer_load_dwordx4 v10, s[4:7], s26 offen lds
    s_add_u32 m0, s27, 57344
    s_add_u32 s26, s24, 65536
    buffer_load_dwordx4 v10, s[4:7], s26 offen lds
    s_add_u32 m0, s27, 65536
    s_add_u32 s26, s24, 131072
    buffer_load_dwordx4 v10, s[4:7], s26 offen lds
    s_add_u32 m0, s27, 73728
    s_add_u32 s26, s24, 196608
    buffer_load_dwordx4 v10, s[4:7], s26 offen lds
    s_add_u32 m0, s27, 81920
    s_add_u32 s26, s25, 0
    buffer_load_dwordx4 v11, s[8:11], s26 offen lds
    s_add_u32 m0, s27, 90112
    s_add_u32 s26, s25, 262144
    buffer_load_dwordx4 v11, s[8:11], s26 offen lds
    s_add_u32 s24, s24, 128
    s_add_u32 s25, s25, 524288
    v_and_b32 v12, 31, v1
    s_mul_i32 s23, s21, 64
    v_add_u32 v12, s23, v12
    v_lshrrev_b32 v13, 1, v12
    v_and_b32 v13, 7, v13
    v_lshrrev_b32 v14, 5, v1
    v_lshlrev_b32 v12, 7, v12
    v_add_u32 v15, 0, v14
    v_xor_b32 v15, v15, v13
    v_lshlrev_b32 v15, 4, v15
    v_add_u32 v120, v12, v15
    v_add_u32 v15, 2, v14
    v_xor_b32 v15, v15, v13
    v_lshlrev_b32 v15, 4, v15
    v_add_u32 v121, v12, v15
    v_add_u32 v15, 4, v14
    v_xor_b32 v15, v15, v13
    v_lshlrev_b32 v15, 4, v15
    v_add_u32 v122, v12, v15
    v_add_u32 v15, 6, v14
    v_xor_b32 v15, v15, v13
    v_lshlrev_b32 v15, 4, v15
    v_add_u32 v123, v12, v15
    v_lshrrev_b32 v12, 2, v1
    v_and_b32 v12, 3, v12
    v_lshrrev_b32 v13, 5, v1
    v_lshlrev_b32 v13, 3, v13
    v_add_u32 v13, v13, v12
    v_mul_u32_u24 v13, 256, v13
    v_lshrrev_b32 v14, 4, v1
    v_and_b32 v14, 1, v14
    v_lshlrev_b32 v14, 1, v14
    v_and_b32 v15, 3, v1
    v_lshrrev_b32 v16, 1, v15
    v_add_u32 v14, v14, v16
    v_and_b32 v15, 1, v15
    v_lshlrev_b32 v15, 3, v15
    v_add_u32 v13, v13, v15
    v_lshlrev_b32 v12, 2, v12
    s_mul_i32 s23, s22, 8
    s_add_u32 s23, s23, 0
    v_add_u32 v15, s23, v14
    v_xor_b32 v15, v15, v12
    v_lshlrev_b32 v15, 4, v15
    v_add_u32 v132, v13, v15
    s_mul_i32 s23, s22, 8
    s_add_u32 s23, s23, 4
    v_add_u32 v15, s23, v14
    v_xor_b32 v15, v15, v12
    v_lshlrev_b32 v15, 4, v15
    v_add_u32 v133, v13, v15
    v_add_u32 v124, 0x10000, v120
    v_add_u32 v125, 0x10000, v121
    v_add_u32 v126, 0x10000, v122
    v_add_u32 v127, 0x10000, v123
    v_add_u32 v134, 0x10000, v132
    v_add_u32 v135, 0x10000, v133
    v_add_u32 v128, 0x20000, v120
    v_add_u32 v129, 0x20000, v121
    v_add_u32 v130, 0x20000, v122
    v_add_u32 v131, 0x20000, v123
    v_add_u32 v136, 0x20000, v132
    v_add_u32 v137, 0x20000, v133
    s_waitcnt vmcnt(6)
    s_barrier
    s_add_u32 m0, s27, 98304
    s_add_u32 s26, s24, 0
    buffer_load_dwordx4 v10, s[4:7], s26 offen lds
    s_add_u32 m0, s27, 106496
    s_add_u32 s26, s24, 65536
    buffer_load_dwordx4 v10, s[4:7], s26 offen lds
    s_add_u32 m0, s27, 114688
    s_add_u32 s26, s24, 131072
    buffer_load_dwordx4 v10, s[4:7], s26 offen lds
    s_add_u32 m0, s27, 122880
    s_add_u32 s26, s24, 196608
    buffer_load_dwordx4 v10, s[4:7], s26 offen lds
    s_add_u32 m0, s27, 131072
    s_add_u32 s26, s25, 0
    buffer_load_dwordx4 v11, s[8:11], s26 offen lds
    s_add_u32 m0, s27, 139264
    s_add_u32 s26, s25, 262144
    buffer_load_dwordx4 v11, s[8:11], s26 offen lds
    s_add_u32 s24, s24, 128
    s_add_u32 s25, s25, 524288
    ds_read_b128 v[88:91], v120 offset:0
    ds_read_b128 v[92:95], v120 offset:4096
    ds_read_b64_tr_b16 v[104:105], v132 offset:32768
    ds_read_b64_tr_b16 v[106:107], v132 offset:33792
    ds_read_b64_tr_b16 v[108:109], v133 offset:32768
    ds_read_b64_tr_b16 v[110:111], v133 offset:33792
    ds_read_b128 v[96:99], v121 offset:0
    ds_read_b128 v[100:103], v121 offset:4096
    ds_read_b64_tr_b16 v[112:113], v132 offset:36864
    ds_read_b64_tr_b16 v[114:115], v132 offset:37888
    ds_read_b64_tr_b16 v[116:117], v133 offset:36864
    ds_read_b64_tr_b16 v[118:119], v133 offset:37888
    s_waitcnt lgkmcnt(6)
    v_mfma_f32_32x32x16_bf16 v[24:39], v[104:107], v[88:91], 0
    v_mfma_f32_32x32x16_bf16 v[40:55], v[104:107], v[92:95], 0
    v_mfma_f32_32x32x16_bf16 v[56:71], v[108:111], v[88:91], 0
    v_mfma_f32_32x32x16_bf16 v[72:87], v[108:111], v[92:95], 0
    ds_read_b128 v[88:91], v122 offset:0
    ds_read_b128 v[92:95], v122 offset:4096
    ds_read_b64_tr_b16 v[104:105], v132 offset:40960
    ds_read_b64_tr_b16 v[106:107], v132 offset:41984
    ds_read_b64_tr_b16 v[108:109], v133 offset:40960
    ds_read_b64_tr_b16 v[110:111], v133 offset:41984
    s_waitcnt lgkmcnt(6)
    v_mfma_f32_32x32x16_bf16 v[24:39], v[112:115], v[96:99], v[24:39]
    v_mfma_f32_32x32x16_bf16 v[40:55], v[112:115], v[100:103], v[40:55]
    v_mfma_f32_32x32x16_bf16 v[56:71], v[116:119], v[96:99], v[56:71]
    v_mfma_f32_32x32x16_bf16 v[72:87], v[116:119], v[100:103], v[72:87]
    ds_read_b128 v[96:99], v123 offset:0
    ds_read_b128 v[100:103], v123 offset:4096
    ds_read_b64_tr_b16 v[112:113], v132 offset:45056
    ds_read_b64_tr_b16 v[114:115], v132 offset:46080
    ds_read_b64_tr_b16 v[116:117], v133 offset:45056
    ds_read_b64_tr_b16 v[118:119], v133 offset:46080
    s_waitcnt lgkmcnt(6)
    v_mfma_f32_32x32x16_bf16 v[24:39], v[104:107], v[88:91], v[24:39]
    v_mfma_f32_32x32x16_bf16 v[40:55], v[104:107], v[92:95], v[40:55]
    v_mfma_f32_32x32x16_bf16 v[56:71], v[108:111], v[88:91], v[56:71]
    v_mfma_f32_32x32x16_bf16 v[72:87], v[108:111], v[92:95], v[72:87]
    s_waitcnt lgkmcnt(0)
    v_mfma_f32_32x32x16_bf16 v[24:39], v[112:115], v[96:99], v[24:39]
    v_mfma_f32_32x32x16_bf16 v[40:55], v[112:115], v[100:103], v[40:55]
    v_mfma_f32_32x32x16_bf16 v[56:71], v[116:119], v[96:99], v[56:71]
    v_mfma_f32_32x32x16_bf16 v[72:87], v[116:119], v[100:103], v[72:87]
    s_waitcnt vmcnt(6)
    s_barrier
    s_add_u32 m0, s27, 0
    s_add_u32 s26, s24, 0
    buffer_load_dwordx4 v10, s[4:7], s26 offen lds
    s_add_u32 m0, s27, 8192
    s_add_u32 s26, s24, 65536
    buffer_load_dwordx4 v10, s[4:7], s26 offen lds
    s_add_u32 m0, s27, 16384
    s_add_u32 s26, s24, 131072
    buffer_load_dwordx4 v10, s[4:7], s26 offen lds
    s_add_u32 m0, s27, 24576
    s_add_u32 s26, s24, 196608
    buffer_load_dwordx4 v10, s[4:7], s26 offen lds
    s_add_u32 m0, s27, 32768
    s_add_u32 s26, s25, 0
    buffer_load_dwordx4 v11, s[8:11], s26 offen lds
    s_add_u32 m0, s27, 40960
    s_add_u32 s26, s25, 262144
    buffer_load_dwordx4 v11, s[8:11], s26 offen lds
    s_add_u32 s24, s24, 128
    s_add_u32 s25, s25, 524288
    ds_read_b128 v[88:91], v120 offset:49152
    ds_read_b128 v[92:95], v120 offset:53248
    ds_read_b64_tr_b16 v[104:105], v134 offset:16384
    ds_read_b64_tr_b16 v[106:107], v134 offset:17408
    ds_read_b64_tr_b16 v[108:109], v135 offset:16384
    ds_read_b64_tr_b16 v[110:111], v135 offset:17408
    ds_read_b128 v[96:99], v121 offset:49152
    ds_read_b128 v[100:103], v121 offset:53248
    ds_read_b64_tr_b16 v[112:113], v134 offset:20480
    ds_read_b64_tr_b16 v[114:115], v134 offset:21504
    ds_read_b64_tr_b16 v[116:117], v135 offset:20480
    ds_read_b64_tr_b16 v[118:119], v135 offset:21504
    s_waitcnt lgkmcnt(6)
    v_mfma_f32_32x32x16_bf16 v[24:39], v[104:107], v[88:91], v[24:39]
    v_mfma_f32_32x32x16_bf16 v[40:55], v[104:107], v[92:95], v[40:55]
    v_mfma_f32_32x32x16_bf16 v[56:71], v[108:111], v[88:91], v[56:71]
    v_mfma_f32_32x32x16_bf16 v[72:87], v[108:111], v[92:95], v[72:87]
    ds_read_b128 v[88:91], v122 offset:49152
    ds_read_b128 v[92:95], v122 offset:53248
    ds_read_b64_tr_b16 v[104:105], v134 offset:24576
    ds_read_b64_tr_b16 v[106:107], v134 offset:25600
    ds_read_b64_tr_b16 v[108:109], v135 offset:24576
    ds_read_b64_tr_b16 v[110:111], v135 offset:25600
    s_waitcnt lgkmcnt(6)
    v_mfma_f32_32x32x16_bf16 v[24:39], v[112:115], v[96:99], v[24:39]
    v_mfma_f32_32x32x16_bf16 v[40:55], v[112:115], v[100:103], v[40:55]
    v_mfma_f32_32x32x16_bf16 v[56:71], v[116:119], v[96:99], v[56:71]
    v_mfma_f32_32x32x16_bf16 v[72:87], v[116:119], v[100:103], v[72:87]
    ds_read_b128 v[96:99], v123 offset:49152
    ds_read_b128 v[100:103], v123 offset:53248
    ds_read_b64_tr_b16 v[112:113], v134 offset:28672
    ds_read_b64_tr_b16 v[114:115], v134 offset:29696
    ds_read_b64_tr_b16 v[116:117], v135 offset:28672
    ds_read_b64_tr_b16 v[118:119], v135 offset:29696
    s_waitcnt lgkmcnt(6)
    v_mfma_f32_32x32x16_bf16 v[24:39], v[104:107], v[88:91], v[24:39]
    v_mfma_f32_32x32x16_bf16 v[40:55], v[104:107], v[92:95], v[40:55]
    v_mfma_f32_32x32x16_bf16 v[56:71], v[108:111], v[88:91], v[56:71]
    v_mfma_f32_32x32x16_bf16 v[72:87], v[108:111], v[92:95], v[72:87]
    s_waitcnt lgkmcnt(0)
    v_mfma_f32_32x32x16_bf16 v[24:39], v[112:115], v[96:99], v[24:39]
    v_mfma_f32_32x32x16_bf16 v[40:55], v[112:115], v[100:103], v[40:55]
    v_mfma_f32_32x32x16_bf16 v[56:71], v[116:119], v[96:99], v[56:71]
    v_mfma_f32_32x32x16_bf16 v[72:87], v[116:119], v[100:103], v[72:87]
    s_waitcnt vmcnt(6)
    s_barrier
    s_add_u32 m0, s27, 49152
    s_add_u32 s26, s24, 0
    buffer_load_dwordx4 v10, s[4:7], s26 offen lds
    s_add_u32 m0, s27, 57344
    s_add_u32 s26, s24, 65536
    buffer_load_dwordx4 v10, s[4:7], s26 offen lds
    s_add_u32 m0, s27, 65536
    s_add_u32 s26, s24, 131072
    buffer_load_dwordx4 v10, s[4:7], s26 offen lds
    s_add_u32 m0, s27, 73728
    s_add_u32 s26, s24, 196608
    buffer_load_dwordx4 v10, s[4:7], s26 offen lds
    s_add_u32 m0, s27, 81920
    s_add_u32 s26, s25, 0
    buffer_load_dwordx4 v11, s[8:11], s26 offen lds
    s_add_u32 m0, s27, 90112
    s_add_u32 s26, s25, 262144
    buffer_load_dwordx4 v11, s[8:11], s26 offen lds
    s_add_u32 s24, s24, 128
    s_add_u32 s25, s25, 524288
    ds_read_b128 v[88:91], v124 offset:32768
    ds_read_b128 v[92:95], v124 offset:36864
    ds_read_b64_tr_b16 v[104:105], v136 offset:0
    ds_read_b64_tr_b16 v[106:107], v136 offset:1024
    ds_read_b64_tr_b16 v[108:109], v137 offset:0
    ds_read_b64_tr_b16 v[110:111], v137 offset:1024
    ds_read_b128 v[96:99], v125 offset:32768
    ds_read_b128 v[100:103], v125 offset:36864
    ds_read_b64_tr_b16 v[112:113], v136 offset:4096
    ds_read_b64_tr_b16 v[114:115], v136 offset:5120
    ds_read_b64_tr_b16 v[116:117], v137 offset:4096
    ds_read_b64_tr_b16 v[118:119], v137 offset:5120
    s_waitcnt lgkmcnt(6)
    v_mfma_f32_32x32x16_bf16 v[24:39], v[104:107], v[88:91], v[24:39]
    v_mfma_f32_32x32x16_bf16 v[40:55], v[104:107], v[92:95], v[40:55]
    v_mfma_f32_32x32x16_bf16 v[56:71], v[108:111], v[88:91], v[56:71]
    v_mfma_f32_32x32x16_bf16 v[72:87], v[108:111], v[92:95], v[72:87]
    ds_read_b128 v[88:91], v126 offset:32768
    ds_read_b128 v[92:95], v126 offset:36864
    ds_read_b64_tr_b16 v[104:105], v136 offset:8192
    ds_read_b64_tr_b16 v[106:107], v136 offset:9216
    ds_read_b64_tr_b16 v[108:109], v137 offset:8192
    ds_read_b64_tr_b16 v[110:111], v137 offset:9216
    s_waitcnt lgkmcnt(6)
    v_mfma_f32_32x32x16_bf16 v[24:39], v[112:115], v[96:99], v[24:39]
    v_mfma_f32_32x32x16_bf16 v[40:55], v[112:115], v[100:103], v[40:55]
    v_mfma_f32_32x32x16_bf16 v[56:71], v[116:119], v[96:99], v[56:71]
    v_mfma_f32_32x32x16_bf16 v[72:87], v[116:119], v[100:103], v[72:87]
    ds_read_b128 v[96:99], v127 offset:32768
    ds_read_b128 v[100:103], v127 offset:36864
    ds_read_b64_tr_b16 v[112:113], v136 offset:12288
    ds_read_b64_tr_b16 v[114:115], v136 offset:13312
    ds_read_b64_tr_b16 v[116:117], v137 offset:12288
    ds_read_b64_tr_b16 v[118:119], v137 offset:13312
    s_waitcnt lgkmcnt(6)
    v_mfma_f32_32x32x16_bf16 v[24:39], v[104:107], v[88:91], v[24:39]
    v_mfma_f32_32x32x16_bf16 v[40:55], v[104:107], v[92:95], v[40:55]
    v_mfma_f32_32x32x16_bf16 v[56:71], v[108:111], v[88:91], v[56:71]
    v_mfma_f32_32x32x16_bf16 v[72:87], v[108:111], v[92:95], v[72:87]
    s_waitcnt lgkmcnt(0)
    v_mfma_f32_32x32x16_bf16 v[24:39], v[112:115], v[96:99], v[24:39]
    v_mfma_f32_32x32x16_bf16 v[40:55], v[112:115], v[100:103], v[40:55]
    v_mfma_f32_32x32x16_bf16 v[56:71], v[116:119], v[96:99], v[56:71]
    v_mfma_f32_32x32x16_bf16 v[72:87], v[116:119], v[100:103], v[72:87]
    s_waitcnt vmcnt(6)
    s_barrier
    s_add_u32 m0, s27, 98304
    s_add_u32 s26, s24, 0
    buffer_load_dwordx4 v10, s[4:7], s26 offen lds
    s_add_u32 m0, s27, 106496
    s_add_u32 s26, s24, 65536
    buffer_load_dwordx4 v10, s[4:7], s26 offen lds
    s_add_u32 m0, s27, 114688
    s_add_u32 s26, s24, 131072
    buffer_load_dwordx4 v10, s[4:7], s26 offen lds
    s_add_u32 m0, s27, 122880
    s_add_u32 s26, s24, 196608
    buffer_load_dwordx4 v10, s[4:7], s26 offen lds
    s_add_u32 m0, s27, 131072
    s_add_u32 s26, s25, 0
    buffer_load_dwordx4 v11, s[8:11], s26 offen lds
    s_add_u32 m0, s27, 139264
    s_add_u32 s26, s25, 262144
    buffer_load_dwordx4 v11, s[8:11], s26 offen lds
    s_add_u32 s24, s24, 128
    s_add_u32 s25, s25, 524288
    ds_read_b128 v[88:91], v120 offset:0
    ds_read_b128 v[92:95], v120 offset:4096
    ds_read_b64_tr_b16 v[104:105], v132 offset:32768
    ds_read_b64_tr_b16 v[106:107], v132 offset:33792
    ds_read_b64_tr_b16 v[108:109], v133 offset:32768
    ds_read_b64_tr_b16 v[110:111], v133 offset:33792
    ds_read_b128 v[96:99], v121 offset:0
    ds_read_b128 v[100:103], v121 offset:4096
    ds_read_b64_tr_b16 v[112:113], v132 offset:36864
    ds_read_b64_tr_b16 v[114:115], v132 offset:37888
    ds_read_b64_tr_b16 v[116:117], v133 offset:36864
    ds_read_b64_tr_b16 v[118:119], v133 offset:37888
    s_waitcnt lgkmcnt(6)
    v_mfma_f32_32x32x16_bf16 v[24:39], v[104:107], v[88:91], v[24:39]
    v_mfma_f32_32x32x16_bf16 v[40:55], v[104:107], v[92:95], v[40:55]
    v_mfma_f32_32x32x16_bf16 v[56:71], v[108:111], v[88:91], v[56:71]
    v_mfma_f32_32x32x16_bf16 v[72:87], v[108:111], v[92:95], v[72:87]
    ds_read_b128 v[88:91], v122 offset:0
    ds_read_b128 v[92:95], v122 offset:4096
    ds_read_b64_tr_b16 v[104:105], v132 offset:40960
    ds_read_b64_tr_b16 v[106:107], v132 offset:41984
    ds_read_b64_tr_b16 v[108:109], v133 offset:40960
    ds_read_b64_tr_b16 v[110:111], v133 offset:41984
    s_waitcnt lgkmcnt(6)
    v_mfma_f32_32x32x16_bf16 v[24:39], v[112:115], v[96:99], v[24:39]
    v_mfma_f32_32x32x16_bf16 v[40:55], v[112:115], v[100:103], v[40:55]
    v_mfma_f32_32x32x16_bf16 v[56:71], v[116:119], v[96:99], v[56:71]
    v_mfma_f32_32x32x16_bf16 v[72:87], v[116:119], v[100:103], v[72:87]
    ds_read_b128 v[96:99], v123 offset:0
    ds_read_b128 v[100:103], v123 offset:4096
    ds_read_b64_tr_b16 v[112:113], v132 offset:45056
    ds_read_b64_tr_b16 v[114:115], v132 offset:46080
    ds_read_b64_tr_b16 v[116:117], v133 offset:45056
    ds_read_b64_tr_b16 v[118:119], v133 offset:46080
    s_waitcnt lgkmcnt(6)
    v_mfma_f32_32x32x16_bf16 v[24:39], v[104:107], v[88:91], v[24:39]
    v_mfma_f32_32x32x16_bf16 v[40:55], v[104:107], v[92:95], v[40:55]
    v_mfma_f32_32x32x16_bf16 v[56:71], v[108:111], v[88:91], v[56:71]
    v_mfma_f32_32x32x16_bf16 v[72:87], v[108:111], v[92:95], v[72:87]
    s_waitcnt lgkmcnt(0)
    v_mfma_f32_32x32x16_bf16 v[24:39], v[112:115], v[96:99], v[24:39]
    v_mfma_f32_32x32x16_bf16 v[40:55], v[112:115], v[100:103], v[40:55]
    v_mfma_f32_32x32x16_bf16 v[56:71], v[116:119], v[96:99], v[56:71]
    v_mfma_f32_32x32x16_bf16 v[72:87], v[116:119], v[100:103], v[72:87]
    s_waitcnt vmcnt(6)
    s_barrier
    s_add_u32 m0, s27, 0
    s_add_u32 s26, s24, 0
    buffer_load_dwordx4 v10, s[4:7], s26 offen lds
    s_add_u32 m0, s27, 8192
    s_add_u32 s26, s24, 65536
    buffer_load_dwordx4 v10, s[4:7], s26 offen lds
    s_add_u32 m0, s27, 16384
    s_add_u32 s26, s24, 131072
    buffer_load_dwordx4 v10, s[4:7], s26 offen lds
    s_add_u32 m0, s27, 24576
    s_add_u32 s26, s24, 196608
    buffer_load_dwordx4 v10, s[4:7], s26 offen lds
    s_add_u32 m0, s27, 32768
    s_add_u32 s26, s25, 0
    buffer_load_dwordx4 v11, s[8:11], s26 offen lds
    s_add_u32 m0, s27, 40960
    s_add_u32 s26, s25, 262144
    buffer_load_dwordx4 v11, s[8:11], s26 offen lds
    s_add_u32 s24, s24, 128
    s_add_u32 s25, s25, 524288
    ds_read_b128 v[88:91], v120 offset:49152
    ds_read_b128 v[92:95], v120 offset:53248
    ds_read_b64_tr_b16 v[104:105], v134 offset:16384
    ds_read_b64_tr_b16 v[106:107], v134 offset:17408
    ds_read_b64_tr_b16 v[108:109], v135 offset:16384
    ds_read_b64_tr_b16 v[110:111], v135 offset:17408
    ds_read_b128 v[96:99], v121 offset:49152
    ds_read_b128 v[100:103], v121 offset:53248
    ds_read_b64_tr_b16 v[112:113], v134 offset:20480
    ds_read_b64_tr_b16 v[114:115], v134 offset:21504
    ds_read_b64_tr_b16 v[116:117], v135 offset:20480
    ds_read_b64_tr_b16 v[118:119], v135 offset:21504
    s_waitcnt lgkmcnt(6)
    v_mfma_f32_32x32x16_bf16 v[24:39], v[104:107], v[88:91], v[24:39]
    v_mfma_f32_32x32x16_bf16 v[40:55], v[104:107], v[92:95], v[40:55]
    v_mfma_f32_32x32x16_bf16 v[56:71], v[108:111], v[88:91], v[56:71]
    v_mfma_f32_32x32x16_bf16 v[72:87], v[108:111], v[92:95], v[72:87]
    ds_read_b128 v[88:91], v122 offset:49152
    ds_read_b128 v[92:95], v122 offset:53248
    ds_read_b64_tr_b16 v[104:105], v134 offset:24576
    ds_read_b64_tr_b16 v[106:107], v134 offset:25600
    ds_read_b64_tr_b16 v[108:109], v135 offset:24576
    ds_read_b64_tr_b16 v[110:111], v135 offset:25600
    s_waitcnt lgkmcnt(6)
    v_mfma_f32_32x32x16_bf16 v[24:39], v[112:115], v[96:99], v[24:39]
    v_mfma_f32_32x32x16_bf16 v[40:55], v[112:115], v[100:103], v[40:55]
    v_mfma_f32_32x32x16_bf16 v[56:71], v[116:119], v[96:99], v[56:71]
    v_mfma_f32_32x32x16_bf16 v[72:87], v[116:119], v[100:103], v[72:87]
    ds_read_b128 v[96:99], v123 offset:49152
    ds_read_b128 v[100:103], v123 offset:53248
    ds_read_b64_tr_b16 v[112:113], v134 offset:28672
    ds_read_b64_tr_b16 v[114:115], v134 offset:29696
    ds_read_b64_tr_b16 v[116:117], v135 offset:28672
    ds_read_b64_tr_b16 v[118:119], v135 offset:29696
    s_waitcnt lgkmcnt(6)
    v_mfma_f32_32x32x16_bf16 v[24:39], v[104:107], v[88:91], v[24:39]
    v_mfma_f32_32x32x16_bf16 v[40:55], v[104:107], v[92:95], v[40:55]
    v_mfma_f32_32x32x16_bf16 v[56:71], v[108:111], v[88:91], v[56:71]
    v_mfma_f32_32x32x16_bf16 v[72:87], v[108:111], v[92:95], v[72:87]
    s_waitcnt lgkmcnt(0)
    v_mfma_f32_32x32x16_bf16 v[24:39], v[112:115], v[96:99], v[24:39]
    v_mfma_f32_32x32x16_bf16 v[40:55], v[112:115], v[100:103], v[40:55]
    v_mfma_f32_32x32x16_bf16 v[56:71], v[116:119], v[96:99], v[56:71]
    v_mfma_f32_32x32x16_bf16 v[72:87], v[116:119], v[100:103], v[72:87]
    s_waitcnt vmcnt(6)
    s_barrier
    s_add_u32 m0, s27, 49152
    s_add_u32 s26, s24, 0
    buffer_load_dwordx4 v10, s[4:7], s26 offen lds
    s_add_u32 m0, s27, 57344
    s_add_u32 s26, s24, 65536
    buffer_load_dwordx4 v10, s[4:7], s26 offen lds
    s_add_u32 m0, s27, 65536
    s_add_u32 s26, s24, 131072
    buffer_load_dwordx4 v10, s[4:7], s26 offen lds
    s_add_u32 m0, s27, 73728
    s_add_u32 s26, s24, 196608
    buffer_load_dwordx4 v10, s[4:7], s26 offen lds
    s_add_u32 m0, s27, 81920
    s_add_u32 s26, s25, 0
    buffer_load_dwordx4 v11, s[8:11], s26 offen lds
    s_add_u32 m0, s27, 90112
    s_add_u32 s26, s25, 262144
    buffer_load_dwordx4 v11, s[8:11], s26 offen lds
    s_add_u32 s24, s24, 128
    s_add_u32 s25, s25, 524288
    ds_read_b128 v[88:91], v124 offset:32768
    ds_read_b128 v[92:95], v124 offset:36864
    ds_read_b64_tr_b16 v[104:105], v136 offset:0
    ds_read_b64_tr_b16 v[106:107], v136 offset:1024
    ds_read_b64_tr_b16 v[108:109], v137 offset:0
    ds_read_b64_tr_b16 v[110:111], v137 offset:1024
    ds_read_b128 v[96:99], v125 offset:32768
    ds_read_b128 v[100:103], v125 offset:36864
    ds_read_b64_tr_b16 v[112:113], v136 offset:4096
    ds_read_b64_tr_b16 v[114:115], v136 offset:5120
    ds_read_b64_tr_b16 v[116:117], v137 offset:4096
    ds_read_b64_tr_b16 v[118:119], v137 offset:5120
    s_waitcnt lgkmcnt(6)
    v_mfma_f32_32x32x16_bf16 v[24:39], v[104:107], v[88:91], v[24:39]
    v_mfma_f32_32x32x16_bf16 v[40:55], v[104:107], v[92:95], v[40:55]
    v_mfma_f32_32x32x16_bf16 v[56:71], v[108:111], v[88:91], v[56:71]
    v_mfma_f32_32x32x16_bf16 v[72:87], v[108:111], v[92:95], v[72:87]
    ds_read_b128 v[88:91], v126 offset:32768
    ds_read_b128 v[92:95], v126 offset:36864
    ds_read_b64_tr_b16 v[104:105], v136 offset:8192
    ds_read_b64_tr_b16 v[106:107], v136 offset:9216
    ds_read_b64_tr_b16 v[108:109], v137 offset:8192
    ds_read_b64_tr_b16 v[110:111], v137 offset:9216
    s_waitcnt lgkmcnt(6)
    v_mfma_f32_32x32x16_bf16 v[24:39], v[112:115], v[96:99], v[24:39]
    v_mfma_f32_32x32x16_bf16 v[40:55], v[112:115], v[100:103], v[40:55]
    v_mfma_f32_32x32x16_bf16 v[56:71], v[116:119], v[96:99], v[56:71]
    v_mfma_f32_32x32x16_bf16 v[72:87], v[116:119], v[100:103], v[72:87]
    ds_read_b128 v[96:99], v127 offset:32768
    ds_read_b128 v[100:103], v127 offset:36864
    ds_read_b64_tr_b16 v[112:113], v136 offset:12288
    ds_read_b64_tr_b16 v[114:115], v136 offset:13312
    ds_read_b64_tr_b16 v[116:117], v137 offset:12288
    ds_read_b64_tr_b16 v[118:119], v137 offset:13312
    s_waitcnt lgkmcnt(6)
    v_mfma_f32_32x32x16_bf16 v[24:39], v[104:107], v[88:91], v[24:39]
    v_mfma_f32_32x32x16_bf16 v[40:55], v[104:107], v[92:95], v[40:55]
    v_mfma_f32_32x32x16_bf16 v[56:71], v[108:111], v[88:91], v[56:71]
    v_mfma_f32_32x32x16_bf16 v[72:87], v[108:111], v[92:95], v[72:87]
    s_waitcnt lgkmcnt(0)
    v_mfma_f32_32x32x16_bf16 v[24:39], v[112:115], v[96:99], v[24:39]
    v_mfma_f32_32x32x16_bf16 v[40:55], v[112:115], v[100:103], v[40:55]
    v_mfma_f32_32x32x16_bf16 v[56:71], v[116:119], v[96:99], v[56:71]
    v_mfma_f32_32x32x16_bf16 v[72:87], v[116:119], v[100:103], v[72:87]
    s_waitcnt vmcnt(6)
    s_barrier
    ds_read_b128 v[88:91], v120 offset:0
    ds_read_b128 v[92:95], v120 offset:4096
    ds_read_b64_tr_b16 v[104:105], v132 offset:32768
    ds_read_b64_tr_b16 v[106:107], v132 offset:33792
    ds_read_b64_tr_b16 v[108:109], v133 offset:32768
    ds_read_b64_tr_b16 v[110:111], v133 offset:33792
    ds_read_b128 v[96:99], v121 offset:0
    ds_read_b128 v[100:103], v121 offset:4096
    ds_read_b64_tr_b16 v[112:113], v132 offset:36864
    ds_read_b64_tr_b16 v[114:115], v132 offset:37888
    ds_read_b64_tr_b16 v[116:117], v133 offset:36864
    ds_read_b64_tr_b16 v[118:119], v133 offset:37888
    s_waitcnt lgkmcnt(6)
    v_mfma_f32_32x32x16_bf16 v[24:39], v[104:107], v[88:91], v[24:39]
    v_mfma_f32_32x32x16_bf16 v[40:55], v[104:107], v[92:95], v[40:55]
    v_mfma_f32_32x32x16_bf16 v[56:71], v[108:111], v[88:91], v[56:71]
    v_mfma_f32_32x32x16_bf16 v[72:87], v[108:111], v[92:95], v[72:87]
    ds_read_b128 v[88:91], v122 offset:0
    ds_read_b128 v[92:95], v122 offset:4096
    ds_read_b64_tr_b16 v[104:105], v132 offset:40960
    ds_read_b64_tr_b16 v[106:107], v132 offset:41984
    ds_read_b64_tr_b16 v[108:109], v133 offset:40960
    ds_read_b64_tr_b16 v[110:111], v133 offset:41984
    s_waitcnt lgkmcnt(6)
    v_mfma_f32_32x32x16_bf16 v[24:39], v[112:115], v[96:99], v[24:39]
    v_mfma_f32_32x32x16_bf16 v[40:55], v[112:115], v[100:103], v[40:55]
    v_mfma_f32_32x32x16_bf16 v[56:71], v[116:119], v[96:99], v[56:71]
    v_mfma_f32_32x32x16_bf16 v[72:87], v[116:119], v[100:103], v[72:87]
    ds_read_b128 v[96:99], v123 offset:0
    ds_read_b128 v[100:103], v123 offset:4096
    ds_read_b64_tr_b16 v[112:113], v132 offset:45056
    ds_read_b64_tr_b16 v[114:115], v132 offset:46080
    ds_read_b64_tr_b16 v[116:117], v133 offset:45056
    ds_read_b64_tr_b16 v[118:119], v133 offset:46080
    s_waitcnt lgkmcnt(6)
    v_mfma_f32_32x32x16_bf16 v[24:39], v[104:107], v[88:91], v[24:39]
    v_mfma_f32_32x32x16_bf16 v[40:55], v[104:107], v[92:95], v[40:55]
    v_mfma_f32_32x32x16_bf16 v[56:71], v[108:111], v[88:91], v[56:71]
    v_mfma_f32_32x32x16_bf16 v[72:87], v[108:111], v[92:95], v[72:87]
    s_waitcnt lgkmcnt(0)
    v_mfma_f32_32x32x16_bf16 v[24:39], v[112:115], v[96:99], v[24:39]
    v_mfma_f32_32x32x16_bf16 v[40:55], v[112:115], v[100:103], v[40:55]
    v_mfma_f32_32x32x16_bf16 v[56:71], v[116:119], v[96:99], v[56:71]
    v_mfma_f32_32x32x16_bf16 v[72:87], v[116:119], v[100:103], v[72:87]
    s_waitcnt vmcnt(0)
    s_barrier
    ds_read_b128 v[88:91], v120 offset:49152
    ds_read_b128 v[92:95], v120 offset:53248
    ds_read_b64_tr_b16 v[104:105], v134 offset:16384
    ds_read_b64_tr_b16 v[106:107], v134 offset:17408
    ds_read_b64_tr_b16 v[108:109], v135 offset:16384
    ds_read_b64_tr_b16 v[110:111], v135 offset:17408
    ds_read_b128 v[96:99], v121 offset:49152
    ds_read_b128 v[100:103], v121 offset:53248
    ds_read_b64_tr_b16 v[112:113], v134 offset:20480
    ds_read_b64_tr_b16 v[114:115], v134 offset:21504
    ds_read_b64_tr_b16 v[116:117], v135 offset:20480
    ds_read_b64_tr_b16 v[118:119], v135 offset:21504
    s_waitcnt lgkmcnt(6)
    v_mfma_f32_32x32x16_bf16 v[24:39], v[104:107], v[88:91], v[24:39]
    v_mfma_f32_32x32x16_bf16 v[40:55], v[104:107], v[92:95], v[40:55]
    v_mfma_f32_32x32x16_bf16 v[56:71], v[108:111], v[88:91], v[56:71]
    v_mfma_f32_32x32x16_bf16 v[72:87], v[108:111], v[92:95], v[72:87]
    ds_read_b128 v[88:91], v122 offset:49152
    ds_read_b128 v[92:95], v122 offset:53248
    ds_read_b64_tr_b16 v[104:105], v134 offset:24576
    ds_read_b64_tr_b16 v[106:107], v134 offset:25600
    ds_read_b64_tr_b16 v[108:109], v135 offset:24576
    ds_read_b64_tr_b16 v[110:111], v135 offset:25600
    s_waitcnt lgkmcnt(6)
    v_mfma_f32_32x32x16_bf16 v[24:39], v[112:115], v[96:99], v[24:39]
    v_mfma_f32_32x32x16_bf16 v[40:55], v[112:115], v[100:103], v[40:55]
    v_mfma_f32_32x32x16_bf16 v[56:71], v[116:119], v[96:99], v[56:71]
    v_mfma_f32_32x32x16_bf16 v[72:87], v[116:119], v[100:103], v[72:87]
    ds_read_b128 v[96:99], v123 offset:49152
    ds_read_b128 v[100:103], v123 offset:53248
    ds_read_b64_tr_b16 v[112:113], v134 offset:28672
    ds_read_b64_tr_b16 v[114:115], v134 offset:29696
    ds_read_b64_tr_b16 v[116:117], v135 offset:28672
    ds_read_b64_tr_b16 v[118:119], v135 offset:29696
    s_waitcnt lgkmcnt(6)
    v_mfma_f32_32x32x16_bf16 v[24:39], v[104:107], v[88:91], v[24:39]
    v_mfma_f32_32x32x16_bf16 v[40:55], v[104:107], v[92:95], v[40:55]
    v_mfma_f32_32x32x16_bf16 v[56:71], v[108:111], v[88:91], v[56:71]
    v_mfma_f32_32x32x16_bf16 v[72:87], v[108:111], v[92:95], v[72:87]
    s_waitcnt lgkmcnt(0)
    v_mfma_f32_32x32x16_bf16 v[24:39], v[112:115], v[96:99], v[24:39]
    v_mfma_f32_32x32x16_bf16 v[40:55], v[112:115], v[100:103], v[40:55]
    v_mfma_f32_32x32x16_bf16 v[56:71], v[116:119], v[96:99], v[56:71]
    v_mfma_f32_32x32x16_bf16 v[72:87], v[116:119], v[100:103], v[72:87]
    v_and_b32 v12, 31, v1
    s_mul_i32 s23, s21, 64
    s_add_u32 s23, s23, s19
    v_add_u32 v12, s23, v12
    v_lshrrev_b32 v13, 5, v1
    v_lshlrev_b32 v13, 2, v13
    s_mul_i32 s23, s22, 64
    s_add_u32 s23, s23, s20
    v_add_u32 v13, s23, v13
    s_load_dwordx2 s[12:13], s[0:1], 112
    s_waitcnt lgkmcnt(0)
    s_add_u32 s12, s12, 0x400000
    s_addc_u32 s13, s13, 0
    s_and_b32 s13, s13, 0xffff
    s_mov_b32 s14, 0x1000000
    s_mov_b32 s15, 0x00020000
    v_mul_u32_u24 v14, 8192, v12
    v_lshlrev_b32 v15, 1, v13
    v_add_u32 v14, v14, v15
    v_lshrrev_b32 v15, 5, v1
    v_lshlrev_b32 v15, 3, v15
    v_add_u32 v14, v14, v15
    s_mov_b32 s23, 0
    v_cvt_pk_bf16_f32 v138, v24, v25
    v_cvt_pk_bf16_f32 v139, v26, v27
    v_cvt_pk_bf16_f32 v140, v28, v29
    v_cvt_pk_bf16_f32 v141, v30, v31
    s_nop 0
    v_permlane32_swap_b32 v138, v140
    v_permlane32_swap_b32 v139, v141
    buffer_store_dwordx4 v[138:141], v14, s[12:15], s23 offen offset:0
    v_cvt_pk_bf16_f32 v142, v32, v33
    v_cvt_pk_bf16_f32 v143, v34, v35
    v_cvt_pk_bf16_f32 v144, v36, v37
    v_cvt_pk_bf16_f32 v145, v38, v39
    s_nop 0
    v_permlane32_swap_b32 v142, v144
    v_permlane32_swap_b32 v143, v145
    buffer_store_dwordx4 v[142:145], v14, s[12:15], s23 offen offset:32
    v_cvt_pk_bf16_f32 v146, v56, v57
    v_cvt_pk_bf16_f32 v147, v58, v59
    v_cvt_pk_bf16_f32 v148, v60, v61
    v_cvt_pk_bf16_f32 v149, v62, v63
    s_nop 0
    v_permlane32_swap_b32 v146, v148
    v_permlane32_swap_b32 v147, v149
    buffer_store_dwordx4 v[146:149], v14, s[12:15], s23 offen offset:64
    v_cvt_pk_bf16_f32 v138, v64, v65
    v_cvt_pk_bf16_f32 v139, v66, v67
    v_cvt_pk_bf16_f32 v140, v68, v69
    v_cvt_pk_bf16_f32 v141, v70, v71
    s_nop 0
    v_permlane32_swap_b32 v138, v140
    v_permlane32_swap_b32 v139, v141
    buffer_store_dwordx4 v[138:141], v14, s[12:15], s23 offen offset:96
    s_nop 1
    s_mov_b32 s23, 262144
    v_cvt_pk_bf16_f32 v142, v40, v41
    v_cvt_pk_bf16_f32 v143, v42, v43
    v_cvt_pk_bf16_f32 v144, v44, v45
    v_cvt_pk_bf16_f32 v145, v46, v47
    s_nop 0
    v_permlane32_swap_b32 v142, v144
    v_permlane32_swap_b32 v143, v145
    buffer_store_dwordx4 v[142:145], v14, s[12:15], s23 offen offset:0
    v_cvt_pk_bf16_f32 v146, v48, v49
    v_cvt_pk_bf16_f32 v147, v50, v51
    v_cvt_pk_bf16_f32 v148, v52, v53
    v_cvt_pk_bf16_f32 v149, v54, v55
    s_nop 0
    v_permlane32_swap_b32 v146, v148
    v_permlane32_swap_b32 v147, v149
    buffer_store_dwordx4 v[146:149], v14, s[12:15], s23 offen offset:32
    v_cvt_pk_bf16_f32 v138, v72, v73
    v_cvt_pk_bf16_f32 v139, v74, v75
    v_cvt_pk_bf16_f32 v140, v76, v77
    v_cvt_pk_bf16_f32 v141, v78, v79
    s_nop 0
    v_permlane32_swap_b32 v138, v140
    v_permlane32_swap_b32 v139, v141
    buffer_store_dwordx4 v[138:141], v14, s[12:15], s23 offen offset:64
    v_cvt_pk_bf16_f32 v142, v80, v81
    v_cvt_pk_bf16_f32 v143, v82, v83
    v_cvt_pk_bf16_f32 v144, v84, v85
    v_cvt_pk_bf16_f32 v145, v86, v87
    s_nop 0
    v_permlane32_swap_b32 v142, v144
    v_permlane32_swap_b32 v143, v145
    buffer_store_dwordx4 v[142:145], v14, s[12:15], s23 offen offset:96
    s_nop 3
.Lend_gemmq_kernel:
    s_endpgm
.globl attn_kernel
.p2align 8
.type attn_kernel,@function
attn_kernel:
    s_cmp_ge_u32 s2, 256
    s_cbranch_scc1 .Lend_attn_kernel
    s_load_dwordx2 s[4:5], s[0:1], 8
    s_load_dwordx2 s[8:9], s[0:1], 16
    s_load_dwordx2 s[12:13], s[0:1], 112
    v_and_b32 v1, 63, v0
    v_lshrrev_b32 v2, 6, v0
    s_nop 0
    v_readfirstlane_b32 s3, v2
    s_and_b32 s16, s2, 7
    s_lshr_b32 s17, s2, 3
    s_and_b32 s18, s17, 7
    s_lshr_b32 s17, s17, 3
    s_lshl_b32 s17, s17, 3
    s_add_u32 s17, s17, s16
    s_waitcnt lgkmcnt(0)
    s_and_b32 s5, s5, 0xffff
    s_mov_b32 s6, 0x1000000
    s_mov_b32 s7, 0x00020000
    s_and_b32 s9, s9, 0xffff
    s_mov_b32 s10, 0x1000000
    s_mov_b32 s11, 0x00020000
    s_add_u32 s12, s12, 0x400000
    s_addc_u32 s13, s13, 0
    s_and_b32 s13, s13, 0xffff
    s_mov_b32 s14, 0x1000000
    s_mov_b32 s15, 0x00020000
    s_lshl_b32 s19, s18, 8
    s_lshl_b32 s20, s3, 5
    s_add_u32 s19, s19, s20
    v_and_b32 v2, 31, v1
    v_add_u32 v2, s19, v2
    v_lshlrev_b32 v2, 13, v2
    v_lshrrev_b32 v3, 5, v1
    v_lshlrev_b32 v3, 4, v3
    v_add_u32 v2, v2, v3
    s_lshl_b32 s20, s17, 8
    buffer_load_dwordx4 v[32:35], v2, s[12:15], s20 offen offset:0
    buffer_load_dwordx4 v[36:39], v2, s[12:15], s20 offen offset:32
    buffer_load_dwordx4 v[40:43], v2, s[12:15], s20 offen offset:64
    buffer_load_dwordx4 v[44:47], v2, s[12:15], s20 offen offset:96
    buffer_load_dwordx4 v[48:51], v2, s[12:15], s20 offen offset:128
    buffer_load_dwordx4 v[52:55], v2, s[12:15], s20 offen offset:160
    buffer_load_dwordx4 v[56:59], v2, s[12:15], s20 offen offset:192
    buffer_load_dwordx4 v[60:63], v2, s[12:15], s20 offen offset:224
    v_lshrrev_b32 v2, 4, v1
    v_lshlrev_b32 v3, 8, v2
    s_and_b32 s21, s3, 3
    s_lshl_b32 s21, s21, 2
    v_add_u32 v22, s21, v2
    v_and_b32 v23, 15, v1
    v_xor_b32 v22, v22, v23
    v_lshlrev_b32 v22, 4, v22
    v_add_u32 v16, v3, v22
    v_lshlrev_b32 v22, 2, v2
    v_xor_b32 v22, v22, v23
    v_lshlrev_b32 v22, 4, v22
    v_add_u32 v17, v3, v22
    v_and_b32 v2, 31, v1
    v_lshlrev_b32 v2, 8, v2
    v_lshrrev_b32 v3, 5, v1
    v_add_u32 v22, 0, v3
    v_xor_b32 v22, v22, v23
    v_lshlrev_b32 v22, 4, v22
    v_add_u32 v4, v2, v22
    v_add_u32 v22, 2, v3
    v_xor_b32 v22, v22, v23
    v_lshlrev_b32 v22, 4, v22
    v_add_u32 v5, v2, v22
    v_add_u32 v22, 4, v3
    v_xor_b32 v22, v22, v23
    v_lshlrev_b32 v22, 4, v22
    v_add_u32 v6, v2, v22
    v_add_u32 v22, 6, v3
    v_xor_b32 v22, v22, v23
    v_lshlrev_b32 v22, 4, v22
    v_add_u32 v7, v2, v22
    v_add_u32 v22, 8, v3
    v_xor_b32 v22, v22, v23
    v_lshlrev_b32 v22, 4, v22
    v_add_u32 v8, v2, v22
    v_add_u32 v22, 10, v3
    v_xor_b32 v22, v22, v23
    v_lshlrev_b32 v22, 4, v22
    v_add_u32 v9, v2, v22
    v_add_u32 v22, 12, v3
    v_xor_b32 v22, v22, v23
    v_lshlrev_b32 v22, 4, v22
    v_add_u32 v10, v2, v22
    v_add_u32 v22, 14, v3
    v_xor_b32 v22, v22, v23
    v_lshlrev_b32 v22, 4, v22
    v_add_u32 v11, v2, v22
    v_lshrrev_b32 v2, 2, v1
    v_and_b32 v2, 3, v2
    v_lshrrev_b32 v3, 5, v1
    v_lshlrev_b32 v3, 2, v3
    v_add_u32 v3, v3, v2
    v_lshlrev_b32 v3, 8, v3
    v_and_b32 v22, 1, v1
    v_lshlrev_b32 v22, 3, v22
    v_add_u32 v3, v3, v22
    v_add_u32 v3, 32768, v3
    v_lshrrev_b32 v22, 4, v1
    v_and_b32 v22, 1, v22
    v_lshlrev_b32 v22, 1, v22
    v_lshrrev_b32 v23, 1, v1
    v_and_b32 v23, 1, v23
    v_add_u32 v22, v22, v23
    v_lshlrev_b32 v2, 2, v2
    v_add_u32 v23, 0, v22
    v_xor_b32 v23, v23, v2
    v_lshlrev_b32 v23, 4, v23
    v_add_u32 v12, v3, v23
    v_add_u32 v23, 4, v22
    v_xor_b32 v23, v23, v2
    v_lshlrev_b32 v23, 4, v23
    v_add_u32 v13, v3, v23
    v_add_u32 v23, 8, v22
    v_xor_b32 v23, v23, v2
    v_lshlrev_b32 v23, 4, v23
    v_add_u32 v14, v3, v23
    v_add_u32 v23, 12, v22
    v_xor_b32 v23, v23, v2
    v_lshlrev_b32 v23, 4, v23
    v_add_u32 v15, v3, v23
    v_mov_b32 v128, 0
    v_mov_b32 v129, 0
    v_mov_b32 v130, 0
    v_mov_b32 v131, 0
    v_mov_b32 v132, 0
    v_mov_b32 v133, 0
    v_mov_b32 v134, 0
    v_mov_b32 v135, 0
    v_mov_b32 v136, 0
    v_mov_b32 v137, 0
    v_mov_b32 v138, 0
    v_mov_b32 v139, 0
    v_mov_b32 v140, 0
    v_mov_b32 v141, 0
    v_mov_b32 v142, 0
    v_mov_b32 v143, 0
    v_mov_b32 v144, 0
    v_mov_b32 v145, 0
    v_mov_b32 v146, 0
    v_mov_b32 v147, 0
    v_mov_b32 v148, 0
    v_mov_b32 v149, 0
    v_mov_b32 v150, 0
    v_mov_b32 v151, 0
    v_mov_b32 v152, 0
    v_mov_b32 v153, 0
    v_mov_b32 v154, 0
    v_mov_b32 v155, 0
    v_mov_b32 v156, 0
    v_mov_b32 v157, 0
    v_mov_b32 v158, 0
    v_mov_b32 v159, 0
    v_mov_b32 v160, 0
    v_mov_b32 v161, 0
    v_mov_b32 v162, 0
    v_mov_b32 v163, 0
    v_mov_b32 v164, 0
    v_mov_b32 v165, 0
    v_mov_b32 v166, 0
    v_mov_b32 v167, 0
    v_mov_b32 v168, 0
    v_mov_b32 v169, 0
    v_mov_b32 v170, 0
    v_mov_b32 v171, 0
    v_mov_b32 v172, 0
    v_mov_b32 v173, 0
    v_mov_b32 v174, 0
    v_mov_b32 v175, 0
    v_mov_b32 v176, 0
    v_mov_b32 v177, 0
    v_mov_b32 v178, 0
    v_mov_b32 v179, 0
    v_mov_b32 v180, 0
    v_mov_b32 v181, 0
    v_mov_b32 v182, 0
    v_mov_b32 v183, 0
    v_mov_b32 v184, 0
    v_mov_b32 v185, 0
    v_mov_b32 v186, 0
    v_mov_b32 v187, 0
    v_mov_b32 v188, 0
    v_mov_b32 v189, 0
    v_mov_b32 v190, 0
    v_mov_b32 v191, 0
    v_mov_b32 v18, 0xf149f2ca
    v_mov_b32 v19, 0
    s_mul_i32 s22, s17, 524288
    s_lshl_b32 s23, s3, 10
    s_add_u32 s22, s22, s23
    s_add_u32 m0, s23, 0
    s_add_u32 s24, s22, 0
    buffer_load_dwordx4 v16, s[4:7], s24 offen lds
    s_add_u32 m0, s23, 8192
    s_add_u32 s24, s22, 8192
    buffer_load_dwordx4 v16, s[4:7], s24 offen lds
    s_add_u32 m0, s23, 16384
    s_add_u32 s24, s22, 16384
    buffer_load_dwordx4 v16, s[4:7], s24 offen lds
    s_add_u32 m0, s23, 24576
    s_add_u32 s24, s22, 24576
    buffer_load_dwordx4 v16, s[4:7], s24 offen lds
    s_add_u32 m0, s23, 32768
    s_add_u32 s24, s22, 0
    buffer_load_dwordx4 v17, s[8:11], s24 offen lds
    s_add_u32 m0, s23, 40960
    s_add_u32 s24, s22, 8192
    buffer_load_dwordx4 v17, s[8:11], s24 offen lds
    s_add_u32 m0, s23, 49152
    s_add_u32 s24, s22, 16384
    buffer_load_dwordx4 v17, s[8:11], s24 offen lds
    s_add_u32 m0, s23, 57344
    s_add_u32 s24, s22, 24576
    buffer_load_dwordx4 v17, s[8:11], s24 offen lds
    s_add_u32 s22, s22, 32768
    s_cmp_lt_u32 s3, 4
    s_cbranch_scc0 .Lprio_attn
    s_setprio 3
.Lprio_attn:
    s_mov_b32 s25, 0
    s_mov_b32 s26, 0x3e0293ee
.Lloop_attn:
    s_waitcnt vmcnt(0)
    s_barrier
    s_cmp_ge_u32 s25, 15
    s_cbranch_scc1 .Lnodma_attn
    s_bitcmp1_b32 s25, 0
    s_cbranch_scc1 .Ldma0_attn
    s_add_u32 m0, s23, 65536
    s_add_u32 s24, s22, 0
    buffer_load_dwordx4 v16, s[4:7], s24 offen lds
    s_add_u32 m0, s23, 73728
    s_add_u32 s24, s22, 8192
    buffer_load_dwordx4 v16, s[4:7], s24 offen lds
    s_add_u32 m0, s23, 81920
    s_add_u32 s24, s22, 16384
    buffer_load_dwordx4 v16, s[4:7], s24 offen lds
    s_add_u32 m0, s23, 90112
    s_add_u32 s24, s22, 24576
    buffer_load_dwordx4 v16, s[4:7], s24 offen lds
    s_add_u32 m0, s23, 98304
    s_add_u32 s24, s22, 0
    buffer_load_dwordx4 v17, s[8:11], s24 offen lds
    s_add_u32 m0, s23, 106496
    s_add_u32 s24, s22, 8192
    buffer_load_dwordx4 v17, s[8:11], s24 offen lds
    s_add_u32 m0, s23, 114688
    s_add_u32 s24, s22, 16384
    buffer_load_dwordx4 v17, s[8:11], s24 offen lds
    s_add_u32 m0, s23, 122880
    s_add_u32 s24, s22, 24576
    buffer_load_dwordx4 v17, s[8:11], s24 offen lds
    s_add_u32 s22, s22, 32768
    s_nop 0
    s_branch .Lnodma_attn
.Ldma0_attn:
    s_add_u32 m0, s23, 0
    s_add_u32 s24, s22, 0
    buffer_load_dwordx4 v16, s[4:7], s24 offen lds
    s_add_u32 m0, s23, 8192
    s_add_u32 s24, s22, 8192
    buffer_load_dwordx4 v16, s[4:7], s24 offen lds
    s_add_u32 m0, s23, 16384
    s_add_u32 s24, s22, 16384
    buffer_load_dwordx4 v16, s[4:7], s24 offen lds
    s_add_u32 m0, s23, 24576
    s_add_u32 s24, s22, 24576
    buffer_load_dwordx4 v16, s[4:7], s24 offen lds
    s_add_u32 m0, s23, 32768
    s_add_u32 s24, s22, 0
    buffer_load_dwordx4 v17, s[8:11], s24 offen lds
    s_add_u32 m0, s23, 40960
    s_add_u32 s24, s22, 8192
    buffer_load_dwordx4 v17, s[8:11], s24 offen lds
    s_add_u32 m0, s23, 49152
    s_add_u32 s24, s22, 16384
    buffer_load_dwordx4 v17, s[8:11], s24 offen lds
    s_add_u32 m0, s23, 57344
    s_add_u32 s24, s22, 24576
    buffer_load_dwordx4 v17, s[8:11], s24 offen lds
    s_add_u32 s22, s22, 32768
    s_nop 0
.Lnodma_attn:
    ds_read_b128 v[192:195], v4 offset:0
    ds_read_b128 v[196:199], v5 offset:0
    ds_read_b128 v[200:203], v6 offset:0
    ds_read_b128 v[204:207], v7 offset:0
    ds_read_b128 v[208:211], v8 offset:0
    ds_read_b128 v[212:215], v9 offset:0
    ds_read_b128 v[216:219], v10 offset:0
    ds_read_b128 v[220:223], v11 offset:0
    s_waitcnt lgkmcnt(4)
    v_mfma_f32_32x32x16_bf16 v[64:79], v[192:195], v[32:35], 0
    v_mfma_f32_32x32x16_bf16 v[64:79], v[196:199], v[36:39], v[64:79]
    v_mfma_f32_32x32x16_bf16 v[64:79], v[200:203], v[40:43], v[64:79]
    v_mfma_f32_32x32x16_bf16 v[64:79], v[204:207], v[44:47], v[64:79]
    ds_read_b128 v[192:195], v4 offset:8192
    ds_read_b128 v[196:199], v5 offset:8192
    ds_read_b128 v[200:203], v6 offset:8192
    ds_read_b128 v[204:207], v7 offset:8192
    s_waitcnt lgkmcnt(4)
    v_mfma_f32_32x32x16_bf16 v[64:79], v[208:211], v[48:51], v[64:79]
    v_mfma_f32_32x32x16_bf16 v[64:79], v[212:215], v[52:55], v[64:79]
    v_mfma_f32_32x32x16_bf16 v[64:79], v[216:219], v[56:59], v[64:79]
    v_mfma_f32_32x32x16_bf16 v[64:79], v[220:223], v[60:63], v[64:79]
    ds_read_b128 v[208:211], v8 offset:8192
    ds_read_b128 v[212:215], v9 offset:8192
    ds_read_b128 v[216:219], v10 offset:8192
    ds_read_b128 v[220:223], v11 offset:8192
    s_waitcnt lgkmcnt(4)
    v_mfma_f32_32x32x16_bf16 v[80:95], v[192:195], v[32:35], 0
    v_mfma_f32_32x32x16_bf16 v[80:95], v[196:199], v[36:39], v[80:95]
    v_mfma_f32_32x32x16_bf16 v[80:95], v[200:203], v[40:43], v[80:95]
    v_mfma_f32_32x32x16_bf16 v[80:95], v[204:207], v[44:47], v[80:95]
    ds_read_b128 v[192:195], v4 offset:16384
    ds_read_b128 v[196:199], v5 offset:16384
    ds_read_b128 v[200:203], v6 offset:16384
    ds_read_b128 v[204:207], v7 offset:16384
    s_waitcnt lgkmcnt(4)
    v_mfma_f32_32x32x16_bf16 v[80:95], v[208:211], v[48:51], v[80:95]
    v_mfma_f32_32x32x16_bf16 v[80:95], v[212:215], v[52:55], v[80:95]
    v_mfma_f32_32x32x16_bf16 v[80:95], v[216:219], v[56:59], v[80:95]
    v_mfma_f32_32x32x16_bf16 v[80:95], v[220:223], v[60:63], v[80:95]
    ds_read_b128 v[208:211], v8 offset:16384
    ds_read_b128 v[212:215], v9 offset:16384
    ds_read_b128 v[216:219], v10 offset:16384
    ds_read_b128 v[220:223], v11 offset:16384
    s_waitcnt lgkmcnt(4)
    v_mfma_f32_32x32x16_bf16 v[96:111], v[192:195], v[32:35], 0
    v_mfma_f32_32x32x16_bf16 v[96:111], v[196:199], v[36:39], v[96:111]
    v_mfma_f32_32x32x16_bf16 v[96:111], v[200:203], v[40:43], v[96:111]
    v_mfma_f32_32x32x16_bf16 v[96:111], v[204:207], v[44:47], v[96:111]
    ds_read_b128 v[192:195], v4 offset:24576
    ds_read_b128 v[196:199], v5 offset:24576
    ds_read_b128 v[200:203], v6 offset:24576
    ds_read_b128 v[204:207], v7 offset:24576
    s_waitcnt lgkmcnt(4)
    v_mfma_f32_32x32x16_bf16 v[96:111], v[208:211], v[48:51], v[96:111]
    v_mfma_f32_32x32x16_bf16 v[96:111], v[212:215], v[52:55], v[96:111]
    v_mfma_f32_32x32x16_bf16 v[96:111], v[216:219], v[56:59], v[96:111]
    v_mfma_f32_32x32x16_bf16 v[96:111], v[220:223], v[60:63], v[96:111]
    ds_read_b128 v[208:211], v8 offset:24576
    ds_read_b128 v[212:215], v9 offset:24576
    ds_read_b128 v[216:219], v10 offset:24576
    ds_read_b128 v[220:223], v11 offset:24576
    s_waitcnt lgkmcnt(4)
    v_mfma_f32_32x32x16_bf16 v[112:127], v[192:195], v[32:35], 0
    v_mfma_f32_32x32x16_bf16 v[112:127], v[196:199], v[36:39], v[112:127]
    v_mfma_f32_32x32x16_bf16 v[112:127], v[200:203], v[40:43], v[112:127]
    v_mfma_f32_32x32x16_bf16 v[112:127], v[204:207], v[44:47], v[112:127]
    s_waitcnt lgkmcnt(0)
    v_mfma_f32_32x32x16_bf16 v[112:127], v[208:211], v[48:51], v[112:127]
    v_mfma_f32_32x32x16_bf16 v[112:127], v[212:215], v[52:55], v[112:127]
    v_mfma_f32_32x32x16_bf16 v[112:127], v[216:219], v[56:59], v[112:127]
    v_mfma_f32_32x32x16_bf16 v[112:127], v[220:223], v[60:63], v[112:127]
    v_max3_f32 v22, v64, v65, v66
    v_max3_f32 v22, v22, v67, v68
    v_max3_f32 v22, v22, v69, v70
    v_max3_f32 v22, v22, v71, v72
    v_max3_f32 v22, v22, v73, v74
    v_max3_f32 v22, v22, v75, v76
    v_max3_f32 v22, v22, v77, v78
    v_max3_f32 v22, v22, v79, v80
    v_max3_f32 v22, v22, v81, v82
    v_max3_f32 v22, v22, v83, v84
    v_max3_f32 v22, v22, v85, v86
    v_max3_f32 v22, v22, v87, v88
    v_max3_f32 v22, v22, v89, v90
    v_max3_f32 v22, v22, v91, v92
    v_max3_f32 v22, v22, v93, v94
    v_max3_f32 v22, v22, v95, v96
    v_max3_f32 v22, v22, v97, v98
    v_max3_f32 v22, v22, v99, v100
    v_max3_f32 v22, v22, v101, v102
    v_max3_f32 v22, v22, v103, v104
    v_max3_f32 v22, v22, v105, v106
    v_max3_f32 v22, v22, v107, v108
    v_max3_f32 v22, v22, v109, v110
    v_max3_f32 v22, v22, v111, v112
    v_max3_f32 v22, v22, v113, v114
    v_max3_f32 v22, v22, v115, v116
    v_max3_f32 v22, v22, v117, v118
    v_max3_f32 v22, v22, v119, v120
    v_max3_f32 v22, v22, v121, v122
    v_max3_f32 v22, v22, v123, v124
    v_max3_f32 v22, v22, v125, v126
    v_max_f32 v22, v22, v127
    v_mov_b32 v23, v22
    s_nop 1
    v_permlane32_swap_b32 v22, v23
    v_max3_f32 v22, v22, v23, v18
    v_sub_f32 v20, v18, v22
    v_mul_f32 v20, 0x3e0293ee, v20
    v_exp_f32 v20, v20
    v_mov_b32 v18, v22
    v_mul_f32 v21, 0xbe0293ee, v22
    v_mul_f32 v19, v19, v20
    v_fma_f32 v64, v64, s26, v21
    v_exp_f32 v64, v64
    v_fma_f32 v65, v65, s26, v21
    v_exp_f32 v65, v65
    v_fma_f32 v66, v66, s26, v21
    v_exp_f32 v66, v66
    v_fma_f32 v67, v67, s26, v21
    v_exp_f32 v67, v67
    v_fma_f32 v68, v68, s26, v21
    v_exp_f32 v68, v68
    v_fma_f32 v69, v69, s26, v21
    v_exp_f32 v69, v69
    v_fma_f32 v70, v70, s26, v21
    v_exp_f32 v70, v70
    v_fma_f32 v71, v71, s26, v21
    v_exp_f32 v71, v71
    v_fma_f32 v72, v72, s26, v21
    v_exp_f32 v72, v72
    v_fma_f32 v73, v73, s26, v21
    v_exp_f32 v73, v73
    v_fma_f32 v74, v74, s26, v21
    v_exp_f32 v74, v74
    v_fma_f32 v75, v75, s26, v21
    v_exp_f32 v75, v75
    v_fma_f32 v76, v76, s26, v21
    v_exp_f32 v76, v76
    v_fma_f32 v77, v77, s26, v21
    v_exp_f32 v77, v77
    v_fma_f32 v78, v78, s26, v21
    v_exp_f32 v78, v78
    v_fma_f32 v79, v79, s26, v21
    v_exp_f32 v79, v79
    v_fma_f32 v80, v80, s26, v21
    v_exp_f32 v80, v80
    v_fma_f32 v81, v81, s26, v21
    v_exp_f32 v81, v81
    v_fma_f32 v82, v82, s26, v21
    v_exp_f32 v82, v82
    v_fma_f32 v83, v83, s26, v21
    v_exp_f32 v83, v83
    v_fma_f32 v84, v84, s26, v21
    v_exp_f32 v84, v84
    v_fma_f32 v85, v85, s26, v21
    v_exp_f32 v85, v85
    v_fma_f32 v86, v86, s26, v21
    v_exp_f32 v86, v86
    v_fma_f32 v87, v87, s26, v21
    v_exp_f32 v87, v87
    v_fma_f32 v88, v88, s26, v21
    v_exp_f32 v88, v88
    v_fma_f32 v89, v89, s26, v21
    v_exp_f32 v89, v89
    v_fma_f32 v90, v90, s26, v21
    v_exp_f32 v90, v90
    v_fma_f32 v91, v91, s26, v21
    v_exp_f32 v91, v91
    v_fma_f32 v92, v92, s26, v21
    v_exp_f32 v92, v92
    v_fma_f32 v93, v93, s26, v21
    v_exp_f32 v93, v93
    v_fma_f32 v94, v94, s26, v21
    v_exp_f32 v94, v94
    v_fma_f32 v95, v95, s26, v21
    v_exp_f32 v95, v95
    v_fma_f32 v96, v96, s26, v21
    v_exp_f32 v96, v96
    v_fma_f32 v97, v97, s26, v21
    v_exp_f32 v97, v97
    v_fma_f32 v98, v98, s26, v21
    v_exp_f32 v98, v98
    v_fma_f32 v99, v99, s26, v21
    v_exp_f32 v99, v99
    v_fma_f32 v100, v100, s26, v21
    v_exp_f32 v100, v100
    v_fma_f32 v101, v101, s26, v21
    v_exp_f32 v101, v101
    v_fma_f32 v102, v102, s26, v21
    v_exp_f32 v102, v102
    v_fma_f32 v103, v103, s26, v21
    v_exp_f32 v103, v103
    v_fma_f32 v104, v104, s26, v21
    v_exp_f32 v104, v104
    v_fma_f32 v105, v105, s26, v21
    v_exp_f32 v105, v105
    v_fma_f32 v106, v106, s26, v21
    v_exp_f32 v106, v106
    v_fma_f32 v107, v107, s26, v21
    v_exp_f32 v107, v107
    v_fma_f32 v108, v108, s26, v21
    v_exp_f32 v108, v108
    v_fma_f32 v109, v109, s26, v21
    v_exp_f32 v109, v109
    v_fma_f32 v110, v110, s26, v21
    v_exp_f32 v110, v110
    v_fma_f32 v111, v111, s26, v21
    v_exp_f32 v111, v111
    v_fma_f32 v112, v112, s26, v21
    v_exp_f32 v112, v112
    v_fma_f32 v113, v113, s26, v21
    v_exp_f32 v113, v113
    v_fma_f32 v114, v114, s26, v21
    v_exp_f32 v114, v114
    v_fma_f32 v115, v115, s26, v21
    v_exp_f32 v115, v115
    v_fma_f32 v116, v116, s26, v21
    v_exp_f32 v116, v116
    v_fma_f32 v117, v117, s26, v21
    v_exp_f32 v117, v117
    v_fma_f32 v118, v118, s26, v21
    v_exp_f32 v118, v118
    v_fma_f32 v119, v119, s26, v21
    v_exp_f32 v119, v119
    v_fma_f32 v120, v120, s26, v21
    v_exp_f32 v120, v120
    v_fma_f32 v121, v121, s26, v21
    v_exp_f32 v121, v121
    v_fma_f32 v122, v122, s26, v21
    v_exp_f32 v122, v122
    v_fma_f32 v123, v123, s26, v21
    v_exp_f32 v123, v123
    v_fma_f32 v124, v124, s26, v21
    v_exp_f32 v124, v124
    v_fma_f32 v125, v125, s26, v21
    v_exp_f32 v125, v125
    v_fma_f32 v126, v126, s26, v21
    v_exp_f32 v126, v126
    v_fma_f32 v127, v127, s26, v21
    v_exp_f32 v127, v127
    v_add_f32 v19, v19, v64
    v_add_f32 v19, v19, v65
    v_add_f32 v19, v19, v66
    v_add_f32 v19, v19, v67
    v_add_f32 v19, v19, v68
    v_add_f32 v19, v19, v69
    v_add_f32 v19, v19, v70
    v_add_f32 v19, v19, v71
    v_add_f32 v19, v19, v72
    v_add_f32 v19, v19, v73
    v_add_f32 v19, v19, v74
    v_add_f32 v19, v19, v75
    v_add_f32 v19, v19, v76
    v_add_f32 v19, v19, v77
    v_add_f32 v19, v19, v78
    v_add_f32 v19, v19, v79
    v_add_f32 v19, v19, v80
    v_add_f32 v19, v19, v81
    v_add_f32 v19, v19, v82
    v_add_f32 v19, v19, v83
    v_add_f32 v19, v19, v84
    v_add_f32 v19, v19, v85
    v_add_f32 v19, v19, v86
    v_add_f32 v19, v19, v87
    v_add_f32 v19, v19, v88
    v_add_f32 v19, v19, v89
    v_add_f32 v19, v19, v90
    v_add_f32 v19, v19, v91
    v_add_f32 v19, v19, v92
    v_add_f32 v19, v19, v93
    v_add_f32 v19, v19, v94
    v_add_f32 v19, v19, v95
    v_add_f32 v19, v19, v96
    v_add_f32 v19, v19, v97
    v_add_f32 v19, v19, v98
    v_add_f32 v19, v19, v99
    v_add_f32 v19, v19, v100
    v_add_f32 v19, v19, v101
    v_add_f32 v19, v19, v102
    v_add_f32 v19, v19, v103
    v_add_f32 v19, v19, v104
    v_add_f32 v19, v19, v105
    v_add_f32 v19, v19, v106
    v_add_f32 v19, v19, v107
    v_add_f32 v19, v19, v108
    v_add_f32 v19, v19, v109
    v_add_f32 v19, v19, v110
    v_add_f32 v19, v19, v111
    v_add_f32 v19, v19, v112
    v_add_f32 v19, v19, v113
    v_add_f32 v19, v19, v114
    v_add_f32 v19, v19, v115
    v_add_f32 v19, v19, v116
    v_add_f32 v19, v19, v117
    v_add_f32 v19, v19, v118
    v_add_f32 v19, v19, v119
    v_add_f32 v19, v19, v120
    v_add_f32 v19, v19, v121
    v_add_f32 v19, v19, v122
    v_add_f32 v19, v19, v123
    v_add_f32 v19, v19, v124
    v_add_f32 v19, v19, v125
    v_add_f32 v19, v19, v126
    v_add_f32 v19, v19, v127
    v_mul_f32 v128, v128, v20
    v_mul_f32 v129, v129, v20
    v_mul_f32 v130, v130, v20
    v_mul_f32 v131, v131, v20
    v_mul_f32 v132, v132, v20
    v_mul_f32 v133, v133, v20
    v_mul_f32 v134, v134, v20
    v_mul_f32 v135, v135, v20
    v_mul_f32 v136, v136, v20
    v_mul_f32 v137, v137, v20
    v_mul_f32 v138, v138, v20
    v_mul_f32 v139, v139, v20
    v_mul_f32 v140, v140, v20
    v_mul_f32 v141, v141, v20
    v_mul_f32 v142, v142, v20
    v_mul_f32 v143, v143, v20
    v_mul_f32 v144, v144, v20
    v_mul_f32 v145, v145, v20
    v_mul_f32 v146, v146, v20
    v_mul_f32 v147, v147, v20
    v_mul_f32 v148, v148, v20
    v_mul_f32 v149, v149, v20
    v_mul_f32 v150, v150, v20
    v_mul_f32 v151, v151, v20
    v_mul_f32 v152, v152, v20
    v_mul_f32 v153, v153, v20
    v_mul_f32 v154, v154, v20
    v_mul_f32 v155, v155, v20
    v_mul_f32 v156, v156, v20
    v_mul_f32 v157, v157, v20
    v_mul_f32 v158, v158, v20
    v_mul_f32 v159, v159, v20
    v_mul_f32 v160, v160, v20
    v_mul_f32 v161, v161, v20
    v_mul_f32 v162, v162, v20
    v_mul_f32 v163, v163, v20
    v_mul_f32 v164, v164, v20
    v_mul_f32 v165, v165, v20
    v_mul_f32 v166, v166, v20
    v_mul_f32 v167, v167, v20
    v_mul_f32 v168, v168, v20
    v_mul_f32 v169, v169, v20
    v_mul_f32 v170, v170, v20
    v_mul_f32 v171, v171, v20
    v_mul_f32 v172, v172, v20
    v_mul_f32 v173, v173, v20
    v_mul_f32 v174, v174, v20
    v_mul_f32 v175, v175, v20
    v_mul_f32 v176, v176, v20
    v_mul_f32 v177, v177, v20
    v_mul_f32 v178, v178, v20
    v_mul_f32 v179, v179, v20
    v_mul_f32 v180, v180, v20
    v_mul_f32 v181, v181, v20
    v_mul_f32 v182, v182, v20
    v_mul_f32 v183, v183, v20
    v_mul_f32 v184, v184, v20
    v_mul_f32 v185, v185, v20
    v_mul_f32 v186, v186, v20
    v_mul_f32 v187, v187, v20
    v_mul_f32 v188, v188, v20
    v_mul_f32 v189, v189, v20
    v_mul_f32 v190, v190, v20
    v_mul_f32 v191, v191, v20
    v_cvt_pk_bf16_f32 v64, v64, v65
    v_cvt_pk_bf16_f32 v65, v66, v67
    v_cvt_pk_bf16_f32 v66, v68, v69
    v_cvt_pk_bf16_f32 v67, v70, v71
    v_cvt_pk_bf16_f32 v72, v72, v73
    v_cvt_pk_bf16_f32 v73, v74, v75
    v_cvt_pk_bf16_f32 v74, v76, v77
    v_cvt_pk_bf16_f32 v75, v78, v79
    v_cvt_pk_bf16_f32 v80, v80, v81
    v_cvt_pk_bf16_f32 v81, v82, v83
    v_cvt_pk_bf16_f32 v82, v84, v85
    v_cvt_pk_bf16_f32 v83, v86, v87
    v_cvt_pk_bf16_f32 v88, v88, v89
    v_cvt_pk_bf16_f32 v89, v90, v91
    v_cvt_pk_bf16_f32 v90, v92, v93
    v_cvt_pk_bf16_f32 v91, v94, v95
    v_cvt_pk_bf16_f32 v96, v96, v97
    v_cvt_pk_bf16_f32 v97, v98, v99
    v_cvt_pk_bf16_f32 v98, v100, v101
    v_cvt_pk_bf16_f32 v99, v102, v103
    v_cvt_pk_bf16_f32 v104, v104, v105
    v_cvt_pk_bf16_f32 v105, v106, v107
    v_cvt_pk_bf16_f32 v106, v108, v109
    v_cvt_pk_bf16_f32 v107, v110, v111
    v_cvt_pk_bf16_f32 v112, v112, v113
    v_cvt_pk_bf16_f32 v113, v114, v115
    v_cvt_pk_bf16_f32 v114, v116, v117
    v_cvt_pk_bf16_f32 v115, v118, v119
    v_cvt_pk_bf16_f32 v120, v120, v121
    v_cvt_pk_bf16_f32 v121, v122, v123
    v_cvt_pk_bf16_f32 v122, v124, v125
    v_cvt_pk_bf16_f32 v123, v126, v127
    ds_read_b64_tr_b16 v[224:225], v12 offset:0
    ds_read_b64_tr_b16 v[226:227], v12 offset:2048
    ds_read_b64_tr_b16 v[228:229], v12 offset:4096
    ds_read_b64_tr_b16 v[230:231], v12 offset:6144
    ds_read_b64_tr_b16 v[232:233], v12 offset:8192
    ds_read_b64_tr_b16 v[234:235], v12 offset:10240
    ds_read_b64_tr_b16 v[236:237], v12 offset:12288
    ds_read_b64_tr_b16 v[238:239], v12 offset:14336
    ds_read_b64_tr_b16 v[240:241], v12 offset:16384
    ds_read_b64_tr_b16 v[242:243], v12 offset:18432
    ds_read_b64_tr_b16 v[244:245], v12 offset:20480
    ds_read_b64_tr_b16 v[246:247], v12 offset:22528
    ds_read_b64_tr_b16 v[248:249], v12 offset:24576
    ds_read_b64_tr_b16 v[250:251], v12 offset:26624
    ds_read_b64_tr_b16 v[252:253], v12 offset:28672
    ds_read_b64_tr_b16 v[254:255], v12 offset:30720
    s_waitcnt lgkmcnt(8)
    v_mfma_f32_32x32x16_bf16 v[128:143], v[224:227], v[64:67], v[128:143]
    v_mfma_f32_32x32x16_bf16 v[128:143], v[228:231], v[72:75], v[128:143]
    v_mfma_f32_32x32x16_bf16 v[128:143], v[232:235], v[80:83], v[128:143]
    v_mfma_f32_32x32x16_bf16 v[128:143], v[236:239], v[88:91], v[128:143]
    ds_read_b64_tr_b16 v[224:225], v13 offset:0
    ds_read_b64_tr_b16 v[226:227], v13 offset:2048
    ds_read_b64_tr_b16 v[228:229], v13 offset:4096
    ds_read_b64_tr_b16 v[230:231], v13 offset:6144
    ds_read_b64_tr_b16 v[232:233], v13 offset:8192
    ds_read_b64_tr_b16 v[234:235], v13 offset:10240
    ds_read_b64_tr_b16 v[236:237], v13 offset:12288
    ds_read_b64_tr_b16 v[238:239], v13 offset:14336
    s_waitcnt lgkmcnt(8)
    v_mfma_f32_32x32x16_bf16 v[128:143], v[240:243], v[96:99], v[128:143]
    v_mfma_f32_32x32x16_bf16 v[128:143], v[244:247], v[104:107], v[128:143]
    v_mfma_f32_32x32x16_bf16 v[128:143], v[248:251], v[112:115], v[128:143]
    v_mfma_f32_32x32x16_bf16 v[128:143], v[252:255], v[120:123], v[128:143]
    ds_read_b64_tr_b16 v[240:241], v13 offset:16384
    ds_read_b64_tr_b16 v[242:243], v13 offset:18432
    ds_read_b64_tr_b16 v[244:245], v13 offset:20480
    ds_read_b64_tr_b16 v[246:247], v13 offset:22528
    ds_read_b64_tr_b16 v[248:249], v13 offset:24576
    ds_read_b64_tr_b16 v[250:251], v13 offset:26624
    ds_read_b64_tr_b16 v[252:253], v13 offset:28672
    ds_read_b64_tr_b16 v[254:255], v13 offset:30720
    s_waitcnt lgkmcnt(8)
    v_mfma_f32_32x32x16_bf16 v[144:159], v[224:227], v[64:67], v[144:159]
    v_mfma_f32_32x32x16_bf16 v[144:159], v[228:231], v[72:75], v[144:159]
    v_mfma_f32_32x32x16_bf16 v[144:159], v[232:235], v[80:83], v[144:159]
    v_mfma_f32_32x32x16_bf16 v[144:159], v[236:239], v[88:91], v[144:159]
    ds_read_b64_tr_b16 v[224:225], v14 offset:0
    ds_read_b64_tr_b16 v[226:227], v14 offset:2048
    ds_read_b64_tr_b16 v[228:229], v14 offset:4096
    ds_read_b64_tr_b16 v[230:231], v14 offset:6144
    ds_read_b64_tr_b16 v[232:233], v14 offset:8192
    ds_read_b64_tr_b16 v[234:235], v14 offset:10240
    ds_read_b64_tr_b16 v[236:237], v14 offset:12288
    ds_read_b64_tr_b16 v[238:239], v14 offset:14336
    s_waitcnt lgkmcnt(8)
    v_mfma_f32_32x32x16_bf16 v[144:159], v[240:243], v[96:99], v[144:159]
    v_mfma_f32_32x32x16_bf16 v[144:159], v[244:247], v[104:107], v[144:159]
    v_mfma_f32_32x32x16_bf16 v[144:159], v[248:251], v[112:115], v[144:159]
    v_mfma_f32_32x32x16_bf16 v[144:159], v[252:255], v[120:123], v[144:159]
    ds_read_b64_tr_b16 v[240:241], v14 offset:16384
    ds_read_b64_tr_b16 v[242:243], v14 offset:18432
    ds_read_b64_tr_b16 v[244:245], v14 offset:20480
    ds_read_b64_tr_b16 v[246:247], v14 offset:22528
    ds_read_b64_tr_b16 v[248:249], v14 offset:24576
    ds_read_b64_tr_b16 v[250:251], v14 offset:26624
    ds_read_b64_tr_b16 v[252:253], v14 offset:28672
    ds_read_b64_tr_b16 v[254:255], v14 offset:30720
    s_waitcnt lgkmcnt(8)
    v_mfma_f32_32x32x16_bf16 v[160:175], v[224:227], v[64:67], v[160:175]
    v_mfma_f32_32x32x16_bf16 v[160:175], v[228:231], v[72:75], v[160:175]
    v_mfma_f32_32x32x16_bf16 v[160:175], v[232:235], v[80:83], v[160:175]
    v_mfma_f32_32x32x16_bf16 v[160:175], v[236:239], v[88:91], v[160:175]
    ds_read_b64_tr_b16 v[224:225], v15 offset:0
    ds_read_b64_tr_b16 v[226:227], v15 offset:2048
    ds_read_b64_tr_b16 v[228:229], v15 offset:4096
    ds_read_b64_tr_b16 v[230:231], v15 offset:6144
    ds_read_b64_tr_b16 v[232:233], v15 offset:8192
    ds_read_b64_tr_b16 v[234:235], v15 offset:10240
    ds_read_b64_tr_b16 v[236:237], v15 offset:12288
    ds_read_b64_tr_b16 v[238:239], v15 offset:14336
    s_waitcnt lgkmcnt(8)
    v_mfma_f32_32x32x16_bf16 v[160:175], v[240:243], v[96:99], v[160:175]
    v_mfma_f32_32x32x16_bf16 v[160:175], v[244:247], v[104:107], v[160:175]
    v_mfma_f32_32x32x16_bf16 v[160:175], v[248:251], v[112:115], v[160:175]
    v_mfma_f32_32x32x16_bf16 v[160:175], v[252:255], v[120:123], v[160:175]
    ds_read_b64_tr_b16 v[240:241], v15 offset:16384
    ds_read_b64_tr_b16 v[242:243], v15 offset:18432
    ds_read_b64_tr_b16 v[244:245], v15 offset:20480
    ds_read_b64_tr_b16 v[246:247], v15 offset:22528
    ds_read_b64_tr_b16 v[248:249], v15 offset:24576
    ds_read_b64_tr_b16 v[250:251], v15 offset:26624
    ds_read_b64_tr_b16 v[252:253], v15 offset:28672
    ds_read_b64_tr_b16 v[254:255], v15 offset:30720
    s_waitcnt lgkmcnt(8)
    v_mfma_f32_32x32x16_bf16 v[176:191], v[224:227], v[64:67], v[176:191]
    v_mfma_f32_32x32x16_bf16 v[176:191], v[228:231], v[72:75], v[176:191]
    v_mfma_f32_32x32x16_bf16 v[176:191], v[232:235], v[80:83], v[176:191]
    v_mfma_f32_32x32x16_bf16 v[176:191], v[236:239], v[88:91], v[176:191]
    s_waitcnt lgkmcnt(0)
    v_mfma_f32_32x32x16_bf16 v[176:191], v[240:243], v[96:99], v[176:191]
    v_mfma_f32_32x32x16_bf16 v[176:191], v[244:247], v[104:107], v[176:191]
    v_mfma_f32_32x32x16_bf16 v[176:191], v[248:251], v[112:115], v[176:191]
    v_mfma_f32_32x32x16_bf16 v[176:191], v[252:255], v[120:123], v[176:191]
    v_xor_b32 v4, 0x10000, v4
    v_xor_b32 v5, 0x10000, v5
    v_xor_b32 v6, 0x10000, v6
    v_xor_b32 v7, 0x10000, v7
    v_xor_b32 v8, 0x10000, v8
    v_xor_b32 v9, 0x10000, v9
    v_xor_b32 v10, 0x10000, v10
    v_xor_b32 v11, 0x10000, v11
    v_xor_b32 v12, 0x10000, v12
    v_xor_b32 v13, 0x10000, v13
    v_xor_b32 v14, 0x10000, v14
    v_xor_b32 v15, 0x10000, v15
    s_add_u32 s25, s25, 1
    s_cmp_lt_u32 s25, 16
    s_nop 2
    s_cbranch_scc1 .Lloop_attn
    s_load_dwordx2 s[12:13], s[0:1], 112
    v_mov_b32 v23, v19
    s_nop 1
    v_permlane32_swap_b32 v19, v23
    v_add_f32 v19, v19, v23
    v_rcp_f32 v19, v19
    v_and_b32 v2, 31, v1
    v_add_u32 v2, s19, v2
    v_lshlrev_b32 v2, 13, v2
    v_lshrrev_b32 v3, 5, v1
    v_lshlrev_b32 v3, 3, v3
    v_add_u32 v2, v2, v3
    s_waitcnt lgkmcnt(0)
    s_add_u32 s12, s12, 0x1400000
    s_addc_u32 s13, s13, 0
    s_and_b32 s13, s13, 0xffff
    s_mov_b32 s14, 0x1000000
    s_mov_b32 s15, 0x00020000
    v_mul_f32 v128, v128, v19
    v_mul_f32 v129, v129, v19
    v_mul_f32 v130, v130, v19
    v_mul_f32 v131, v131, v19
    v_cvt_pk_bf16_f32 v128, v128, v129
    v_cvt_pk_bf16_f32 v129, v130, v131
    buffer_store_dwordx2 v[128:129], v2, s[12:15], s20 offen offset:0
    v_mul_f32 v132, v132, v19
    v_mul_f32 v133, v133, v19
    v_mul_f32 v134, v134, v19
    v_mul_f32 v135, v135, v19
    v_cvt_pk_bf16_f32 v132, v132, v133
    v_cvt_pk_bf16_f32 v133, v134, v135
    buffer_store_dwordx2 v[132:133], v2, s[12:15], s20 offen offset:16
    v_mul_f32 v136, v136, v19
    v_mul_f32 v137, v137, v19
    v_mul_f32 v138, v138, v19
    v_mul_f32 v139, v139, v19
    v_cvt_pk_bf16_f32 v136, v136, v137
    v_cvt_pk_bf16_f32 v137, v138, v139
    buffer_store_dwordx2 v[136:137], v2, s[12:15], s20 offen offset:32
    v_mul_f32 v140, v140, v19
    v_mul_f32 v141, v141, v19
    v_mul_f32 v142, v142, v19
    v_mul_f32 v143, v143, v19
    v_cvt_pk_bf16_f32 v140, v140, v141
    v_cvt_pk_bf16_f32 v141, v142, v143
    buffer_store_dwordx2 v[140:141], v2, s[12:15], s20 offen offset:48
    v_mul_f32 v144, v144, v19
    v_mul_f32 v145, v145, v19
    v_mul_f32 v146, v146, v19
    v_mul_f32 v147, v147, v19
    v_cvt_pk_bf16_f32 v144, v144, v145
    v_cvt_pk_bf16_f32 v145, v146, v147
    buffer_store_dwordx2 v[144:145], v2, s[12:15], s20 offen offset:64
    v_mul_f32 v148, v148, v19
    v_mul_f32 v149, v149, v19
    v_mul_f32 v150, v150, v19
    v_mul_f32 v151, v151, v19
    v_cvt_pk_bf16_f32 v148, v148, v149
    v_cvt_pk_bf16_f32 v149, v150, v151
    buffer_store_dwordx2 v[148:149], v2, s[12:15], s20 offen offset:80
    v_mul_f32 v152, v152, v19
    v_mul_f32 v153, v153, v19
    v_mul_f32 v154, v154, v19
    v_mul_f32 v155, v155, v19
    v_cvt_pk_bf16_f32 v152, v152, v153
    v_cvt_pk_bf16_f32 v153, v154, v155
    buffer_store_dwordx2 v[152:153], v2, s[12:15], s20 offen offset:96
    v_mul_f32 v156, v156, v19
    v_mul_f32 v157, v157, v19
    v_mul_f32 v158, v158, v19
    v_mul_f32 v159, v159, v19
    v_cvt_pk_bf16_f32 v156, v156, v157
    v_cvt_pk_bf16_f32 v157, v158, v159
    buffer_store_dwordx2 v[156:157], v2, s[12:15], s20 offen offset:112
    v_mul_f32 v160, v160, v19
    v_mul_f32 v161, v161, v19
    v_mul_f32 v162, v162, v19
    v_mul_f32 v163, v163, v19
    v_cvt_pk_bf16_f32 v160, v160, v161
    v_cvt_pk_bf16_f32 v161, v162, v163
    buffer_store_dwordx2 v[160:161], v2, s[12:15], s20 offen offset:128
    v_mul_f32 v164, v164, v19
    v_mul_f32 v165, v165, v19
    v_mul_f32 v166, v166, v19
    v_mul_f32 v167, v167, v19
    v_cvt_pk_bf16_f32 v164, v164, v165
    v_cvt_pk_bf16_f32 v165, v166, v167
    buffer_store_dwordx2 v[164:165], v2, s[12:15], s20 offen offset:144
    v_mul_f32 v168, v168, v19
    v_mul_f32 v169, v169, v19
    v_mul_f32 v170, v170, v19
    v_mul_f32 v171, v171, v19
    v_cvt_pk_bf16_f32 v168, v168, v169
    v_cvt_pk_bf16_f32 v169, v170, v171
    buffer_store_dwordx2 v[168:169], v2, s[12:15], s20 offen offset:160
    v_mul_f32 v172, v172, v19
    v_mul_f32 v173, v173, v19
    v_mul_f32 v174, v174, v19
    v_mul_f32 v175, v175, v19
    v_cvt_pk_bf16_f32 v172, v172, v173
    v_cvt_pk_bf16_f32 v173, v174, v175
    buffer_store_dwordx2 v[172:173], v2, s[12:15], s20 offen offset:176
    v_mul_f32 v176, v176, v19
    v_mul_f32 v177, v177, v19
    v_mul_f32 v178, v178, v19
    v_mul_f32 v179, v179, v19
    v_cvt_pk_bf16_f32 v176, v176, v177
    v_cvt_pk_bf16_f32 v177, v178, v179
    buffer_store_dwordx2 v[176:177], v2, s[12:15], s20 offen offset:192
    v_mul_f32 v180, v180, v19
    v_mul_f32 v181, v181, v19
    v_mul_f32 v182, v182, v19
    v_mul_f32 v183, v183, v19
    v_cvt_pk_bf16_f32 v180, v180, v181
    v_cvt_pk_bf16_f32 v181, v182, v183
    buffer_store_dwordx2 v[180:181], v2, s[12:15], s20 offen offset:208
    v_mul_f32 v184, v184, v19
    v_mul_f32 v185, v185, v19
    v_mul_f32 v186, v186, v19
    v_mul_f32 v187, v187, v19
    v_cvt_pk_bf16_f32 v184, v184, v185
    v_cvt_pk_bf16_f32 v185, v186, v187
    buffer_store_dwordx2 v[184:185], v2, s[12:15], s20 offen offset:224
    v_mul_f32 v188, v188, v19
    v_mul_f32 v189, v189, v19
    v_mul_f32 v190, v190, v19
    v_mul_f32 v191, v191, v19
    v_cvt_pk_bf16_f32 v188, v188, v189
    v_cvt_pk_bf16_f32 v189, v190, v191
    buffer_store_dwordx2 v[188:189], v2, s[12:15], s20 offen offset:240
    s_nop 3
.Lend_attn_kernel:
    s_endpgm
.globl gemmo_kernel
.p2align 8
.type gemmo_kernel,@function
gemmo_kernel:
    s_cmp_ge_u32 s2, 256
    s_cbranch_scc1 .Lend_gemmo_kernel
    s_load_dwordx2 s[4:5], s[0:1], 112
    s_load_dwordx2 s[8:9], s[0:1], 32
    v_and_b32 v1, 63, v0
    v_lshrrev_b32 v12, 6, v0
    s_nop 0
    v_readfirstlane_b32 s3, v12
    s_mov_b32 s29, 0
    s_mov_b32 s16, s2
    s_mul_hi_u32 s17, s16, 0x20000001
    s_mul_i32 s18, s17, 8
    s_sub_u32 s18, s16, s18
    s_mul_i32 s19, s17, 64
    s_mul_i32 s20, s18, 64
    s_and_b32 s21, s3, 1
    s_lshr_b32 s22, s3, 1
    s_waitcnt lgkmcnt(0)
    s_add_u32 s4, s4, 0x1400000
    s_addc_u32 s5, s5, 0
    s_and_b32 s5, s5, 0xffff
    s_mov_b32 s6, 0x1000000
    s_mov_b32 s7, 0x00020000
    s_and_b32 s9, s9, 0xffff
    s_mov_b32 s10, 0x400000
    s_mov_b32 s11, 0x00020000
    v_lshrrev_b32 v12, 3, v1
    v_mul_u32_u24 v10, 8192, v12
    v_lshrrev_b32 v13, 4, v1
    s_and_b32 s23, s3, 1
    s_lshl_b32 s23, s23, 2
    v_add_u32 v13, s23, v13
    v_and_b32 v13, 7, v13
    v_and_b32 v14, 7, v1
    v_xor_b32 v14, v14, v13
    v_lshlrev_b32 v14, 4, v14
    v_add_u32 v10, v10, v14
    v_lshrrev_b32 v12, 3, v1
    v_mul_u32_u24 v11, 1024, v12
    v_lshrrev_b32 v13, 1, v12
    v_and_b32 v13, 1, v13
    v_lshlrev_b32 v13, 2, v13
    v_and_b32 v14, 7, v1
    v_xor_b32 v14, v14, v13
    v_lshlrev_b32 v14, 4, v14
    v_add_u32 v11, v11, v14
    s_lshl_b32 s23, s3, 3
    s_add_u32 s23, s23, s19
    s_mul_i32 s24, s23, 8192
    s_mul_i32 s25, s3, 8192
    s_lshl_b32 s23, s20, 1
    s_add_u32 s25, s25, s23
    s_lshl_b32 s27, s3, 10
    s_add_u32 m0, s27, 0
    s_add_u32 s26, s24, 0
    buffer_load_dwordx4 v10, s[4:7], s26 offen lds
    s_add_u32 m0, s27, 4096
    s_add_u32 s26, s24, 262144
    buffer_load_dwordx4 v10, s[4:7], s26 offen lds
    s_add_u32 m0, s27, 8192
    s_add_u32 s26, s25, 0
    buffer_load_dwordx4 v11, s[8:11], s26 offen lds
    s_add_u32 m0, s27, 12288
    s_add_u32 s26, s25, 32768
    buffer_load_dwordx4 v11, s[8:11], s26 offen lds
    s_add_u32 s24, s24, 128
    s_add_u32 s25, s25, 65536
    s_add_u32 m0, s27, 16384
    s_add_u32 s26, s24, 0
    buffer_load_dwordx4 v10, s[4:7], s26 offen lds
    s_add_u32 m0, s27, 20480
    s_add_u32 s26, s24, 262144
    buffer_load_dwordx4 v10, s[4:7], s26 offen lds
    s_add_u32 m0, s27, 24576
    s_add_u32 s26, s25, 0
    buffer_load_dwordx4 v11, s[8:11], s26 offen lds
    s_add_u32 m0, s27, 28672
    s_add_u32 s26, s25, 32768
    buffer_load_dwordx4 v11, s[8:11], s26 offen lds
    s_add_u32 s24, s24, 128
    s_add_u32 s25, s25, 65536
    s_add_u32 m0, s27, 32768
    s_add_u32 s26, s24, 0
    buffer_load_dwordx4 v10, s[4:7], s26 offen lds
    s_add_u32 m0, s27, 36864
    s_add_u32 s26, s24, 262144
    buffer_load_dwordx4 v10, s[4:7], s26 offen lds
    s_add_u32 m0, s27, 40960
    s_add_u32 s26, s25, 0
    buffer_load_dwordx4 v11, s[8:11], s26 offen lds
    s_add_u32 m0, s27, 45056
    s_add_u32 s26, s25, 32768
    buffer_load_dwordx4 v11, s[8:11], s26 offen lds
    s_add_u32 s24, s24, 128
    s_add_u32 s25, s25, 65536
    s_add_u32 m0, s27, 49152
    s_add_u32 s26, s24, 0
    buffer_load_dwordx4 v10, s[4:7], s26 offen lds
    s_add_u32 m0, s27, 53248
    s_add_u32 s26, s24, 262144
    buffer_load_dwordx4 v10, s[4:7], s26 offen lds
    s_add_u32 m0, s27, 57344
    s_add_u32 s26, s25, 0
    buffer_load_dwordx4 v11, s[8:11], s26 offen lds
    s_add_u32 m0, s27, 61440
    s_add_u32 s26, s25, 32768
    buffer_load_dwordx4 v11, s[8:11], s26 offen lds
    s_add_u32 s24, s24, 128
    s_add_u32 s25, s25, 65536
    s_add_u32 m0, s27, 65536
    s_add_u32 s26, s24, 0
    buffer_load_dwordx4 v10, s[4:7], s26 offen lds
    s_add_u32 m0, s27, 69632
    s_add_u32 s26, s24, 262144
    buffer_load_dwordx4 v10, s[4:7], s26 offen lds
    s_add_u32 m0, s27, 73728
    s_add_u32 s26, s25, 0
    buffer_load_dwordx4 v11, s[8:11], s26 offen lds
    s_add_u32 m0, s27, 77824
    s_add_u32 s26, s25, 32768
    buffer_load_dwordx4 v11, s[8:11], s26 offen lds
    s_add_u32 s24, s24, 128
    s_add_u32 s25, s25, 65536
    s_add_u32 m0, s27, 81920
    s_add_u32 s26, s24, 0
    buffer_load_dwordx4 v10, s[4:7], s26 offen lds
    s_add_u32 m0, s27, 86016
    s_add_u32 s26, s24, 262144
    buffer_load_dwordx4 v10, s[4:7], s26 offen lds
    s_add_u32 m0, s27, 90112
    s_add_u32 s26, s25, 0
    buffer_load_dwordx4 v11, s[8:11], s26 offen lds
    s_add_u32 m0, s27, 94208
    s_add_u32 s26, s25, 32768
    buffer_load_dwordx4 v11, s[8:11], s26 offen lds
    s_add_u32 s24, s24, 128
    s_add_u32 s25, s25, 65536
    s_add_u32 m0, s27, 98304
    s_add_u32 s26, s24, 0
    buffer_load_dwordx4 v10, s[4:7], s26 offen lds
    s_add_u32 m0, s27, 102400
    s_add_u32 s26, s24, 262144
    buffer_load_dwordx4 v10, s[4:7], s26 offen lds
    s_add_u32 m0, s27, 106496
    s_add_u32 s26, s25, 0
    buffer_load_dwordx4 v11, s[8:11], s26 offen lds
    s_add_u32 m0, s27, 110592
    s_add_u32 s26, s25, 32768
    buffer_load_dwordx4 v11, s[8:11], s26 offen lds
    s_add_u32 s24, s24, 128
    s_add_u32 s25, s25, 65536
    v_and_b32 v12, 31, v1
    s_mul_i32 s23, s21, 32
    v_add_u32 v12, s23, v12
    v_lshrrev_b32 v13, 1, v12
    v_and_b32 v13, 7, v13
    v_lshrrev_b32 v14, 5, v1
    v_lshlrev_b32 v12, 7, v12
    v_add_u32 v15, 0, v14
    v_xor_b32 v15, v15, v13
    v_lshlrev_b32 v15, 4, v15
    v_add_u32 v56, v12, v15
    v_add_u32 v15, 2, v14
    v_xor_b32 v15, v15, v13
    v_lshlrev_b32 v15, 4, v15
    v_add_u32 v57, v12, v15
    v_add_u32 v15, 4, v14
    v_xor_b32 v15, v15, v13
    v_lshlrev_b32 v15, 4, v15
    v_add_u32 v58, v12, v15
    v_add_u32 v15, 6, v14
    v_xor_b32 v15, v15, v13
    v_lshlrev_b32 v15, 4, v15
    v_add_u32 v59, v12, v15
    v_lshrrev_b32 v12, 2, v1
    v_and_b32 v12, 3, v12
    v_lshrrev_b32 v13, 5, v1
    v_lshlrev_b32 v13, 3, v13
    v_add_u32 v13, v13, v12
    v_mul_u32_u24 v13, 128, v13
    v_lshrrev_b32 v14, 4, v1
    v_and_b32 v14, 1, v14
    v_lshlrev_b32 v14, 1, v14
    v_and_b32 v15, 3, v1
    v_lshrrev_b32 v16, 1, v15
    v_add_u32 v14, v14, v16
    v_and_b32 v15, 1, v15
    v_lshlrev_b32 v15, 3, v15
    v_add_u32 v13, v13, v15
    v_lshrrev_b32 v12, 1, v12
    v_lshlrev_b32 v12, 2, v12
    s_mul_i32 s23, s22, 4
    s_add_u32 s23, s23, 0
    v_add_u32 v15, s23, v14
    v_xor_b32 v15, v15, v12
    v_lshlrev_b32 v15, 4, v15
    v_add_u32 v64, v13, v15
    v_add_u32 v60, 0x10000, v56
    v_add_u32 v61, 0x10000, v57
    v_add_u32 v62, 0x10000, v58
    v_add_u32 v63, 0x10000, v59
    v_add_u32 v65, 0x10000, v64
    s_waitcnt vmcnt(24)
    s_barrier
    s_add_u32 m0, s27, 114688
    s_add_u32 s26, s24, 0
    buffer_load_dwordx4 v10, s[4:7], s26 offen lds
    s_add_u32 m0, s27, 118784
    s_add_u32 s26, s24, 262144
    buffer_load_dwordx4 v10, s[4:7], s26 offen lds
    s_add_u32 m0, s27, 122880
    s_add_u32 s26, s25, 0
    buffer_load_dwordx4 v11, s[8:11], s26 offen lds
    s_add_u32 m0, s27, 126976
    s_add_u32 s26, s25, 32768
    buffer_load_dwordx4 v11, s[8:11], s26 offen lds
    s_add_u32 s24, s24, 128
    s_add_u32 s25, s25, 65536
    ds_read_b128 v[40:43], v56 offset:0
    ds_read_b64_tr_b16 v[48:49], v64 offset:8192
    ds_read_b64_tr_b16 v[50:51], v64 offset:8704
    ds_read_b128 v[44:47], v57 offset:0
    ds_read_b64_tr_b16 v[52:53], v64 offset:10240
    ds_read_b64_tr_b16 v[54:55], v64 offset:10752
    s_waitcnt lgkmcnt(3)
    v_mfma_f32_32x32x16_bf16 v[24:39], v[48:51], v[40:43], 0
    ds_read_b128 v[40:43], v58 offset:0
    ds_read_b64_tr_b16 v[48:49], v64 offset:12288
    ds_read_b64_tr_b16 v[50:51], v64 offset:12800
    s_waitcnt lgkmcnt(3)
    v_mfma_f32_32x32x16_bf16 v[24:39], v[52:55], v[44:47], v[24:39]
    ds_read_b128 v[44:47], v59 offset:0
    ds_read_b64_tr_b16 v[52:53], v64 offset:14336
    ds_read_b64_tr_b16 v[54:55], v64 offset:14848
    s_waitcnt lgkmcnt(3)
    v_mfma_f32_32x32x16_bf16 v[24:39], v[48:51], v[40:43], v[24:39]
    s_waitcnt lgkmcnt(0)
    v_mfma_f32_32x32x16_bf16 v[24:39], v[52:55], v[44:47], v[24:39]
    s_waitcnt vmcnt(24)
    s_barrier
    s_add_u32 m0, s27, 0
    s_add_u32 s26, s24, 0
    buffer_load_dwordx4 v10, s[4:7], s26 offen lds
    s_add_u32 m0, s27, 4096
    s_add_u32 s26, s24, 262144
    buffer_load_dwordx4 v10, s[4:7], s26 offen lds
    s_add_u32 m0, s27, 8192
    s_add_u32 s26, s25, 0
    buffer_load_dwordx4 v11, s[8:11], s26 offen lds
    s_add_u32 m0, s27, 12288
    s_add_u32 s26, s25, 32768
    buffer_load_dwordx4 v11, s[8:11], s26 offen lds
    s_add_u32 s24, s24, 128
    s_add_u32 s25, s25, 65536
    ds_read_b128 v[40:43], v56 offset:16384
    ds_read_b64_tr_b16 v[48:49], v64 offset:24576
    ds_read_b64_tr_b16 v[50:51], v64 offset:25088
    ds_read_b128 v[44:47], v57 offset:16384
    ds_read_b64_tr_b16 v[52:53], v64 offset:26624
    ds_read_b64_tr_b16 v[54:55], v64 offset:27136
    s_waitcnt lgkmcnt(3)
    v_mfma_f32_32x32x16_bf16 v[24:39], v[48:51], v[40:43], v[24:39]
    ds_read_b128 v[40:43], v58 offset:16384
    ds_read_b64_tr_b16 v[48:49], v64 offset:28672
    ds_read_b64_tr_b16 v[50:51], v64 offset:29184
    s_waitcnt lgkmcnt(3)
    v_mfma_f32_32x32x16_bf16 v[24:39], v[52:55], v[44:47], v[24:39]
    ds_read_b128 v[44:47], v59 offset:16384
    ds_read_b64_tr_b16 v[52:53], v64 offset:30720
    ds_read_b64_tr_b16 v[54:55], v64 offset:31232
    s_waitcnt lgkmcnt(3)
    v_mfma_f32_32x32x16_bf16 v[24:39], v[48:51], v[40:43], v[24:39]
    s_waitcnt lgkmcnt(0)
    v_mfma_f32_32x32x16_bf16 v[24:39], v[52:55], v[44:47], v[24:39]
    s_waitcnt vmcnt(24)
    s_barrier
    s_add_u32 m0, s27, 16384
    s_add_u32 s26, s24, 0
    buffer_load_dwordx4 v10, s[4:7], s26 offen lds
    s_add_u32 m0, s27, 20480
    s_add_u32 s26, s24, 262144
    buffer_load_dwordx4 v10, s[4:7], s26 offen lds
    s_add_u32 m0, s27, 24576
    s_add_u32 s26, s25, 0
    buffer_load_dwordx4 v11, s[8:11], s26 offen lds
    s_add_u32 m0, s27, 28672
    s_add_u32 s26, s25, 32768
    buffer_load_dwordx4 v11, s[8:11], s26 offen lds
    s_add_u32 s24, s24, 128
    s_add_u32 s25, s25, 65536
    ds_read_b128 v[40:43], v56 offset:32768
    ds_read_b64_tr_b16 v[48:49], v64 offset:40960
    ds_read_b64_tr_b16 v[50:51], v64 offset:41472
    ds_read_b128 v[44:47], v57 offset:32768
    ds_read_b64_tr_b16 v[52:53], v64 offset:43008
    ds_read_b64_tr_b16 v[54:55], v64 offset:43520
    s_waitcnt lgkmcnt(3)
    v_mfma_f32_32x32x16_bf16 v[24:39], v[48:51], v[40:43], v[24:39]
    ds_read_b128 v[40:43], v58 offset:32768
    ds_read_b64_tr_b16 v[48:49], v64 offset:45056
    ds_read_b64_tr_b16 v[50:51], v64 offset:45568
    s_waitcnt lgkmcnt(3)
    v_mfma_f32_32x32x16_bf16 v[24:39], v[52:55], v[44:47], v[24:39]
    ds_read_b128 v[44:47], v59 offset:32768
    ds_read_b64_tr_b16 v[52:53], v64 offset:47104
    ds_read_b64_tr_b16 v[54:55], v64 offset:47616
    s_waitcnt lgkmcnt(3)
    v_mfma_f32_32x32x16_bf16 v[24:39], v[48:51], v[40:43], v[24:39]
    s_waitcnt lgkmcnt(0)
    v_mfma_f32_32x32x16_bf16 v[24:39], v[52:55], v[44:47], v[24:39]
    s_waitcnt vmcnt(24)
    s_barrier
    s_add_u32 m0, s27, 32768
    s_add_u32 s26, s24, 0
    buffer_load_dwordx4 v10, s[4:7], s26 offen lds
    s_add_u32 m0, s27, 36864
    s_add_u32 s26, s24, 262144
    buffer_load_dwordx4 v10, s[4:7], s26 offen lds
    s_add_u32 m0, s27, 40960
    s_add_u32 s26, s25, 0
    buffer_load_dwordx4 v11, s[8:11], s26 offen lds
    s_add_u32 m0, s27, 45056
    s_add_u32 s26, s25, 32768
    buffer_load_dwordx4 v11, s[8:11], s26 offen lds
    s_add_u32 s24, s24, 128
    s_add_u32 s25, s25, 65536
    ds_read_b128 v[40:43], v56 offset:49152
    ds_read_b64_tr_b16 v[48:49], v64 offset:57344
    ds_read_b64_tr_b16 v[50:51], v64 offset:57856
    ds_read_b128 v[44:47], v57 offset:49152
    ds_read_b64_tr_b16 v[52:53], v64 offset:59392
    ds_read_b64_tr_b16 v[54:55], v64 offset:59904
    s_waitcnt lgkmcnt(3)
    v_mfma_f32_32x32x16_bf16 v[24:39], v[48:51], v[40:43], v[24:39]
    ds_read_b128 v[40:43], v58 offset:49152
    ds_read_b64_tr_b16 v[48:49], v64 offset:61440
    ds_read_b64_tr_b16 v[50:51], v64 offset:61952
    s_waitcnt lgkmcnt(3)
    v_mfma_f32_32x32x16_bf16 v[24:39], v[52:55], v[44:47], v[24:39]
    ds_read_b128 v[44:47], v59 offset:49152
    ds_read_b64_tr_b16 v[52:53], v64 offset:63488
    ds_read_b64_tr_b16 v[54:55], v64 offset:64000
    s_waitcnt lgkmcnt(3)
    v_mfma_f32_32x32x16_bf16 v[24:39], v[48:51], v[40:43], v[24:39]
    s_waitcnt lgkmcnt(0)
    v_mfma_f32_32x32x16_bf16 v[24:39], v[52:55], v[44:47], v[24:39]
    s_waitcnt vmcnt(24)
    s_barrier
    s_add_u32 m0, s27, 49152
    s_add_u32 s26, s24, 0
    buffer_load_dwordx4 v10, s[4:7], s26 offen lds
    s_add_u32 m0, s27, 53248
    s_add_u32 s26, s24, 262144
    buffer_load_dwordx4 v10, s[4:7], s26 offen lds
    s_add_u32 m0, s27, 57344
    s_add_u32 s26, s25, 0
    buffer_load_dwordx4 v11, s[8:11], s26 offen lds
    s_add_u32 m0, s27, 61440
    s_add_u32 s26, s25, 32768
    buffer_load_dwordx4 v11, s[8:11], s26 offen lds
    s_add_u32 s24, s24, 128
    s_add_u32 s25, s25, 65536
    ds_read_b128 v[40:43], v60 offset:0
    ds_read_b64_tr_b16 v[48:49], v65 offset:8192
    ds_read_b64_tr_b16 v[50:51], v65 offset:8704
    ds_read_b128 v[44:47], v61 offset:0
    ds_read_b64_tr_b16 v[52:53], v65 offset:10240
    ds_read_b64_tr_b16 v[54:55], v65 offset:10752
    s_waitcnt lgkmcnt(3)
    v_mfma_f32_32x32x16_bf16 v[24:39], v[48:51], v[40:43], v[24:39]
    ds_read_b128 v[40:43], v62 offset:0
    ds_read_b64_tr_b16 v[48:49], v65 offset:12288
    ds_read_b64_tr_b16 v[50:51], v65 offset:12800
    s_waitcnt lgkmcnt(3)
    v_mfma_f32_32x32x16_bf16 v[24:39], v[52:55], v[44:47], v[24:39]
    ds_read_b128 v[44:47], v63 offset:0
    ds_read_b64_tr_b16 v[52:53], v65 offset:14336
    ds_read_b64_tr_b16 v[54:55], v65 offset:14848
    s_waitcnt lgkmcnt(3)
    v_mfma_f32_32x32x16_bf16 v[24:39], v[48:51], v[40:43], v[24:39]
    s_waitcnt lgkmcnt(0)
    v_mfma_f32_32x32x16_bf16 v[24:39], v[52:55], v[44:47], v[24:39]
    s_waitcnt vmcnt(24)
    s_barrier
    s_add_u32 m0, s27, 65536
    s_add_u32 s26, s24, 0
    buffer_load_dwordx4 v10, s[4:7], s26 offen lds
    s_add_u32 m0, s27, 69632
    s_add_u32 s26, s24, 262144
    buffer_load_dwordx4 v10, s[4:7], s26 offen lds
    s_add_u32 m0, s27, 73728
    s_add_u32 s26, s25, 0
    buffer_load_dwordx4 v11, s[8:11], s26 offen lds
    s_add_u32 m0, s27, 77824
    s_add_u32 s26, s25, 32768
    buffer_load_dwordx4 v11, s[8:11], s26 offen lds
    s_add_u32 s24, s24, 128
    s_add_u32 s25, s25, 65536
    ds_read_b128 v[40:43], v60 offset:16384
    ds_read_b64_tr_b16 v[48:49], v65 offset:24576
    ds_read_b64_tr_b16 v[50:51], v65 offset:25088
    ds_read_b128 v[44:47], v61 offset:16384
    ds_read_b64_tr_b16 v[52:53], v65 offset:26624
    ds_read_b64_tr_b16 v[54:55], v65 offset:27136
    s_waitcnt lgkmcnt(3)
    v_mfma_f32_32x32x16_bf16 v[24:39], v[48:51], v[40:43], v[24:39]
    ds_read_b128 v[40:43], v62 offset:16384
    ds_read_b64_tr_b16 v[48:49], v65 offset:28672
    ds_read_b64_tr_b16 v[50:51], v65 offset:29184
    s_waitcnt lgkmcnt(3)
    v_mfma_f32_32x32x16_bf16 v[24:39], v[52:55], v[44:47], v[24:39]
    ds_read_b128 v[44:47], v63 offset:16384
    ds_read_b64_tr_b16 v[52:53], v65 offset:30720
    ds_read_b64_tr_b16 v[54:55], v65 offset:31232
    s_waitcnt lgkmcnt(3)
    v_mfma_f32_32x32x16_bf16 v[24:39], v[48:51], v[40:43], v[24:39]
    s_waitcnt lgkmcnt(0)
    v_mfma_f32_32x32x16_bf16 v[24:39], v[52:55], v[44:47], v[24:39]
    s_waitcnt vmcnt(24)
    s_barrier
    s_add_u32 m0, s27, 81920
    s_add_u32 s26, s24, 0
    buffer_load_dwordx4 v10, s[4:7], s26 offen lds
    s_add_u32 m0, s27, 86016
    s_add_u32 s26, s24, 262144
    buffer_load_dwordx4 v10, s[4:7], s26 offen lds
    s_add_u32 m0, s27, 90112
    s_add_u32 s26, s25, 0
    buffer_load_dwordx4 v11, s[8:11], s26 offen lds
    s_add_u32 m0, s27, 94208
    s_add_u32 s26, s25, 32768
    buffer_load_dwordx4 v11, s[8:11], s26 offen lds
    s_add_u32 s24, s24, 128
    s_add_u32 s25, s25, 65536
    ds_read_b128 v[40:43], v60 offset:32768
    ds_read_b64_tr_b16 v[48:49], v65 offset:40960
    ds_read_b64_tr_b16 v[50:51], v65 offset:41472
    ds_read_b128 v[44:47], v61 offset:32768
    ds_read_b64_tr_b16 v[52:53], v65 offset:43008
    ds_read_b64_tr_b16 v[54:55], v65 offset:43520
    s_waitcnt lgkmcnt(3)
    v_mfma_f32_32x32x16_bf16 v[24:39], v[48:51], v[40:43], v[24:39]
    ds_read_b128 v[40:43], v62 offset:32768
    ds_read_b64_tr_b16 v[48:49], v65 offset:45056
    ds_read_b64_tr_b16 v[50:51], v65 offset:45568
    s_waitcnt lgkmcnt(3)
    v_mfma_f32_32x32x16_bf16 v[24:39], v[52:55], v[44:47], v[24:39]
    ds_read_b128 v[44:47], v63 offset:32768
    ds_read_b64_tr_b16 v[52:53], v65 offset:47104
    ds_read_b64_tr_b16 v[54:55], v65 offset:47616
    s_waitcnt lgkmcnt(3)
    v_mfma_f32_32x32x16_bf16 v[24:39], v[48:51], v[40:43], v[24:39]
    s_waitcnt lgkmcnt(0)
    v_mfma_f32_32x32x16_bf16 v[24:39], v[52:55], v[44:47], v[24:39]
    s_waitcnt vmcnt(24)
    s_barrier
    s_add_u32 m0, s27, 98304
    s_add_u32 s26, s24, 0
    buffer_load_dwordx4 v10, s[4:7], s26 offen lds
    s_add_u32 m0, s27, 102400
    s_add_u32 s26, s24, 262144
    buffer_load_dwordx4 v10, s[4:7], s26 offen lds
    s_add_u32 m0, s27, 106496
    s_add_u32 s26, s25, 0
    buffer_load_dwordx4 v11, s[8:11], s26 offen lds
    s_add_u32 m0, s27, 110592
    s_add_u32 s26, s25, 32768
    buffer_load_dwordx4 v11, s[8:11], s26 offen lds
    s_add_u32 s24, s24, 128
    s_add_u32 s25, s25, 65536
    ds_read_b128 v[40:43], v60 offset:49152
    ds_read_b64_tr_b16 v[48:49], v65 offset:57344
    ds_read_b64_tr_b16 v[50:51], v65 offset:57856
    ds_read_b128 v[44:47], v61 offset:49152
    ds_read_b64_tr_b16 v[52:53], v65 offset:59392
    ds_read_b64_tr_b16 v[54:55], v65 offset:59904
    s_waitcnt lgkmcnt(3)
    v_mfma_f32_32x32x16_bf16 v[24:39], v[48:51], v[40:43], v[24:39]
    ds_read_b128 v[40:43], v62 offset:49152
    ds_read_b64_tr_b16 v[48:49], v65 offset:61440
    ds_read_b64_tr_b16 v[50:51], v65 offset:61952
    s_waitcnt lgkmcnt(3)
    v_mfma_f32_32x32x16_bf16 v[24:39], v[52:55], v[44:47], v[24:39]
    ds_read_b128 v[44:47], v63 offset:49152
    ds_read_b64_tr_b16 v[52:53], v65 offset:63488
    ds_read_b64_tr_b16 v[54:55], v65 offset:64000
    s_waitcnt lgkmcnt(3)
    v_mfma_f32_32x32x16_bf16 v[24:39], v[48:51], v[40:43], v[24:39]
    s_waitcnt lgkmcnt(0)
    v_mfma_f32_32x32x16_bf16 v[24:39], v[52:55], v[44:47], v[24:39]
    s_waitcnt vmcnt(24)
    s_barrier
    s_add_u32 m0, s27, 114688
    s_add_u32 s26, s24, 0
    buffer_load_dwordx4 v10, s[4:7], s26 offen lds
    s_add_u32 m0, s27, 118784
    s_add_u32 s26, s24, 262144
    buffer_load_dwordx4 v10, s[4:7], s26 offen lds
    s_add_u32 m0, s27, 122880
    s_add_u32 s26, s25, 0
    buffer_load_dwordx4 v11, s[8:11], s26 offen lds
    s_add_u32 m0, s27, 126976
    s_add_u32 s26, s25, 32768
    buffer_load_dwordx4 v11, s[8:11], s26 offen lds
    s_add_u32 s24, s24, 128
    s_add_u32 s25, s25, 65536
    ds_read_b128 v[40:43], v56 offset:0
    ds_read_b64_tr_b16 v[48:49], v64 offset:8192
    ds_read_b64_tr_b16 v[50:51], v64 offset:8704
    ds_read_b128 v[44:47], v57 offset:0
    ds_read_b64_tr_b16 v[52:53], v64 offset:10240
    ds_read_b64_tr_b16 v[54:55], v64 offset:10752
    s_waitcnt lgkmcnt(3)
    v_mfma_f32_32x32x16_bf16 v[24:39], v[48:51], v[40:43], v[24:39]
    ds_read_b128 v[40:43], v58 offset:0
    ds_read_b64_tr_b16 v[48:49], v64 offset:12288
    ds_read_b64_tr_b16 v[50:51], v64 offset:12800
    s_waitcnt lgkmcnt(3)
    v_mfma_f32_32x32x16_bf16 v[24:39], v[52:55], v[44:47], v[24:39]
    ds_read_b128 v[44:47], v59 offset:0
    ds_read_b64_tr_b16 v[52:53], v64 offset:14336
    ds_read_b64_tr_b16 v[54:55], v64 offset:14848
    s_waitcnt lgkmcnt(3)
    v_mfma_f32_32x32x16_bf16 v[24:39], v[48:51], v[40:43], v[24:39]
    s_waitcnt lgkmcnt(0)
    v_mfma_f32_32x32x16_bf16 v[24:39], v[52:55], v[44:47], v[24:39]
    s_waitcnt vmcnt(24)
    s_barrier
    s_add_u32 m0, s27, 0
    s_add_u32 s26, s24, 0
    buffer_load_dwordx4 v10, s[4:7], s26 offen lds
    s_add_u32 m0, s27, 4096
    s_add_u32 s26, s24, 262144
    buffer_load_dwordx4 v10, s[4:7], s26 offen lds
    s_add_u32 m0, s27, 8192
    s_add_u32 s26, s25, 0
    buffer_load_dwordx4 v11, s[8:11], s26 offen lds
    s_add_u32 m0, s27, 12288
    s_add_u32 s26, s25, 32768
    buffer_load_dwordx4 v11, s[8:11], s26 offen lds
    s_add_u32 s24, s24, 128
    s_add_u32 s25, s25, 65536
    ds_read_b128 v[40:43], v56 offset:16384
    ds_read_b64_tr_b16 v[48:49], v64 offset:24576
    ds_read_b64_tr_b16 v[50:51], v64 offset:25088
    ds_read_b128 v[44:47], v57 offset:16384
    ds_read_b64_tr_b16 v[52:53], v64 offset:26624
    ds_read_b64_tr_b16 v[54:55], v64 offset:27136
    s_waitcnt lgkmcnt(3)
    v_mfma_f32_32x32x16_bf16 v[24:39], v[48:51], v[40:43], v[24:39]
    ds_read_b128 v[40:43], v58 offset:16384
    ds_read_b64_tr_b16 v[48:49], v64 offset:28672
    ds_read_b64_tr_b16 v[50:51], v64 offset:29184
    s_waitcnt lgkmcnt(3)
    v_mfma_f32_32x32x16_bf16 v[24:39], v[52:55], v[44:47], v[24:39]
    ds_read_b128 v[44:47], v59 offset:16384
    ds_read_b64_tr_b16 v[52:53], v64 offset:30720
    ds_read_b64_tr_b16 v[54:55], v64 offset:31232
    s_waitcnt lgkmcnt(3)
    v_mfma_f32_32x32x16_bf16 v[24:39], v[48:51], v[40:43], v[24:39]
    s_waitcnt lgkmcnt(0)
    v_mfma_f32_32x32x16_bf16 v[24:39], v[52:55], v[44:47], v[24:39]
    s_waitcnt vmcnt(24)
    s_barrier
    s_add_u32 m0, s27, 16384
    s_add_u32 s26, s24, 0
    buffer_load_dwordx4 v10, s[4:7], s26 offen lds
    s_add_u32 m0, s27, 20480
    s_add_u32 s26, s24, 262144
    buffer_load_dwordx4 v10, s[4:7], s26 offen lds
    s_add_u32 m0, s27, 24576
    s_add_u32 s26, s25, 0
    buffer_load_dwordx4 v11, s[8:11], s26 offen lds
    s_add_u32 m0, s27, 28672
    s_add_u32 s26, s25, 32768
    buffer_load_dwordx4 v11, s[8:11], s26 offen lds
    s_add_u32 s24, s24, 128
    s_add_u32 s25, s25, 65536
    ds_read_b128 v[40:43], v56 offset:32768
    ds_read_b64_tr_b16 v[48:49], v64 offset:40960
    ds_read_b64_tr_b16 v[50:51], v64 offset:41472
    ds_read_b128 v[44:47], v57 offset:32768
    ds_read_b64_tr_b16 v[52:53], v64 offset:43008
    ds_read_b64_tr_b16 v[54:55], v64 offset:43520
    s_waitcnt lgkmcnt(3)
    v_mfma_f32_32x32x16_bf16 v[24:39], v[48:51], v[40:43], v[24:39]
    ds_read_b128 v[40:43], v58 offset:32768
    ds_read_b64_tr_b16 v[48:49], v64 offset:45056
    ds_read_b64_tr_b16 v[50:51], v64 offset:45568
    s_waitcnt lgkmcnt(3)
    v_mfma_f32_32x32x16_bf16 v[24:39], v[52:55], v[44:47], v[24:39]
    ds_read_b128 v[44:47], v59 offset:32768
    ds_read_b64_tr_b16 v[52:53], v64 offset:47104
    ds_read_b64_tr_b16 v[54:55], v64 offset:47616
    s_waitcnt lgkmcnt(3)
    v_mfma_f32_32x32x16_bf16 v[24:39], v[48:51], v[40:43], v[24:39]
    s_waitcnt lgkmcnt(0)
    v_mfma_f32_32x32x16_bf16 v[24:39], v[52:55], v[44:47], v[24:39]
    s_waitcnt vmcnt(24)
    s_barrier
    s_add_u32 m0, s27, 32768
    s_add_u32 s26, s24, 0
    buffer_load_dwordx4 v10, s[4:7], s26 offen lds
    s_add_u32 m0, s27, 36864
    s_add_u32 s26, s24, 262144
    buffer_load_dwordx4 v10, s[4:7], s26 offen lds
    s_add_u32 m0, s27, 40960
    s_add_u32 s26, s25, 0
    buffer_load_dwordx4 v11, s[8:11], s26 offen lds
    s_add_u32 m0, s27, 45056
    s_add_u32 s26, s25, 32768
    buffer_load_dwordx4 v11, s[8:11], s26 offen lds
    s_add_u32 s24, s24, 128
    s_add_u32 s25, s25, 65536
    ds_read_b128 v[40:43], v56 offset:49152
    ds_read_b64_tr_b16 v[48:49], v64 offset:57344
    ds_read_b64_tr_b16 v[50:51], v64 offset:57856
    ds_read_b128 v[44:47], v57 offset:49152
    ds_read_b64_tr_b16 v[52:53], v64 offset:59392
    ds_read_b64_tr_b16 v[54:55], v64 offset:59904
    s_waitcnt lgkmcnt(3)
    v_mfma_f32_32x32x16_bf16 v[24:39], v[48:51], v[40:43], v[24:39]
    ds_read_b128 v[40:43], v58 offset:49152
    ds_read_b64_tr_b16 v[48:49], v64 offset:61440
    ds_read_b64_tr_b16 v[50:51], v64 offset:61952
    s_waitcnt lgkmcnt(3)
    v_mfma_f32_32x32x16_bf16 v[24:39], v[52:55], v[44:47], v[24:39]
    ds_read_b128 v[44:47], v59 offset:49152
    ds_read_b64_tr_b16 v[52:53], v64 offset:63488
    ds_read_b64_tr_b16 v[54:55], v64 offset:64000
    s_waitcnt lgkmcnt(3)
    v_mfma_f32_32x32x16_bf16 v[24:39], v[48:51], v[40:43], v[24:39]
    s_waitcnt lgkmcnt(0)
    v_mfma_f32_32x32x16_bf16 v[24:39], v[52:55], v[44:47], v[24:39]
    s_waitcnt vmcnt(24)
    s_barrier
    s_add_u32 m0, s27, 49152
    s_add_u32 s26, s24, 0
    buffer_load_dwordx4 v10, s[4:7], s26 offen lds
    s_add_u32 m0, s27, 53248
    s_add_u32 s26, s24, 262144
    buffer_load_dwordx4 v10, s[4:7], s26 offen lds
    s_add_u32 m0, s27, 57344
    s_add_u32 s26, s25, 0
    buffer_load_dwordx4 v11, s[8:11], s26 offen lds
    s_add_u32 m0, s27, 61440
    s_add_u32 s26, s25, 32768
    buffer_load_dwordx4 v11, s[8:11], s26 offen lds
    s_add_u32 s24, s24, 128
    s_add_u32 s25, s25, 65536
    ds_read_b128 v[40:43], v60 offset:0
    ds_read_b64_tr_b16 v[48:49], v65 offset:8192
    ds_read_b64_tr_b16 v[50:51], v65 offset:8704
    ds_read_b128 v[44:47], v61 offset:0
    ds_read_b64_tr_b16 v[52:53], v65 offset:10240
    ds_read_b64_tr_b16 v[54:55], v65 offset:10752
    s_waitcnt lgkmcnt(3)
    v_mfma_f32_32x32x16_bf16 v[24:39], v[48:51], v[40:43], v[24:39]
    ds_read_b128 v[40:43], v62 offset:0
    ds_read_b64_tr_b16 v[48:49], v65 offset:12288
    ds_read_b64_tr_b16 v[50:51], v65 offset:12800
    s_waitcnt lgkmcnt(3)
    v_mfma_f32_32x32x16_bf16 v[24:39], v[52:55], v[44:47], v[24:39]
    ds_read_b128 v[44:47], v63 offset:0
    ds_read_b64_tr_b16 v[52:53], v65 offset:14336
    ds_read_b64_tr_b16 v[54:55], v65 offset:14848
    s_waitcnt lgkmcnt(3)
    v_mfma_f32_32x32x16_bf16 v[24:39], v[48:51], v[40:43], v[24:39]
    s_waitcnt lgkmcnt(0)
    v_mfma_f32_32x32x16_bf16 v[24:39], v[52:55], v[44:47], v[24:39]
    s_waitcnt vmcnt(24)
    s_barrier
    s_add_u32 m0, s27, 65536
    s_add_u32 s26, s24, 0
    buffer_load_dwordx4 v10, s[4:7], s26 offen lds
    s_add_u32 m0, s27, 69632
    s_add_u32 s26, s24, 262144
    buffer_load_dwordx4 v10, s[4:7], s26 offen lds
    s_add_u32 m0, s27, 73728
    s_add_u32 s26, s25, 0
    buffer_load_dwordx4 v11, s[8:11], s26 offen lds
    s_add_u32 m0, s27, 77824
    s_add_u32 s26, s25, 32768
    buffer_load_dwordx4 v11, s[8:11], s26 offen lds
    s_add_u32 s24, s24, 128
    s_add_u32 s25, s25, 65536
    ds_read_b128 v[40:43], v60 offset:16384
    ds_read_b64_tr_b16 v[48:49], v65 offset:24576
    ds_read_b64_tr_b16 v[50:51], v65 offset:25088
    ds_read_b128 v[44:47], v61 offset:16384
    ds_read_b64_tr_b16 v[52:53], v65 offset:26624
    ds_read_b64_tr_b16 v[54:55], v65 offset:27136
    s_waitcnt lgkmcnt(3)
    v_mfma_f32_32x32x16_bf16 v[24:39], v[48:51], v[40:43], v[24:39]
    ds_read_b128 v[40:43], v62 offset:16384
    ds_read_b64_tr_b16 v[48:49], v65 offset:28672
    ds_read_b64_tr_b16 v[50:51], v65 offset:29184
    s_waitcnt lgkmcnt(3)
    v_mfma_f32_32x32x16_bf16 v[24:39], v[52:55], v[44:47], v[24:39]
    ds_read_b128 v[44:47], v63 offset:16384
    ds_read_b64_tr_b16 v[52:53], v65 offset:30720
    ds_read_b64_tr_b16 v[54:55], v65 offset:31232
    s_waitcnt lgkmcnt(3)
    v_mfma_f32_32x32x16_bf16 v[24:39], v[48:51], v[40:43], v[24:39]
    s_waitcnt lgkmcnt(0)
    v_mfma_f32_32x32x16_bf16 v[24:39], v[52:55], v[44:47], v[24:39]
    s_waitcnt vmcnt(24)
    s_barrier
    s_add_u32 m0, s27, 81920
    s_add_u32 s26, s24, 0
    buffer_load_dwordx4 v10, s[4:7], s26 offen lds
    s_add_u32 m0, s27, 86016
    s_add_u32 s26, s24, 262144
    buffer_load_dwordx4 v10, s[4:7], s26 offen lds
    s_add_u32 m0, s27, 90112
    s_add_u32 s26, s25, 0
    buffer_load_dwordx4 v11, s[8:11], s26 offen lds
    s_add_u32 m0, s27, 94208
    s_add_u32 s26, s25, 32768
    buffer_load_dwordx4 v11, s[8:11], s26 offen lds
    s_add_u32 s24, s24, 128
    s_add_u32 s25, s25, 65536
    ds_read_b128 v[40:43], v60 offset:32768
    ds_read_b64_tr_b16 v[48:49], v65 offset:40960
    ds_read_b64_tr_b16 v[50:51], v65 offset:41472
    ds_read_b128 v[44:47], v61 offset:32768
    ds_read_b64_tr_b16 v[52:53], v65 offset:43008
    ds_read_b64_tr_b16 v[54:55], v65 offset:43520
    s_waitcnt lgkmcnt(3)
    v_mfma_f32_32x32x16_bf16 v[24:39], v[48:51], v[40:43], v[24:39]
    ds_read_b128 v[40:43], v62 offset:32768
    ds_read_b64_tr_b16 v[48:49], v65 offset:45056
    ds_read_b64_tr_b16 v[50:51], v65 offset:45568
    s_waitcnt lgkmcnt(3)
    v_mfma_f32_32x32x16_bf16 v[24:39], v[52:55], v[44:47], v[24:39]
    ds_read_b128 v[44:47], v63 offset:32768
    ds_read_b64_tr_b16 v[52:53], v65 offset:47104
    ds_read_b64_tr_b16 v[54:55], v65 offset:47616
    s_waitcnt lgkmcnt(3)
    v_mfma_f32_32x32x16_bf16 v[24:39], v[48:51], v[40:43], v[24:39]
    s_waitcnt lgkmcnt(0)
    v_mfma_f32_32x32x16_bf16 v[24:39], v[52:55], v[44:47], v[24:39]
    s_waitcnt vmcnt(24)
    s_barrier
    s_add_u32 m0, s27, 98304
    s_add_u32 s26, s24, 0
    buffer_load_dwordx4 v10, s[4:7], s26 offen lds
    s_add_u32 m0, s27, 102400
    s_add_u32 s26, s24, 262144
    buffer_load_dwordx4 v10, s[4:7], s26 offen lds
    s_add_u32 m0, s27, 106496
    s_add_u32 s26, s25, 0
    buffer_load_dwordx4 v11, s[8:11], s26 offen lds
    s_add_u32 m0, s27, 110592
    s_add_u32 s26, s25, 32768
    buffer_load_dwordx4 v11, s[8:11], s26 offen lds
    s_add_u32 s24, s24, 128
    s_add_u32 s25, s25, 65536
    ds_read_b128 v[40:43], v60 offset:49152
    ds_read_b64_tr_b16 v[48:49], v65 offset:57344
    ds_read_b64_tr_b16 v[50:51], v65 offset:57856
    ds_read_b128 v[44:47], v61 offset:49152
    ds_read_b64_tr_b16 v[52:53], v65 offset:59392
    ds_read_b64_tr_b16 v[54:55], v65 offset:59904
    s_waitcnt lgkmcnt(3)
    v_mfma_f32_32x32x16_bf16 v[24:39], v[48:51], v[40:43], v[24:39]
    ds_read_b128 v[40:43], v62 offset:49152
    ds_read_b64_tr_b16 v[48:49], v65 offset:61440
    ds_read_b64_tr_b16 v[50:51], v65 offset:61952
    s_waitcnt lgkmcnt(3)
    v_mfma_f32_32x32x16_bf16 v[24:39], v[52:55], v[44:47], v[24:39]
    ds_read_b128 v[44:47], v63 offset:49152
    ds_read_b64_tr_b16 v[52:53], v65 offset:63488
    ds_read_b64_tr_b16 v[54:55], v65 offset:64000
    s_waitcnt lgkmcnt(3)
    v_mfma_f32_32x32x16_bf16 v[24:39], v[48:51], v[40:43], v[24:39]
    s_waitcnt lgkmcnt(0)
    v_mfma_f32_32x32x16_bf16 v[24:39], v[52:55], v[44:47], v[24:39]
    s_waitcnt vmcnt(24)
    s_barrier
    s_add_u32 m0, s27, 114688
    s_add_u32 s26, s24, 0
    buffer_load_dwordx4 v10, s[4:7], s26 offen lds
    s_add_u32 m0, s27, 118784
    s_add_u32 s26, s24, 262144
    buffer_load_dwordx4 v10, s[4:7], s26 offen lds
    s_add_u32 m0, s27, 122880
    s_add_u32 s26, s25, 0
    buffer_load_dwordx4 v11, s[8:11], s26 offen lds
    s_add_u32 m0, s27, 126976
    s_add_u32 s26, s25, 32768
    buffer_load_dwordx4 v11, s[8:11], s26 offen lds
    s_add_u32 s24, s24, 128
    s_add_u32 s25, s25, 65536
    ds_read_b128 v[40:43], v56 offset:0
    ds_read_b64_tr_b16 v[48:49], v64 offset:8192
    ds_read_b64_tr_b16 v[50:51], v64 offset:8704
    ds_read_b128 v[44:47], v57 offset:0
    ds_read_b64_tr_b16 v[52:53], v64 offset:10240
    ds_read_b64_tr_b16 v[54:55], v64 offset:10752
    s_waitcnt lgkmcnt(3)
    v_mfma_f32_32x32x16_bf16 v[24:39], v[48:51], v[40:43], v[24:39]
    ds_read_b128 v[40:43], v58 offset:0
    ds_read_b64_tr_b16 v[48:49], v64 offset:12288
    ds_read_b64_tr_b16 v[50:51], v64 offset:12800
    s_waitcnt lgkmcnt(3)
    v_mfma_f32_32x32x16_bf16 v[24:39], v[52:55], v[44:47], v[24:39]
    ds_read_b128 v[44:47], v59 offset:0
    ds_read_b64_tr_b16 v[52:53], v64 offset:14336
    ds_read_b64_tr_b16 v[54:55], v64 offset:14848
    s_waitcnt lgkmcnt(3)
    v_mfma_f32_32x32x16_bf16 v[24:39], v[48:51], v[40:43], v[24:39]
    s_waitcnt lgkmcnt(0)
    v_mfma_f32_32x32x16_bf16 v[24:39], v[52:55], v[44:47], v[24:39]
    s_waitcnt vmcnt(24)
    s_barrier
    s_add_u32 m0, s27, 0
    s_add_u32 s26, s24, 0
    buffer_load_dwordx4 v10, s[4:7], s26 offen lds
    s_add_u32 m0, s27, 4096
    s_add_u32 s26, s24, 262144
    buffer_load_dwordx4 v10, s[4:7], s26 offen lds
    s_add_u32 m0, s27, 8192
    s_add_u32 s26, s25, 0
    buffer_load_dwordx4 v11, s[8:11], s26 offen lds
    s_add_u32 m0, s27, 12288
    s_add_u32 s26, s25, 32768
    buffer_load_dwordx4 v11, s[8:11], s26 offen lds
    s_add_u32 s24, s24, 128
    s_add_u32 s25, s25, 65536
    ds_read_b128 v[40:43], v56 offset:16384
    ds_read_b64_tr_b16 v[48:49], v64 offset:24576
    ds_read_b64_tr_b16 v[50:51], v64 offset:25088
    ds_read_b128 v[44:47], v57 offset:16384
    ds_read_b64_tr_b16 v[52:53], v64 offset:26624
    ds_read_b64_tr_b16 v[54:55], v64 offset:27136
    s_waitcnt lgkmcnt(3)
    v_mfma_f32_32x32x16_bf16 v[24:39], v[48:51], v[40:43], v[24:39]
    ds_read_b128 v[40:43], v58 offset:16384
    ds_read_b64_tr_b16 v[48:49], v64 offset:28672
    ds_read_b64_tr_b16 v[50:51], v64 offset:29184
    s_waitcnt lgkmcnt(3)
    v_mfma_f32_32x32x16_bf16 v[24:39], v[52:55], v[44:47], v[24:39]
    ds_read_b128 v[44:47], v59 offset:16384
    ds_read_b64_tr_b16 v[52:53], v64 offset:30720
    ds_read_b64_tr_b16 v[54:55], v64 offset:31232
    s_waitcnt lgkmcnt(3)
    v_mfma_f32_32x32x16_bf16 v[24:39], v[48:51], v[40:43], v[24:39]
    s_waitcnt lgkmcnt(0)
    v_mfma_f32_32x32x16_bf16 v[24:39], v[52:55], v[44:47], v[24:39]
    s_waitcnt vmcnt(24)
    s_barrier
    s_add_u32 m0, s27, 16384
    s_add_u32 s26, s24, 0
    buffer_load_dwordx4 v10, s[4:7], s26 offen lds
    s_add_u32 m0, s27, 20480
    s_add_u32 s26, s24, 262144
    buffer_load_dwordx4 v10, s[4:7], s26 offen lds
    s_add_u32 m0, s27, 24576
    s_add_u32 s26, s25, 0
    buffer_load_dwordx4 v11, s[8:11], s26 offen lds
    s_add_u32 m0, s27, 28672
    s_add_u32 s26, s25, 32768
    buffer_load_dwordx4 v11, s[8:11], s26 offen lds
    s_add_u32 s24, s24, 128
    s_add_u32 s25, s25, 65536
    ds_read_b128 v[40:43], v56 offset:32768
    ds_read_b64_tr_b16 v[48:49], v64 offset:40960
    ds_read_b64_tr_b16 v[50:51], v64 offset:41472
    ds_read_b128 v[44:47], v57 offset:32768
    ds_read_b64_tr_b16 v[52:53], v64 offset:43008
    ds_read_b64_tr_b16 v[54:55], v64 offset:43520
    s_waitcnt lgkmcnt(3)
    v_mfma_f32_32x32x16_bf16 v[24:39], v[48:51], v[40:43], v[24:39]
    ds_read_b128 v[40:43], v58 offset:32768
    ds_read_b64_tr_b16 v[48:49], v64 offset:45056
    ds_read_b64_tr_b16 v[50:51], v64 offset:45568
    s_waitcnt lgkmcnt(3)
    v_mfma_f32_32x32x16_bf16 v[24:39], v[52:55], v[44:47], v[24:39]
    ds_read_b128 v[44:47], v59 offset:32768
    ds_read_b64_tr_b16 v[52:53], v64 offset:47104
    ds_read_b64_tr_b16 v[54:55], v64 offset:47616
    s_waitcnt lgkmcnt(3)
    v_mfma_f32_32x32x16_bf16 v[24:39], v[48:51], v[40:43], v[24:39]
    s_waitcnt lgkmcnt(0)
    v_mfma_f32_32x32x16_bf16 v[24:39], v[52:55], v[44:47], v[24:39]
    s_waitcnt vmcnt(24)
    s_barrier
    s_add_u32 m0, s27, 32768
    s_add_u32 s26, s24, 0
    buffer_load_dwordx4 v10, s[4:7], s26 offen lds
    s_add_u32 m0, s27, 36864
    s_add_u32 s26, s24, 262144
    buffer_load_dwordx4 v10, s[4:7], s26 offen lds
    s_add_u32 m0, s27, 40960
    s_add_u32 s26, s25, 0
    buffer_load_dwordx4 v11, s[8:11], s26 offen lds
    s_add_u32 m0, s27, 45056
    s_add_u32 s26, s25, 32768
    buffer_load_dwordx4 v11, s[8:11], s26 offen lds
    s_add_u32 s24, s24, 128
    s_add_u32 s25, s25, 65536
    ds_read_b128 v[40:43], v56 offset:49152
    ds_read_b64_tr_b16 v[48:49], v64 offset:57344
    ds_read_b64_tr_b16 v[50:51], v64 offset:57856
    ds_read_b128 v[44:47], v57 offset:49152
    ds_read_b64_tr_b16 v[52:53], v64 offset:59392
    ds_read_b64_tr_b16 v[54:55], v64 offset:59904
    s_waitcnt lgkmcnt(3)
    v_mfma_f32_32x32x16_bf16 v[24:39], v[48:51], v[40:43], v[24:39]
    ds_read_b128 v[40:43], v58 offset:49152
    ds_read_b64_tr_b16 v[48:49], v64 offset:61440
    ds_read_b64_tr_b16 v[50:51], v64 offset:61952
    s_waitcnt lgkmcnt(3)
    v_mfma_f32_32x32x16_bf16 v[24:39], v[52:55], v[44:47], v[24:39]
    ds_read_b128 v[44:47], v59 offset:49152
    ds_read_b64_tr_b16 v[52:53], v64 offset:63488
    ds_read_b64_tr_b16 v[54:55], v64 offset:64000
    s_waitcnt lgkmcnt(3)
    v_mfma_f32_32x32x16_bf16 v[24:39], v[48:51], v[40:43], v[24:39]
    s_waitcnt lgkmcnt(0)
    v_mfma_f32_32x32x16_bf16 v[24:39], v[52:55], v[44:47], v[24:39]
    s_waitcnt vmcnt(24)
    s_barrier
    s_add_u32 m0, s27, 49152
    s_add_u32 s26, s24, 0
    buffer_load_dwordx4 v10, s[4:7], s26 offen lds
    s_add_u32 m0, s27, 53248
    s_add_u32 s26, s24, 262144
    buffer_load_dwordx4 v10, s[4:7], s26 offen lds
    s_add_u32 m0, s27, 57344
    s_add_u32 s26, s25, 0
    buffer_load_dwordx4 v11, s[8:11], s26 offen lds
    s_add_u32 m0, s27, 61440
    s_add_u32 s26, s25, 32768
    buffer_load_dwordx4 v11, s[8:11], s26 offen lds
    s_add_u32 s24, s24, 128
    s_add_u32 s25, s25, 65536
    ds_read_b128 v[40:43], v60 offset:0
    ds_read_b64_tr_b16 v[48:49], v65 offset:8192
    ds_read_b64_tr_b16 v[50:51], v65 offset:8704
    ds_read_b128 v[44:47], v61 offset:0
    ds_read_b64_tr_b16 v[52:53], v65 offset:10240
    ds_read_b64_tr_b16 v[54:55], v65 offset:10752
    s_waitcnt lgkmcnt(3)
    v_mfma_f32_32x32x16_bf16 v[24:39], v[48:51], v[40:43], v[24:39]
    ds_read_b128 v[40:43], v62 offset:0
    ds_read_b64_tr_b16 v[48:49], v65 offset:12288
    ds_read_b64_tr_b16 v[50:51], v65 offset:12800
    s_waitcnt lgkmcnt(3)
    v_mfma_f32_32x32x16_bf16 v[24:39], v[52:55], v[44:47], v[24:39]
    ds_read_b128 v[44:47], v63 offset:0
    ds_read_b64_tr_b16 v[52:53], v65 offset:14336
    ds_read_b64_tr_b16 v[54:55], v65 offset:14848
    s_waitcnt lgkmcnt(3)
    v_mfma_f32_32x32x16_bf16 v[24:39], v[48:51], v[40:43], v[24:39]
    s_waitcnt lgkmcnt(0)
    v_mfma_f32_32x32x16_bf16 v[24:39], v[52:55], v[44:47], v[24:39]
    s_waitcnt vmcnt(24)
    s_barrier
    s_add_u32 m0, s27, 65536
    s_add_u32 s26, s24, 0
    buffer_load_dwordx4 v10, s[4:7], s26 offen lds
    s_add_u32 m0, s27, 69632
    s_add_u32 s26, s24, 262144
    buffer_load_dwordx4 v10, s[4:7], s26 offen lds
    s_add_u32 m0, s27, 73728
    s_add_u32 s26, s25, 0
    buffer_load_dwordx4 v11, s[8:11], s26 offen lds
    s_add_u32 m0, s27, 77824
    s_add_u32 s26, s25, 32768
    buffer_load_dwordx4 v11, s[8:11], s26 offen lds
    s_add_u32 s24, s24, 128
    s_add_u32 s25, s25, 65536
    ds_read_b128 v[40:43], v60 offset:16384
    ds_read_b64_tr_b16 v[48:49], v65 offset:24576
    ds_read_b64_tr_b16 v[50:51], v65 offset:25088
    ds_read_b128 v[44:47], v61 offset:16384
    ds_read_b64_tr_b16 v[52:53], v65 offset:26624
    ds_read_b64_tr_b16 v[54:55], v65 offset:27136
    s_waitcnt lgkmcnt(3)
    v_mfma_f32_32x32x16_bf16 v[24:39], v[48:51], v[40:43], v[24:39]
    ds_read_b128 v[40:43], v62 offset:16384
    ds_read_b64_tr_b16 v[48:49], v65 offset:28672
    ds_read_b64_tr_b16 v[50:51], v65 offset:29184
    s_waitcnt lgkmcnt(3)
    v_mfma_f32_32x32x16_bf16 v[24:39], v[52:55], v[44:47], v[24:39]
    ds_read_b128 v[44:47], v63 offset:16384
    ds_read_b64_tr_b16 v[52:53], v65 offset:30720
    ds_read_b64_tr_b16 v[54:55], v65 offset:31232
    s_waitcnt lgkmcnt(3)
    v_mfma_f32_32x32x16_bf16 v[24:39], v[48:51], v[40:43], v[24:39]
    s_waitcnt lgkmcnt(0)
    v_mfma_f32_32x32x16_bf16 v[24:39], v[52:55], v[44:47], v[24:39]
    s_waitcnt vmcnt(24)
    s_barrier
    s_add_u32 m0, s27, 81920
    s_add_u32 s26, s24, 0
    buffer_load_dwordx4 v10, s[4:7], s26 offen lds
    s_add_u32 m0, s27, 86016
    s_add_u32 s26, s24, 262144
    buffer_load_dwordx4 v10, s[4:7], s26 offen lds
    s_add_u32 m0, s27, 90112
    s_add_u32 s26, s25, 0
    buffer_load_dwordx4 v11, s[8:11], s26 offen lds
    s_add_u32 m0, s27, 94208
    s_add_u32 s26, s25, 32768
    buffer_load_dwordx4 v11, s[8:11], s26 offen lds
    s_add_u32 s24, s24, 128
    s_add_u32 s25, s25, 65536
    ds_read_b128 v[40:43], v60 offset:32768
    ds_read_b64_tr_b16 v[48:49], v65 offset:40960
    ds_read_b64_tr_b16 v[50:51], v65 offset:41472
    ds_read_b128 v[44:47], v61 offset:32768
    ds_read_b64_tr_b16 v[52:53], v65 offset:43008
    ds_read_b64_tr_b16 v[54:55], v65 offset:43520
    s_waitcnt lgkmcnt(3)
    v_mfma_f32_32x32x16_bf16 v[24:39], v[48:51], v[40:43], v[24:39]
    ds_read_b128 v[40:43], v62 offset:32768
    ds_read_b64_tr_b16 v[48:49], v65 offset:45056
    ds_read_b64_tr_b16 v[50:51], v65 offset:45568
    s_waitcnt lgkmcnt(3)
    v_mfma_f32_32x32x16_bf16 v[24:39], v[52:55], v[44:47], v[24:39]
    ds_read_b128 v[44:47], v63 offset:32768
    ds_read_b64_tr_b16 v[52:53], v65 offset:47104
    ds_read_b64_tr_b16 v[54:55], v65 offset:47616
    s_waitcnt lgkmcnt(3)
    v_mfma_f32_32x32x16_bf16 v[24:39], v[48:51], v[40:43], v[24:39]
    s_waitcnt lgkmcnt(0)
    v_mfma_f32_32x32x16_bf16 v[24:39], v[52:55], v[44:47], v[24:39]
    s_waitcnt vmcnt(24)
    s_barrier
    s_add_u32 m0, s27, 98304
    s_add_u32 s26, s24, 0
    buffer_load_dwordx4 v10, s[4:7], s26 offen lds
    s_add_u32 m0, s27, 102400
    s_add_u32 s26, s24, 262144
    buffer_load_dwordx4 v10, s[4:7], s26 offen lds
    s_add_u32 m0, s27, 106496
    s_add_u32 s26, s25, 0
    buffer_load_dwordx4 v11, s[8:11], s26 offen lds
    s_add_u32 m0, s27, 110592
    s_add_u32 s26, s25, 32768
    buffer_load_dwordx4 v11, s[8:11], s26 offen lds
    s_add_u32 s24, s24, 128
    s_add_u32 s25, s25, 65536
    ds_read_b128 v[40:43], v60 offset:49152
    ds_read_b64_tr_b16 v[48:49], v65 offset:57344
    ds_read_b64_tr_b16 v[50:51], v65 offset:57856
    ds_read_b128 v[44:47], v61 offset:49152
    ds_read_b64_tr_b16 v[52:53], v65 offset:59392
    ds_read_b64_tr_b16 v[54:55], v65 offset:59904
    s_waitcnt lgkmcnt(3)
    v_mfma_f32_32x32x16_bf16 v[24:39], v[48:51], v[40:43], v[24:39]
    ds_read_b128 v[40:43], v62 offset:49152
    ds_read_b64_tr_b16 v[48:49], v65 offset:61440
    ds_read_b64_tr_b16 v[50:51], v65 offset:61952
    s_waitcnt lgkmcnt(3)
    v_mfma_f32_32x32x16_bf16 v[24:39], v[52:55], v[44:47], v[24:39]
    ds_read_b128 v[44:47], v63 offset:49152
    ds_read_b64_tr_b16 v[52:53], v65 offset:63488
    ds_read_b64_tr_b16 v[54:55], v65 offset:64000
    s_waitcnt lgkmcnt(3)
    v_mfma_f32_32x32x16_bf16 v[24:39], v[48:51], v[40:43], v[24:39]
    s_waitcnt lgkmcnt(0)
    v_mfma_f32_32x32x16_bf16 v[24:39], v[52:55], v[44:47], v[24:39]
    s_waitcnt vmcnt(24)
    s_barrier
    s_add_u32 m0, s27, 114688
    s_add_u32 s26, s24, 0
    buffer_load_dwordx4 v10, s[4:7], s26 offen lds
    s_add_u32 m0, s27, 118784
    s_add_u32 s26, s24, 262144
    buffer_load_dwordx4 v10, s[4:7], s26 offen lds
    s_add_u32 m0, s27, 122880
    s_add_u32 s26, s25, 0
    buffer_load_dwordx4 v11, s[8:11], s26 offen lds
    s_add_u32 m0, s27, 126976
    s_add_u32 s26, s25, 32768
    buffer_load_dwordx4 v11, s[8:11], s26 offen lds
    s_add_u32 s24, s24, 128
    s_add_u32 s25, s25, 65536
    ds_read_b128 v[40:43], v56 offset:0
    ds_read_b64_tr_b16 v[48:49], v64 offset:8192
    ds_read_b64_tr_b16 v[50:51], v64 offset:8704
    ds_read_b128 v[44:47], v57 offset:0
    ds_read_b64_tr_b16 v[52:53], v64 offset:10240
    ds_read_b64_tr_b16 v[54:55], v64 offset:10752
    s_waitcnt lgkmcnt(3)
    v_mfma_f32_32x32x16_bf16 v[24:39], v[48:51], v[40:43], v[24:39]
    ds_read_b128 v[40:43], v58 offset:0
    ds_read_b64_tr_b16 v[48:49], v64 offset:12288
    ds_read_b64_tr_b16 v[50:51], v64 offset:12800
    s_waitcnt lgkmcnt(3)
    v_mfma_f32_32x32x16_bf16 v[24:39], v[52:55], v[44:47], v[24:39]
    ds_read_b128 v[44:47], v59 offset:0
    ds_read_b64_tr_b16 v[52:53], v64 offset:14336
    ds_read_b64_tr_b16 v[54:55], v64 offset:14848
    s_waitcnt lgkmcnt(3)
    v_mfma_f32_32x32x16_bf16 v[24:39], v[48:51], v[40:43], v[24:39]
    s_waitcnt lgkmcnt(0)
    v_mfma_f32_32x32x16_bf16 v[24:39], v[52:55], v[44:47], v[24:39]
    s_waitcnt vmcnt(24)
    s_barrier
    s_add_u32 m0, s27, 0
    s_add_u32 s26, s24, 0
    buffer_load_dwordx4 v10, s[4:7], s26 offen lds
    s_add_u32 m0, s27, 4096
    s_add_u32 s26, s24, 262144
    buffer_load_dwordx4 v10, s[4:7], s26 offen lds
    s_add_u32 m0, s27, 8192
    s_add_u32 s26, s25, 0
    buffer_load_dwordx4 v11, s[8:11], s26 offen lds
    s_add_u32 m0, s27, 12288
    s_add_u32 s26, s25, 32768
    buffer_load_dwordx4 v11, s[8:11], s26 offen lds
    s_add_u32 s24, s24, 128
    s_add_u32 s25, s25, 65536
    ds_read_b128 v[40:43], v56 offset:16384
    ds_read_b64_tr_b16 v[48:49], v64 offset:24576
    ds_read_b64_tr_b16 v[50:51], v64 offset:25088
    ds_read_b128 v[44:47], v57 offset:16384
    ds_read_b64_tr_b16 v[52:53], v64 offset:26624
    ds_read_b64_tr_b16 v[54:55], v64 offset:27136
    s_waitcnt lgkmcnt(3)
    v_mfma_f32_32x32x16_bf16 v[24:39], v[48:51], v[40:43], v[24:39]
    ds_read_b128 v[40:43], v58 offset:16384
    ds_read_b64_tr_b16 v[48:49], v64 offset:28672
    ds_read_b64_tr_b16 v[50:51], v64 offset:29184
    s_waitcnt lgkmcnt(3)
    v_mfma_f32_32x32x16_bf16 v[24:39], v[52:55], v[44:47], v[24:39]
    ds_read_b128 v[44:47], v59 offset:16384
    ds_read_b64_tr_b16 v[52:53], v64 offset:30720
    ds_read_b64_tr_b16 v[54:55], v64 offset:31232
    s_waitcnt lgkmcnt(3)
    v_mfma_f32_32x32x16_bf16 v[24:39], v[48:51], v[40:43], v[24:39]
    s_waitcnt lgkmcnt(0)
    v_mfma_f32_32x32x16_bf16 v[24:39], v[52:55], v[44:47], v[24:39]
    s_waitcnt vmcnt(24)
    s_barrier
    s_add_u32 m0, s27, 16384
    s_add_u32 s26, s24, 0
    buffer_load_dwordx4 v10, s[4:7], s26 offen lds
    s_add_u32 m0, s27, 20480
    s_add_u32 s26, s24, 262144
    buffer_load_dwordx4 v10, s[4:7], s26 offen lds
    s_add_u32 m0, s27, 24576
    s_add_u32 s26, s25, 0
    buffer_load_dwordx4 v11, s[8:11], s26 offen lds
    s_add_u32 m0, s27, 28672
    s_add_u32 s26, s25, 32768
    buffer_load_dwordx4 v11, s[8:11], s26 offen lds
    s_add_u32 s24, s24, 128
    s_add_u32 s25, s25, 65536
    ds_read_b128 v[40:43], v56 offset:32768
    ds_read_b64_tr_b16 v[48:49], v64 offset:40960
    ds_read_b64_tr_b16 v[50:51], v64 offset:41472
    ds_read_b128 v[44:47], v57 offset:32768
    ds_read_b64_tr_b16 v[52:53], v64 offset:43008
    ds_read_b64_tr_b16 v[54:55], v64 offset:43520
    s_waitcnt lgkmcnt(3)
    v_mfma_f32_32x32x16_bf16 v[24:39], v[48:51], v[40:43], v[24:39]
    ds_read_b128 v[40:43], v58 offset:32768
    ds_read_b64_tr_b16 v[48:49], v64 offset:45056
    ds_read_b64_tr_b16 v[50:51], v64 offset:45568
    s_waitcnt lgkmcnt(3)
    v_mfma_f32_32x32x16_bf16 v[24:39], v[52:55], v[44:47], v[24:39]
    ds_read_b128 v[44:47], v59 offset:32768
    ds_read_b64_tr_b16 v[52:53], v64 offset:47104
    ds_read_b64_tr_b16 v[54:55], v64 offset:47616
    s_waitcnt lgkmcnt(3)
    v_mfma_f32_32x32x16_bf16 v[24:39], v[48:51], v[40:43], v[24:39]
    s_waitcnt lgkmcnt(0)
    v_mfma_f32_32x32x16_bf16 v[24:39], v[52:55], v[44:47], v[24:39]
    s_waitcnt vmcnt(24)
    s_barrier
    s_add_u32 m0, s27, 32768
    s_add_u32 s26, s24, 0
    buffer_load_dwordx4 v10, s[4:7], s26 offen lds
    s_add_u32 m0, s27, 36864
    s_add_u32 s26, s24, 262144
    buffer_load_dwordx4 v10, s[4:7], s26 offen lds
    s_add_u32 m0, s27, 40960
    s_add_u32 s26, s25, 0
    buffer_load_dwordx4 v11, s[8:11], s26 offen lds
    s_add_u32 m0, s27, 45056
    s_add_u32 s26, s25, 32768
    buffer_load_dwordx4 v11, s[8:11], s26 offen lds
    s_add_u32 s24, s24, 128
    s_add_u32 s25, s25, 65536
    ds_read_b128 v[40:43], v56 offset:49152
    ds_read_b64_tr_b16 v[48:49], v64 offset:57344
    ds_read_b64_tr_b16 v[50:51], v64 offset:57856
    ds_read_b128 v[44:47], v57 offset:49152
    ds_read_b64_tr_b16 v[52:53], v64 offset:59392
    ds_read_b64_tr_b16 v[54:55], v64 offset:59904
    s_waitcnt lgkmcnt(3)
    v_mfma_f32_32x32x16_bf16 v[24:39], v[48:51], v[40:43], v[24:39]
    ds_read_b128 v[40:43], v58 offset:49152
    ds_read_b64_tr_b16 v[48:49], v64 offset:61440
    ds_read_b64_tr_b16 v[50:51], v64 offset:61952
    s_waitcnt lgkmcnt(3)
    v_mfma_f32_32x32x16_bf16 v[24:39], v[52:55], v[44:47], v[24:39]
    ds_read_b128 v[44:47], v59 offset:49152
    ds_read_b64_tr_b16 v[52:53], v64 offset:63488
    ds_read_b64_tr_b16 v[54:55], v64 offset:64000
    s_waitcnt lgkmcnt(3)
    v_mfma_f32_32x32x16_bf16 v[24:39], v[48:51], v[40:43], v[24:39]
    s_waitcnt lgkmcnt(0)
    v_mfma_f32_32x32x16_bf16 v[24:39], v[52:55], v[44:47], v[24:39]
    s_waitcnt vmcnt(24)
    s_barrier
    s_add_u32 m0, s27, 49152
    s_add_u32 s26, s24, 0
    buffer_load_dwordx4 v10, s[4:7], s26 offen lds
    s_add_u32 m0, s27, 53248
    s_add_u32 s26, s24, 262144
    buffer_load_dwordx4 v10, s[4:7], s26 offen lds
    s_add_u32 m0, s27, 57344
    s_add_u32 s26, s25, 0
    buffer_load_dwordx4 v11, s[8:11], s26 offen lds
    s_add_u32 m0, s27, 61440
    s_add_u32 s26, s25, 32768
    buffer_load_dwordx4 v11, s[8:11], s26 offen lds
    s_add_u32 s24, s24, 128
    s_add_u32 s25, s25, 65536
    ds_read_b128 v[40:43], v60 offset:0
    ds_read_b64_tr_b16 v[48:49], v65 offset:8192
    ds_read_b64_tr_b16 v[50:51], v65 offset:8704
    ds_read_b128 v[44:47], v61 offset:0
    ds_read_b64_tr_b16 v[52:53], v65 offset:10240
    ds_read_b64_tr_b16 v[54:55], v65 offset:10752
    s_waitcnt lgkmcnt(3)
    v_mfma_f32_32x32x16_bf16 v[24:39], v[48:51], v[40:43], v[24:39]
    ds_read_b128 v[40:43], v62 offset:0
    ds_read_b64_tr_b16 v[48:49], v65 offset:12288
    ds_read_b64_tr_b16 v[50:51], v65 offset:12800
    s_waitcnt lgkmcnt(3)
    v_mfma_f32_32x32x16_bf16 v[24:39], v[52:55], v[44:47], v[24:39]
    ds_read_b128 v[44:47], v63 offset:0
    ds_read_b64_tr_b16 v[52:53], v65 offset:14336
    ds_read_b64_tr_b16 v[54:55], v65 offset:14848
    s_waitcnt lgkmcnt(3)
    v_mfma_f32_32x32x16_bf16 v[24:39], v[48:51], v[40:43], v[24:39]
    s_waitcnt lgkmcnt(0)
    v_mfma_f32_32x32x16_bf16 v[24:39], v[52:55], v[44:47], v[24:39]
    s_waitcnt vmcnt(24)
    s_barrier
    s_add_u32 m0, s27, 65536
    s_add_u32 s26, s24, 0
    buffer_load_dwordx4 v10, s[4:7], s26 offen lds
    s_add_u32 m0, s27, 69632
    s_add_u32 s26, s24, 262144
    buffer_load_dwordx4 v10, s[4:7], s26 offen lds
    s_add_u32 m0, s27, 73728
    s_add_u32 s26, s25, 0
    buffer_load_dwordx4 v11, s[8:11], s26 offen lds
    s_add_u32 m0, s27, 77824
    s_add_u32 s26, s25, 32768
    buffer_load_dwordx4 v11, s[8:11], s26 offen lds
    s_add_u32 s24, s24, 128
    s_add_u32 s25, s25, 65536
    ds_read_b128 v[40:43], v60 offset:16384
    ds_read_b64_tr_b16 v[48:49], v65 offset:24576
    ds_read_b64_tr_b16 v[50:51], v65 offset:25088
    ds_read_b128 v[44:47], v61 offset:16384
    ds_read_b64_tr_b16 v[52:53], v65 offset:26624
    ds_read_b64_tr_b16 v[54:55], v65 offset:27136
    s_waitcnt lgkmcnt(3)
    v_mfma_f32_32x32x16_bf16 v[24:39], v[48:51], v[40:43], v[24:39]
    ds_read_b128 v[40:43], v62 offset:16384
    ds_read_b64_tr_b16 v[48:49], v65 offset:28672
    ds_read_b64_tr_b16 v[50:51], v65 offset:29184
    s_waitcnt lgkmcnt(3)
    v_mfma_f32_32x32x16_bf16 v[24:39], v[52:55], v[44:47], v[24:39]
    ds_read_b128 v[44:47], v63 offset:16384
    ds_read_b64_tr_b16 v[52:53], v65 offset:30720
    ds_read_b64_tr_b16 v[54:55], v65 offset:31232
    s_waitcnt lgkmcnt(3)
    v_mfma_f32_32x32x16_bf16 v[24:39], v[48:51], v[40:43], v[24:39]
    s_waitcnt lgkmcnt(0)
    v_mfma_f32_32x32x16_bf16 v[24:39], v[52:55], v[44:47], v[24:39]
    s_waitcnt vmcnt(24)
    s_barrier
    s_add_u32 m0, s27, 81920
    s_add_u32 s26, s24, 0
    buffer_load_dwordx4 v10, s[4:7], s26 offen lds
    s_add_u32 m0, s27, 86016
    s_add_u32 s26, s24, 262144
    buffer_load_dwordx4 v10, s[4:7], s26 offen lds
    s_add_u32 m0, s27, 90112
    s_add_u32 s26, s25, 0
    buffer_load_dwordx4 v11, s[8:11], s26 offen lds
    s_add_u32 m0, s27, 94208
    s_add_u32 s26, s25, 32768
    buffer_load_dwordx4 v11, s[8:11], s26 offen lds
    s_add_u32 s24, s24, 128
    s_add_u32 s25, s25, 65536
    ds_read_b128 v[40:43], v60 offset:32768
    ds_read_b64_tr_b16 v[48:49], v65 offset:40960
    ds_read_b64_tr_b16 v[50:51], v65 offset:41472
    ds_read_b128 v[44:47], v61 offset:32768
    ds_read_b64_tr_b16 v[52:53], v65 offset:43008
    ds_read_b64_tr_b16 v[54:55], v65 offset:43520
    s_waitcnt lgkmcnt(3)
    v_mfma_f32_32x32x16_bf16 v[24:39], v[48:51], v[40:43], v[24:39]
    ds_read_b128 v[40:43], v62 offset:32768
    ds_read_b64_tr_b16 v[48:49], v65 offset:45056
    ds_read_b64_tr_b16 v[50:51], v65 offset:45568
    s_waitcnt lgkmcnt(3)
    v_mfma_f32_32x32x16_bf16 v[24:39], v[52:55], v[44:47], v[24:39]
    ds_read_b128 v[44:47], v63 offset:32768
    ds_read_b64_tr_b16 v[52:53], v65 offset:47104
    ds_read_b64_tr_b16 v[54:55], v65 offset:47616
    s_waitcnt lgkmcnt(3)
    v_mfma_f32_32x32x16_bf16 v[24:39], v[48:51], v[40:43], v[24:39]
    s_waitcnt lgkmcnt(0)
    v_mfma_f32_32x32x16_bf16 v[24:39], v[52:55], v[44:47], v[24:39]
    s_waitcnt vmcnt(24)
    s_barrier
    s_add_u32 m0, s27, 98304
    s_add_u32 s26, s24, 0
    buffer_load_dwordx4 v10, s[4:7], s26 offen lds
    s_add_u32 m0, s27, 102400
    s_add_u32 s26, s24, 262144
    buffer_load_dwordx4 v10, s[4:7], s26 offen lds
    s_add_u32 m0, s27, 106496
    s_add_u32 s26, s25, 0
    buffer_load_dwordx4 v11, s[8:11], s26 offen lds
    s_add_u32 m0, s27, 110592
    s_add_u32 s26, s25, 32768
    buffer_load_dwordx4 v11, s[8:11], s26 offen lds
    s_add_u32 s24, s24, 128
    s_add_u32 s25, s25, 65536
    ds_read_b128 v[40:43], v60 offset:49152
    ds_read_b64_tr_b16 v[48:49], v65 offset:57344
    ds_read_b64_tr_b16 v[50:51], v65 offset:57856
    ds_read_b128 v[44:47], v61 offset:49152
    ds_read_b64_tr_b16 v[52:53], v65 offset:59392
    ds_read_b64_tr_b16 v[54:55], v65 offset:59904
    s_waitcnt lgkmcnt(3)
    v_mfma_f32_32x32x16_bf16 v[24:39], v[48:51], v[40:43], v[24:39]
    ds_read_b128 v[40:43], v62 offset:49152
    ds_read_b64_tr_b16 v[48:49], v65 offset:61440
    ds_read_b64_tr_b16 v[50:51], v65 offset:61952
    s_waitcnt lgkmcnt(3)
    v_mfma_f32_32x32x16_bf16 v[24:39], v[52:55], v[44:47], v[24:39]
    ds_read_b128 v[44:47], v63 offset:49152
    ds_read_b64_tr_b16 v[52:53], v65 offset:63488
    ds_read_b64_tr_b16 v[54:55], v65 offset:64000
    s_waitcnt lgkmcnt(3)
    v_mfma_f32_32x32x16_bf16 v[24:39], v[48:51], v[40:43], v[24:39]
    s_waitcnt lgkmcnt(0)
    v_mfma_f32_32x32x16_bf16 v[24:39], v[52:55], v[44:47], v[24:39]
    s_waitcnt vmcnt(24)
    s_barrier
    s_add_u32 m0, s27, 114688
    s_add_u32 s26, s24, 0
    buffer_load_dwordx4 v10, s[4:7], s26 offen lds
    s_add_u32 m0, s27, 118784
    s_add_u32 s26, s24, 262144
    buffer_load_dwordx4 v10, s[4:7], s26 offen lds
    s_add_u32 m0, s27, 122880
    s_add_u32 s26, s25, 0
    buffer_load_dwordx4 v11, s[8:11], s26 offen lds
    s_add_u32 m0, s27, 126976
    s_add_u32 s26, s25, 32768
    buffer_load_dwordx4 v11, s[8:11], s26 offen lds
    s_add_u32 s24, s24, 128
    s_add_u32 s25, s25, 65536
    ds_read_b128 v[40:43], v56 offset:0
    ds_read_b64_tr_b16 v[48:49], v64 offset:8192
    ds_read_b64_tr_b16 v[50:51], v64 offset:8704
    ds_read_b128 v[44:47], v57 offset:0
    ds_read_b64_tr_b16 v[52:53], v64 offset:10240
    ds_read_b64_tr_b16 v[54:55], v64 offset:10752
    s_waitcnt lgkmcnt(3)
    v_mfma_f32_32x32x16_bf16 v[24:39], v[48:51], v[40:43], v[24:39]
    ds_read_b128 v[40:43], v58 offset:0
    ds_read_b64_tr_b16 v[48:49], v64 offset:12288
    ds_read_b64_tr_b16 v[50:51], v64 offset:12800
    s_waitcnt lgkmcnt(3)
    v_mfma_f32_32x32x16_bf16 v[24:39], v[52:55], v[44:47], v[24:39]
    ds_read_b128 v[44:47], v59 offset:0
    ds_read_b64_tr_b16 v[52:53], v64 offset:14336
    ds_read_b64_tr_b16 v[54:55], v64 offset:14848
    s_waitcnt lgkmcnt(3)
    v_mfma_f32_32x32x16_bf16 v[24:39], v[48:51], v[40:43], v[24:39]
    s_waitcnt lgkmcnt(0)
    v_mfma_f32_32x32x16_bf16 v[24:39], v[52:55], v[44:47], v[24:39]
    s_waitcnt vmcnt(24)
    s_barrier
    s_add_u32 m0, s27, 0
    s_add_u32 s26, s24, 0
    buffer_load_dwordx4 v10, s[4:7], s26 offen lds
    s_add_u32 m0, s27, 4096
    s_add_u32 s26, s24, 262144
    buffer_load_dwordx4 v10, s[4:7], s26 offen lds
    s_add_u32 m0, s27, 8192
    s_add_u32 s26, s25, 0
    buffer_load_dwordx4 v11, s[8:11], s26 offen lds
    s_add_u32 m0, s27, 12288
    s_add_u32 s26, s25, 32768
    buffer_load_dwordx4 v11, s[8:11], s26 offen lds
    s_add_u32 s24, s24, 128
    s_add_u32 s25, s25, 65536
    ds_read_b128 v[40:43], v56 offset:16384
    ds_read_b64_tr_b16 v[48:49], v64 offset:24576
    ds_read_b64_tr_b16 v[50:51], v64 offset:25088
    ds_read_b128 v[44:47], v57 offset:16384
    ds_read_b64_tr_b16 v[52:53], v64 offset:26624
    ds_read_b64_tr_b16 v[54:55], v64 offset:27136
    s_waitcnt lgkmcnt(3)
    v_mfma_f32_32x32x16_bf16 v[24:39], v[48:51], v[40:43], v[24:39]
    ds_read_b128 v[40:43], v58 offset:16384
    ds_read_b64_tr_b16 v[48:49], v64 offset:28672
    ds_read_b64_tr_b16 v[50:51], v64 offset:29184
    s_waitcnt lgkmcnt(3)
    v_mfma_f32_32x32x16_bf16 v[24:39], v[52:55], v[44:47], v[24:39]
    ds_read_b128 v[44:47], v59 offset:16384
    ds_read_b64_tr_b16 v[52:53], v64 offset:30720
    ds_read_b64_tr_b16 v[54:55], v64 offset:31232
    s_waitcnt lgkmcnt(3)
    v_mfma_f32_32x32x16_bf16 v[24:39], v[48:51], v[40:43], v[24:39]
    s_waitcnt lgkmcnt(0)
    v_mfma_f32_32x32x16_bf16 v[24:39], v[52:55], v[44:47], v[24:39]
    s_waitcnt vmcnt(24)
    s_barrier
    s_add_u32 m0, s27, 16384
    s_add_u32 s26, s24, 0
    buffer_load_dwordx4 v10, s[4:7], s26 offen lds
    s_add_u32 m0, s27, 20480
    s_add_u32 s26, s24, 262144
    buffer_load_dwordx4 v10, s[4:7], s26 offen lds
    s_add_u32 m0, s27, 24576
    s_add_u32 s26, s25, 0
    buffer_load_dwordx4 v11, s[8:11], s26 offen lds
    s_add_u32 m0, s27, 28672
    s_add_u32 s26, s25, 32768
    buffer_load_dwordx4 v11, s[8:11], s26 offen lds
    s_add_u32 s24, s24, 128
    s_add_u32 s25, s25, 65536
    ds_read_b128 v[40:43], v56 offset:32768
    ds_read_b64_tr_b16 v[48:49], v64 offset:40960
    ds_read_b64_tr_b16 v[50:51], v64 offset:41472
    ds_read_b128 v[44:47], v57 offset:32768
    ds_read_b64_tr_b16 v[52:53], v64 offset:43008
    ds_read_b64_tr_b16 v[54:55], v64 offset:43520
    s_waitcnt lgkmcnt(3)
    v_mfma_f32_32x32x16_bf16 v[24:39], v[48:51], v[40:43], v[24:39]
    ds_read_b128 v[40:43], v58 offset:32768
    ds_read_b64_tr_b16 v[48:49], v64 offset:45056
    ds_read_b64_tr_b16 v[50:51], v64 offset:45568
    s_waitcnt lgkmcnt(3)
    v_mfma_f32_32x32x16_bf16 v[24:39], v[52:55], v[44:47], v[24:39]
    ds_read_b128 v[44:47], v59 offset:32768
    ds_read_b64_tr_b16 v[52:53], v64 offset:47104
    ds_read_b64_tr_b16 v[54:55], v64 offset:47616
    s_waitcnt lgkmcnt(3)
    v_mfma_f32_32x32x16_bf16 v[24:39], v[48:51], v[40:43], v[24:39]
    s_waitcnt lgkmcnt(0)
    v_mfma_f32_32x32x16_bf16 v[24:39], v[52:55], v[44:47], v[24:39]
    s_waitcnt vmcnt(24)
    s_barrier
    s_add_u32 m0, s27, 32768
    s_add_u32 s26, s24, 0
    buffer_load_dwordx4 v10, s[4:7], s26 offen lds
    s_add_u32 m0, s27, 36864
    s_add_u32 s26, s24, 262144
    buffer_load_dwordx4 v10, s[4:7], s26 offen lds
    s_add_u32 m0, s27, 40960
    s_add_u32 s26, s25, 0
    buffer_load_dwordx4 v11, s[8:11], s26 offen lds
    s_add_u32 m0, s27, 45056
    s_add_u32 s26, s25, 32768
    buffer_load_dwordx4 v11, s[8:11], s26 offen lds
    s_add_u32 s24, s24, 128
    s_add_u32 s25, s25, 65536
    ds_read_b128 v[40:43], v56 offset:49152
    ds_read_b64_tr_b16 v[48:49], v64 offset:57344
    ds_read_b64_tr_b16 v[50:51], v64 offset:57856
    ds_read_b128 v[44:47], v57 offset:49152
    ds_read_b64_tr_b16 v[52:53], v64 offset:59392
    ds_read_b64_tr_b16 v[54:55], v64 offset:59904
    s_waitcnt lgkmcnt(3)
    v_mfma_f32_32x32x16_bf16 v[24:39], v[48:51], v[40:43], v[24:39]
    ds_read_b128 v[40:43], v58 offset:49152
    ds_read_b64_tr_b16 v[48:49], v64 offset:61440
    ds_read_b64_tr_b16 v[50:51], v64 offset:61952
    s_waitcnt lgkmcnt(3)
    v_mfma_f32_32x32x16_bf16 v[24:39], v[52:55], v[44:47], v[24:39]
    ds_read_b128 v[44:47], v59 offset:49152
    ds_read_b64_tr_b16 v[52:53], v64 offset:63488
    ds_read_b64_tr_b16 v[54:55], v64 offset:64000
    s_waitcnt lgkmcnt(3)
    v_mfma_f32_32x32x16_bf16 v[24:39], v[48:51], v[40:43], v[24:39]
    s_waitcnt lgkmcnt(0)
    v_mfma_f32_32x32x16_bf16 v[24:39], v[52:55], v[44:47], v[24:39]
    s_waitcnt vmcnt(24)
    s_barrier
    s_add_u32 m0, s27, 49152
    s_add_u32 s26, s24, 0
    buffer_load_dwordx4 v10, s[4:7], s26 offen lds
    s_add_u32 m0, s27, 53248
    s_add_u32 s26, s24, 262144
    buffer_load_dwordx4 v10, s[4:7], s26 offen lds
    s_add_u32 m0, s27, 57344
    s_add_u32 s26, s25, 0
    buffer_load_dwordx4 v11, s[8:11], s26 offen lds
    s_add_u32 m0, s27, 61440
    s_add_u32 s26, s25, 32768
    buffer_load_dwordx4 v11, s[8:11], s26 offen lds
    s_add_u32 s24, s24, 128
    s_add_u32 s25, s25, 65536
    ds_read_b128 v[40:43], v60 offset:0
    ds_read_b64_tr_b16 v[48:49], v65 offset:8192
    ds_read_b64_tr_b16 v[50:51], v65 offset:8704
    ds_read_b128 v[44:47], v61 offset:0
    ds_read_b64_tr_b16 v[52:53], v65 offset:10240
    ds_read_b64_tr_b16 v[54:55], v65 offset:10752
    s_waitcnt lgkmcnt(3)
    v_mfma_f32_32x32x16_bf16 v[24:39], v[48:51], v[40:43], v[24:39]
    ds_read_b128 v[40:43], v62 offset:0
    ds_read_b64_tr_b16 v[48:49], v65 offset:12288
    ds_read_b64_tr_b16 v[50:51], v65 offset:12800
    s_waitcnt lgkmcnt(3)
    v_mfma_f32_32x32x16_bf16 v[24:39], v[52:55], v[44:47], v[24:39]
    ds_read_b128 v[44:47], v63 offset:0
    ds_read_b64_tr_b16 v[52:53], v65 offset:14336
    ds_read_b64_tr_b16 v[54:55], v65 offset:14848
    s_waitcnt lgkmcnt(3)
    v_mfma_f32_32x32x16_bf16 v[24:39], v[48:51], v[40:43], v[24:39]
    s_waitcnt lgkmcnt(0)
    v_mfma_f32_32x32x16_bf16 v[24:39], v[52:55], v[44:47], v[24:39]
    s_waitcnt vmcnt(24)
    s_barrier
    s_add_u32 m0, s27, 65536
    s_add_u32 s26, s24, 0
    buffer_load_dwordx4 v10, s[4:7], s26 offen lds
    s_add_u32 m0, s27, 69632
    s_add_u32 s26, s24, 262144
    buffer_load_dwordx4 v10, s[4:7], s26 offen lds
    s_add_u32 m0, s27, 73728
    s_add_u32 s26, s25, 0
    buffer_load_dwordx4 v11, s[8:11], s26 offen lds
    s_add_u32 m0, s27, 77824
    s_add_u32 s26, s25, 32768
    buffer_load_dwordx4 v11, s[8:11], s26 offen lds
    s_add_u32 s24, s24, 128
    s_add_u32 s25, s25, 65536
    ds_read_b128 v[40:43], v60 offset:16384
    ds_read_b64_tr_b16 v[48:49], v65 offset:24576
    ds_read_b64_tr_b16 v[50:51], v65 offset:25088
    ds_read_b128 v[44:47], v61 offset:16384
    ds_read_b64_tr_b16 v[52:53], v65 offset:26624
    ds_read_b64_tr_b16 v[54:55], v65 offset:27136
    s_waitcnt lgkmcnt(3)
    v_mfma_f32_32x32x16_bf16 v[24:39], v[48:51], v[40:43], v[24:39]
    ds_read_b128 v[40:43], v62 offset:16384
    ds_read_b64_tr_b16 v[48:49], v65 offset:28672
    ds_read_b64_tr_b16 v[50:51], v65 offset:29184
    s_waitcnt lgkmcnt(3)
    v_mfma_f32_32x32x16_bf16 v[24:39], v[52:55], v[44:47], v[24:39]
    ds_read_b128 v[44:47], v63 offset:16384
    ds_read_b64_tr_b16 v[52:53], v65 offset:30720
    ds_read_b64_tr_b16 v[54:55], v65 offset:31232
    s_waitcnt lgkmcnt(3)
    v_mfma_f32_32x32x16_bf16 v[24:39], v[48:51], v[40:43], v[24:39]
    s_waitcnt lgkmcnt(0)
    v_mfma_f32_32x32x16_bf16 v[24:39], v[52:55], v[44:47], v[24:39]
    s_waitcnt vmcnt(24)
    s_barrier
    s_add_u32 m0, s27, 81920
    s_add_u32 s26, s24, 0
    buffer_load_dwordx4 v10, s[4:7], s26 offen lds
    s_add_u32 m0, s27, 86016
    s_add_u32 s26, s24, 262144
    buffer_load_dwordx4 v10, s[4:7], s26 offen lds
    s_add_u32 m0, s27, 90112
    s_add_u32 s26, s25, 0
    buffer_load_dwordx4 v11, s[8:11], s26 offen lds
    s_add_u32 m0, s27, 94208
    s_add_u32 s26, s25, 32768
    buffer_load_dwordx4 v11, s[8:11], s26 offen lds
    s_add_u32 s24, s24, 128
    s_add_u32 s25, s25, 65536
    ds_read_b128 v[40:43], v60 offset:32768
    ds_read_b64_tr_b16 v[48:49], v65 offset:40960
    ds_read_b64_tr_b16 v[50:51], v65 offset:41472
    ds_read_b128 v[44:47], v61 offset:32768
    ds_read_b64_tr_b16 v[52:53], v65 offset:43008
    ds_read_b64_tr_b16 v[54:55], v65 offset:43520
    s_waitcnt lgkmcnt(3)
    v_mfma_f32_32x32x16_bf16 v[24:39], v[48:51], v[40:43], v[24:39]
    ds_read_b128 v[40:43], v62 offset:32768
    ds_read_b64_tr_b16 v[48:49], v65 offset:45056
    ds_read_b64_tr_b16 v[50:51], v65 offset:45568
    s_waitcnt lgkmcnt(3)
    v_mfma_f32_32x32x16_bf16 v[24:39], v[52:55], v[44:47], v[24:39]
    ds_read_b128 v[44:47], v63 offset:32768
    ds_read_b64_tr_b16 v[52:53], v65 offset:47104
    ds_read_b64_tr_b16 v[54:55], v65 offset:47616
    s_waitcnt lgkmcnt(3)
    v_mfma_f32_32x32x16_bf16 v[24:39], v[48:51], v[40:43], v[24:39]
    s_waitcnt lgkmcnt(0)
    v_mfma_f32_32x32x16_bf16 v[24:39], v[52:55], v[44:47], v[24:39]
    s_waitcnt vmcnt(24)
    s_barrier
    s_add_u32 m0, s27, 98304
    s_add_u32 s26, s24, 0
    buffer_load_dwordx4 v10, s[4:7], s26 offen lds
    s_add_u32 m0, s27, 102400
    s_add_u32 s26, s24, 262144
    buffer_load_dwordx4 v10, s[4:7], s26 offen lds
    s_add_u32 m0, s27, 106496
    s_add_u32 s26, s25, 0
    buffer_load_dwordx4 v11, s[8:11], s26 offen lds
    s_add_u32 m0, s27, 110592
    s_add_u32 s26, s25, 32768
    buffer_load_dwordx4 v11, s[8:11], s26 offen lds
    s_add_u32 s24, s24, 128
    s_add_u32 s25, s25, 65536
    ds_read_b128 v[40:43], v60 offset:49152
    ds_read_b64_tr_b16 v[48:49], v65 offset:57344
    ds_read_b64_tr_b16 v[50:51], v65 offset:57856
    ds_read_b128 v[44:47], v61 offset:49152
    ds_read_b64_tr_b16 v[52:53], v65 offset:59392
    ds_read_b64_tr_b16 v[54:55], v65 offset:59904
    s_waitcnt lgkmcnt(3)
    v_mfma_f32_32x32x16_bf16 v[24:39], v[48:51], v[40:43], v[24:39]
    ds_read_b128 v[40:43], v62 offset:49152
    ds_read_b64_tr_b16 v[48:49], v65 offset:61440
    ds_read_b64_tr_b16 v[50:51], v65 offset:61952
    s_waitcnt lgkmcnt(3)
    v_mfma_f32_32x32x16_bf16 v[24:39], v[52:55], v[44:47], v[24:39]
    ds_read_b128 v[44:47], v63 offset:49152
    ds_read_b64_tr_b16 v[52:53], v65 offset:63488
    ds_read_b64_tr_b16 v[54:55], v65 offset:64000
    s_waitcnt lgkmcnt(3)
    v_mfma_f32_32x32x16_bf16 v[24:39], v[48:51], v[40:43], v[24:39]
    s_waitcnt lgkmcnt(0)
    v_mfma_f32_32x32x16_bf16 v[24:39], v[52:55], v[44:47], v[24:39]
    s_waitcnt vmcnt(24)
    s_barrier
    s_add_u32 m0, s27, 114688
    s_add_u32 s26, s24, 0
    buffer_load_dwordx4 v10, s[4:7], s26 offen lds
    s_add_u32 m0, s27, 118784
    s_add_u32 s26, s24, 262144
    buffer_load_dwordx4 v10, s[4:7], s26 offen lds
    s_add_u32 m0, s27, 122880
    s_add_u32 s26, s25, 0
    buffer_load_dwordx4 v11, s[8:11], s26 offen lds
    s_add_u32 m0, s27, 126976
    s_add_u32 s26, s25, 32768
    buffer_load_dwordx4 v11, s[8:11], s26 offen lds
    s_add_u32 s24, s24, 128
    s_add_u32 s25, s25, 65536
    ds_read_b128 v[40:43], v56 offset:0
    ds_read_b64_tr_b16 v[48:49], v64 offset:8192
    ds_read_b64_tr_b16 v[50:51], v64 offset:8704
    ds_read_b128 v[44:47], v57 offset:0
    ds_read_b64_tr_b16 v[52:53], v64 offset:10240
    ds_read_b64_tr_b16 v[54:55], v64 offset:10752
    s_waitcnt lgkmcnt(3)
    v_mfma_f32_32x32x16_bf16 v[24:39], v[48:51], v[40:43], v[24:39]
    ds_read_b128 v[40:43], v58 offset:0
    ds_read_b64_tr_b16 v[48:49], v64 offset:12288
    ds_read_b64_tr_b16 v[50:51], v64 offset:12800
    s_waitcnt lgkmcnt(3)
    v_mfma_f32_32x32x16_bf16 v[24:39], v[52:55], v[44:47], v[24:39]
    ds_read_b128 v[44:47], v59 offset:0
    ds_read_b64_tr_b16 v[52:53], v64 offset:14336
    ds_read_b64_tr_b16 v[54:55], v64 offset:14848
    s_waitcnt lgkmcnt(3)
    v_mfma_f32_32x32x16_bf16 v[24:39], v[48:51], v[40:43], v[24:39]
    s_waitcnt lgkmcnt(0)
    v_mfma_f32_32x32x16_bf16 v[24:39], v[52:55], v[44:47], v[24:39]
    s_waitcnt vmcnt(24)
    s_barrier
    s_add_u32 m0, s27, 0
    s_add_u32 s26, s24, 0
    buffer_load_dwordx4 v10, s[4:7], s26 offen lds
    s_add_u32 m0, s27, 4096
    s_add_u32 s26, s24, 262144
    buffer_load_dwordx4 v10, s[4:7], s26 offen lds
    s_add_u32 m0, s27, 8192
    s_add_u32 s26, s25, 0
    buffer_load_dwordx4 v11, s[8:11], s26 offen lds
    s_add_u32 m0, s27, 12288
    s_add_u32 s26, s25, 32768
    buffer_load_dwordx4 v11, s[8:11], s26 offen lds
    s_add_u32 s24, s24, 128
    s_add_u32 s25, s25, 65536
    ds_read_b128 v[40:43], v56 offset:16384
    ds_read_b64_tr_b16 v[48:49], v64 offset:24576
    ds_read_b64_tr_b16 v[50:51], v64 offset:25088
    ds_read_b128 v[44:47], v57 offset:16384
    ds_read_b64_tr_b16 v[52:53], v64 offset:26624
    ds_read_b64_tr_b16 v[54:55], v64 offset:27136
    s_waitcnt lgkmcnt(3)
    v_mfma_f32_32x32x16_bf16 v[24:39], v[48:51], v[40:43], v[24:39]
    ds_read_b128 v[40:43], v58 offset:16384
    ds_read_b64_tr_b16 v[48:49], v64 offset:28672
    ds_read_b64_tr_b16 v[50:51], v64 offset:29184
    s_waitcnt lgkmcnt(3)
    v_mfma_f32_32x32x16_bf16 v[24:39], v[52:55], v[44:47], v[24:39]
    ds_read_b128 v[44:47], v59 offset:16384
    ds_read_b64_tr_b16 v[52:53], v64 offset:30720
    ds_read_b64_tr_b16 v[54:55], v64 offset:31232
    s_waitcnt lgkmcnt(3)
    v_mfma_f32_32x32x16_bf16 v[24:39], v[48:51], v[40:43], v[24:39]
    s_waitcnt lgkmcnt(0)
    v_mfma_f32_32x32x16_bf16 v[24:39], v[52:55], v[44:47], v[24:39]
    s_waitcnt vmcnt(24)
    s_barrier
    s_add_u32 m0, s27, 16384
    s_add_u32 s26, s24, 0
    buffer_load_dwordx4 v10, s[4:7], s26 offen lds
    s_add_u32 m0, s27, 20480
    s_add_u32 s26, s24, 262144
    buffer_load_dwordx4 v10, s[4:7], s26 offen lds
    s_add_u32 m0, s27, 24576
    s_add_u32 s26, s25, 0
    buffer_load_dwordx4 v11, s[8:11], s26 offen lds
    s_add_u32 m0, s27, 28672
    s_add_u32 s26, s25, 32768
    buffer_load_dwordx4 v11, s[8:11], s26 offen lds
    s_add_u32 s24, s24, 128
    s_add_u32 s25, s25, 65536
    ds_read_b128 v[40:43], v56 offset:32768
    ds_read_b64_tr_b16 v[48:49], v64 offset:40960
    ds_read_b64_tr_b16 v[50:51], v64 offset:41472
    ds_read_b128 v[44:47], v57 offset:32768
    ds_read_b64_tr_b16 v[52:53], v64 offset:43008
    ds_read_b64_tr_b16 v[54:55], v64 offset:43520
    s_waitcnt lgkmcnt(3)
    v_mfma_f32_32x32x16_bf16 v[24:39], v[48:51], v[40:43], v[24:39]
    ds_read_b128 v[40:43], v58 offset:32768
    ds_read_b64_tr_b16 v[48:49], v64 offset:45056
    ds_read_b64_tr_b16 v[50:51], v64 offset:45568
    s_waitcnt lgkmcnt(3)
    v_mfma_f32_32x32x16_bf16 v[24:39], v[52:55], v[44:47], v[24:39]
    ds_read_b128 v[44:47], v59 offset:32768
    ds_read_b64_tr_b16 v[52:53], v64 offset:47104
    ds_read_b64_tr_b16 v[54:55], v64 offset:47616
    s_waitcnt lgkmcnt(3)
    v_mfma_f32_32x32x16_bf16 v[24:39], v[48:51], v[40:43], v[24:39]
    s_waitcnt lgkmcnt(0)
    v_mfma_f32_32x32x16_bf16 v[24:39], v[52:55], v[44:47], v[24:39]
    s_waitcnt vmcnt(24)
    s_barrier
    s_add_u32 m0, s27, 32768
    s_add_u32 s26, s24, 0
    buffer_load_dwordx4 v10, s[4:7], s26 offen lds
    s_add_u32 m0, s27, 36864
    s_add_u32 s26, s24, 262144
    buffer_load_dwordx4 v10, s[4:7], s26 offen lds
    s_add_u32 m0, s27, 40960
    s_add_u32 s26, s25, 0
    buffer_load_dwordx4 v11, s[8:11], s26 offen lds
    s_add_u32 m0, s27, 45056
    s_add_u32 s26, s25, 32768
    buffer_load_dwordx4 v11, s[8:11], s26 offen lds
    s_add_u32 s24, s24, 128
    s_add_u32 s25, s25, 65536
    ds_read_b128 v[40:43], v56 offset:49152
    ds_read_b64_tr_b16 v[48:49], v64 offset:57344
    ds_read_b64_tr_b16 v[50:51], v64 offset:57856
    ds_read_b128 v[44:47], v57 offset:49152
    ds_read_b64_tr_b16 v[52:53], v64 offset:59392
    ds_read_b64_tr_b16 v[54:55], v64 offset:59904
    s_waitcnt lgkmcnt(3)
    v_mfma_f32_32x32x16_bf16 v[24:39], v[48:51], v[40:43], v[24:39]
    ds_read_b128 v[40:43], v58 offset:49152
    ds_read_b64_tr_b16 v[48:49], v64 offset:61440
    ds_read_b64_tr_b16 v[50:51], v64 offset:61952
    s_waitcnt lgkmcnt(3)
    v_mfma_f32_32x32x16_bf16 v[24:39], v[52:55], v[44:47], v[24:39]
    ds_read_b128 v[44:47], v59 offset:49152
    ds_read_b64_tr_b16 v[52:53], v64 offset:63488
    ds_read_b64_tr_b16 v[54:55], v64 offset:64000
    s_waitcnt lgkmcnt(3)
    v_mfma_f32_32x32x16_bf16 v[24:39], v[48:51], v[40:43], v[24:39]
    s_waitcnt lgkmcnt(0)
    v_mfma_f32_32x32x16_bf16 v[24:39], v[52:55], v[44:47], v[24:39]
    s_waitcnt vmcnt(24)
    s_barrier
    s_add_u32 m0, s27, 49152
    s_add_u32 s26, s24, 0
    buffer_load_dwordx4 v10, s[4:7], s26 offen lds
    s_add_u32 m0, s27, 53248
    s_add_u32 s26, s24, 262144
    buffer_load_dwordx4 v10, s[4:7], s26 offen lds
    s_add_u32 m0, s27, 57344
    s_add_u32 s26, s25, 0
    buffer_load_dwordx4 v11, s[8:11], s26 offen lds
    s_add_u32 m0, s27, 61440
    s_add_u32 s26, s25, 32768
    buffer_load_dwordx4 v11, s[8:11], s26 offen lds
    s_add_u32 s24, s24, 128
    s_add_u32 s25, s25, 65536
    ds_read_b128 v[40:43], v60 offset:0
    ds_read_b64_tr_b16 v[48:49], v65 offset:8192
    ds_read_b64_tr_b16 v[50:51], v65 offset:8704
    ds_read_b128 v[44:47], v61 offset:0
    ds_read_b64_tr_b16 v[52:53], v65 offset:10240
    ds_read_b64_tr_b16 v[54:55], v65 offset:10752
    s_waitcnt lgkmcnt(3)
    v_mfma_f32_32x32x16_bf16 v[24:39], v[48:51], v[40:43], v[24:39]
    ds_read_b128 v[40:43], v62 offset:0
    ds_read_b64_tr_b16 v[48:49], v65 offset:12288
    ds_read_b64_tr_b16 v[50:51], v65 offset:12800
    s_waitcnt lgkmcnt(3)
    v_mfma_f32_32x32x16_bf16 v[24:39], v[52:55], v[44:47], v[24:39]
    ds_read_b128 v[44:47], v63 offset:0
    ds_read_b64_tr_b16 v[52:53], v65 offset:14336
    ds_read_b64_tr_b16 v[54:55], v65 offset:14848
    s_waitcnt lgkmcnt(3)
    v_mfma_f32_32x32x16_bf16 v[24:39], v[48:51], v[40:43], v[24:39]
    s_waitcnt lgkmcnt(0)
    v_mfma_f32_32x32x16_bf16 v[24:39], v[52:55], v[44:47], v[24:39]
    s_waitcnt vmcnt(24)
    s_barrier
    s_add_u32 m0, s27, 65536
    s_add_u32 s26, s24, 0
    buffer_load_dwordx4 v10, s[4:7], s26 offen lds
    s_add_u32 m0, s27, 69632
    s_add_u32 s26, s24, 262144
    buffer_load_dwordx4 v10, s[4:7], s26 offen lds
    s_add_u32 m0, s27, 73728
    s_add_u32 s26, s25, 0
    buffer_load_dwordx4 v11, s[8:11], s26 offen lds
    s_add_u32 m0, s27, 77824
    s_add_u32 s26, s25, 32768
    buffer_load_dwordx4 v11, s[8:11], s26 offen lds
    s_add_u32 s24, s24, 128
    s_add_u32 s25, s25, 65536
    ds_read_b128 v[40:43], v60 offset:16384
    ds_read_b64_tr_b16 v[48:49], v65 offset:24576
    ds_read_b64_tr_b16 v[50:51], v65 offset:25088
    ds_read_b128 v[44:47], v61 offset:16384
    ds_read_b64_tr_b16 v[52:53], v65 offset:26624
    ds_read_b64_tr_b16 v[54:55], v65 offset:27136
    s_waitcnt lgkmcnt(3)
    v_mfma_f32_32x32x16_bf16 v[24:39], v[48:51], v[40:43], v[24:39]
    ds_read_b128 v[40:43], v62 offset:16384
    ds_read_b64_tr_b16 v[48:49], v65 offset:28672
    ds_read_b64_tr_b16 v[50:51], v65 offset:29184
    s_waitcnt lgkmcnt(3)
    v_mfma_f32_32x32x16_bf16 v[24:39], v[52:55], v[44:47], v[24:39]
    ds_read_b128 v[44:47], v63 offset:16384
    ds_read_b64_tr_b16 v[52:53], v65 offset:30720
    ds_read_b64_tr_b16 v[54:55], v65 offset:31232
    s_waitcnt lgkmcnt(3)
    v_mfma_f32_32x32x16_bf16 v[24:39], v[48:51], v[40:43], v[24:39]
    s_waitcnt lgkmcnt(0)
    v_mfma_f32_32x32x16_bf16 v[24:39], v[52:55], v[44:47], v[24:39]
    s_waitcnt vmcnt(24)
    s_barrier
    s_add_u32 m0, s27, 81920
    s_add_u32 s26, s24, 0
    buffer_load_dwordx4 v10, s[4:7], s26 offen lds
    s_add_u32 m0, s27, 86016
    s_add_u32 s26, s24, 262144
    buffer_load_dwordx4 v10, s[4:7], s26 offen lds
    s_add_u32 m0, s27, 90112
    s_add_u32 s26, s25, 0
    buffer_load_dwordx4 v11, s[8:11], s26 offen lds
    s_add_u32 m0, s27, 94208
    s_add_u32 s26, s25, 32768
    buffer_load_dwordx4 v11, s[8:11], s26 offen lds
    s_add_u32 s24, s24, 128
    s_add_u32 s25, s25, 65536
    ds_read_b128 v[40:43], v60 offset:32768
    ds_read_b64_tr_b16 v[48:49], v65 offset:40960
    ds_read_b64_tr_b16 v[50:51], v65 offset:41472
    ds_read_b128 v[44:47], v61 offset:32768
    ds_read_b64_tr_b16 v[52:53], v65 offset:43008
    ds_read_b64_tr_b16 v[54:55], v65 offset:43520
    s_waitcnt lgkmcnt(3)
    v_mfma_f32_32x32x16_bf16 v[24:39], v[48:51], v[40:43], v[24:39]
    ds_read_b128 v[40:43], v62 offset:32768
    ds_read_b64_tr_b16 v[48:49], v65 offset:45056
    ds_read_b64_tr_b16 v[50:51], v65 offset:45568
    s_waitcnt lgkmcnt(3)
    v_mfma_f32_32x32x16_bf16 v[24:39], v[52:55], v[44:47], v[24:39]
    ds_read_b128 v[44:47], v63 offset:32768
    ds_read_b64_tr_b16 v[52:53], v65 offset:47104
    ds_read_b64_tr_b16 v[54:55], v65 offset:47616
    s_waitcnt lgkmcnt(3)
    v_mfma_f32_32x32x16_bf16 v[24:39], v[48:51], v[40:43], v[24:39]
    s_waitcnt lgkmcnt(0)
    v_mfma_f32_32x32x16_bf16 v[24:39], v[52:55], v[44:47], v[24:39]
    s_waitcnt vmcnt(24)
    s_barrier
    s_add_u32 m0, s27, 98304
    s_add_u32 s26, s24, 0
    buffer_load_dwordx4 v10, s[4:7], s26 offen lds
    s_add_u32 m0, s27, 102400
    s_add_u32 s26, s24, 262144
    buffer_load_dwordx4 v10, s[4:7], s26 offen lds
    s_add_u32 m0, s27, 106496
    s_add_u32 s26, s25, 0
    buffer_load_dwordx4 v11, s[8:11], s26 offen lds
    s_add_u32 m0, s27, 110592
    s_add_u32 s26, s25, 32768
    buffer_load_dwordx4 v11, s[8:11], s26 offen lds
    s_add_u32 s24, s24, 128
    s_add_u32 s25, s25, 65536
    ds_read_b128 v[40:43], v60 offset:49152
    ds_read_b64_tr_b16 v[48:49], v65 offset:57344
    ds_read_b64_tr_b16 v[50:51], v65 offset:57856
    ds_read_b128 v[44:47], v61 offset:49152
    ds_read_b64_tr_b16 v[52:53], v65 offset:59392
    ds_read_b64_tr_b16 v[54:55], v65 offset:59904
    s_waitcnt lgkmcnt(3)
    v_mfma_f32_32x32x16_bf16 v[24:39], v[48:51], v[40:43], v[24:39]
    ds_read_b128 v[40:43], v62 offset:49152
    ds_read_b64_tr_b16 v[48:49], v65 offset:61440
    ds_read_b64_tr_b16 v[50:51], v65 offset:61952
    s_waitcnt lgkmcnt(3)
    v_mfma_f32_32x32x16_bf16 v[24:39], v[52:55], v[44:47], v[24:39]
    ds_read_b128 v[44:47], v63 offset:49152
    ds_read_b64_tr_b16 v[52:53], v65 offset:63488
    ds_read_b64_tr_b16 v[54:55], v65 offset:64000
    s_waitcnt lgkmcnt(3)
    v_mfma_f32_32x32x16_bf16 v[24:39], v[48:51], v[40:43], v[24:39]
    s_waitcnt lgkmcnt(0)
    v_mfma_f32_32x32x16_bf16 v[24:39], v[52:55], v[44:47], v[24:39]
    s_waitcnt vmcnt(24)
    s_barrier
    s_add_u32 m0, s27, 114688
    s_add_u32 s26, s24, 0
    buffer_load_dwordx4 v10, s[4:7], s26 offen lds
    s_add_u32 m0, s27, 118784
    s_add_u32 s26, s24, 262144
    buffer_load_dwordx4 v10, s[4:7], s26 offen lds
    s_add_u32 m0, s27, 122880
    s_add_u32 s26, s25, 0
    buffer_load_dwordx4 v11, s[8:11], s26 offen lds
    s_add_u32 m0, s27, 126976
    s_add_u32 s26, s25, 32768
    buffer_load_dwordx4 v11, s[8:11], s26 offen lds
    s_add_u32 s24, s24, 128
    s_add_u32 s25, s25, 65536
    ds_read_b128 v[40:43], v56 offset:0
    ds_read_b64_tr_b16 v[48:49], v64 offset:8192
    ds_read_b64_tr_b16 v[50:51], v64 offset:8704
    ds_read_b128 v[44:47], v57 offset:0
    ds_read_b64_tr_b16 v[52:53], v64 offset:10240
    ds_read_b64_tr_b16 v[54:55], v64 offset:10752
    s_waitcnt lgkmcnt(3)
    v_mfma_f32_32x32x16_bf16 v[24:39], v[48:51], v[40:43], v[24:39]
    ds_read_b128 v[40:43], v58 offset:0
    ds_read_b64_tr_b16 v[48:49], v64 offset:12288
    ds_read_b64_tr_b16 v[50:51], v64 offset:12800
    s_waitcnt lgkmcnt(3)
    v_mfma_f32_32x32x16_bf16 v[24:39], v[52:55], v[44:47], v[24:39]
    ds_read_b128 v[44:47], v59 offset:0
    ds_read_b64_tr_b16 v[52:53], v64 offset:14336
    ds_read_b64_tr_b16 v[54:55], v64 offset:14848
    s_waitcnt lgkmcnt(3)
    v_mfma_f32_32x32x16_bf16 v[24:39], v[48:51], v[40:43], v[24:39]
    s_waitcnt lgkmcnt(0)
    v_mfma_f32_32x32x16_bf16 v[24:39], v[52:55], v[44:47], v[24:39]
    s_waitcnt vmcnt(24)
    s_barrier
    s_add_u32 m0, s27, 0
    s_add_u32 s26, s24, 0
    buffer_load_dwordx4 v10, s[4:7], s26 offen lds
    s_add_u32 m0, s27, 4096
    s_add_u32 s26, s24, 262144
    buffer_load_dwordx4 v10, s[4:7], s26 offen lds
    s_add_u32 m0, s27, 8192
    s_add_u32 s26, s25, 0
    buffer_load_dwordx4 v11, s[8:11], s26 offen lds
    s_add_u32 m0, s27, 12288
    s_add_u32 s26, s25, 32768
    buffer_load_dwordx4 v11, s[8:11], s26 offen lds
    s_add_u32 s24, s24, 128
    s_add_u32 s25, s25, 65536
    ds_read_b128 v[40:43], v56 offset:16384
    ds_read_b64_tr_b16 v[48:49], v64 offset:24576
    ds_read_b64_tr_b16 v[50:51], v64 offset:25088
    ds_read_b128 v[44:47], v57 offset:16384
    ds_read_b64_tr_b16 v[52:53], v64 offset:26624
    ds_read_b64_tr_b16 v[54:55], v64 offset:27136
    s_waitcnt lgkmcnt(3)
    v_mfma_f32_32x32x16_bf16 v[24:39], v[48:51], v[40:43], v[24:39]
    ds_read_b128 v[40:43], v58 offset:16384
    ds_read_b64_tr_b16 v[48:49], v64 offset:28672
    ds_read_b64_tr_b16 v[50:51], v64 offset:29184
    s_waitcnt lgkmcnt(3)
    v_mfma_f32_32x32x16_bf16 v[24:39], v[52:55], v[44:47], v[24:39]
    ds_read_b128 v[44:47], v59 offset:16384
    ds_read_b64_tr_b16 v[52:53], v64 offset:30720
    ds_read_b64_tr_b16 v[54:55], v64 offset:31232
    s_waitcnt lgkmcnt(3)
    v_mfma_f32_32x32x16_bf16 v[24:39], v[48:51], v[40:43], v[24:39]
    s_waitcnt lgkmcnt(0)
    v_mfma_f32_32x32x16_bf16 v[24:39], v[52:55], v[44:47], v[24:39]
    s_waitcnt vmcnt(24)
    s_barrier
    s_add_u32 m0, s27, 16384
    s_add_u32 s26, s24, 0
    buffer_load_dwordx4 v10, s[4:7], s26 offen lds
    s_add_u32 m0, s27, 20480
    s_add_u32 s26, s24, 262144
    buffer_load_dwordx4 v10, s[4:7], s26 offen lds
    s_add_u32 m0, s27, 24576
    s_add_u32 s26, s25, 0
    buffer_load_dwordx4 v11, s[8:11], s26 offen lds
    s_add_u32 m0, s27, 28672
    s_add_u32 s26, s25, 32768
    buffer_load_dwordx4 v11, s[8:11], s26 offen lds
    s_add_u32 s24, s24, 128
    s_add_u32 s25, s25, 65536
    ds_read_b128 v[40:43], v56 offset:32768
    ds_read_b64_tr_b16 v[48:49], v64 offset:40960
    ds_read_b64_tr_b16 v[50:51], v64 offset:41472
    ds_read_b128 v[44:47], v57 offset:32768
    ds_read_b64_tr_b16 v[52:53], v64 offset:43008
    ds_read_b64_tr_b16 v[54:55], v64 offset:43520
    s_waitcnt lgkmcnt(3)
    v_mfma_f32_32x32x16_bf16 v[24:39], v[48:51], v[40:43], v[24:39]
    ds_read_b128 v[40:43], v58 offset:32768
    ds_read_b64_tr_b16 v[48:49], v64 offset:45056
    ds_read_b64_tr_b16 v[50:51], v64 offset:45568
    s_waitcnt lgkmcnt(3)
    v_mfma_f32_32x32x16_bf16 v[24:39], v[52:55], v[44:47], v[24:39]
    ds_read_b128 v[44:47], v59 offset:32768
    ds_read_b64_tr_b16 v[52:53], v64 offset:47104
    ds_read_b64_tr_b16 v[54:55], v64 offset:47616
    s_waitcnt lgkmcnt(3)
    v_mfma_f32_32x32x16_bf16 v[24:39], v[48:51], v[40:43], v[24:39]
    s_waitcnt lgkmcnt(0)
    v_mfma_f32_32x32x16_bf16 v[24:39], v[52:55], v[44:47], v[24:39]
    s_waitcnt vmcnt(24)
    s_barrier
    s_add_u32 m0, s27, 32768
    s_add_u32 s26, s24, 0
    buffer_load_dwordx4 v10, s[4:7], s26 offen lds
    s_add_u32 m0, s27, 36864
    s_add_u32 s26, s24, 262144
    buffer_load_dwordx4 v10, s[4:7], s26 offen lds
    s_add_u32 m0, s27, 40960
    s_add_u32 s26, s25, 0
    buffer_load_dwordx4 v11, s[8:11], s26 offen lds
    s_add_u32 m0, s27, 45056
    s_add_u32 s26, s25, 32768
    buffer_load_dwordx4 v11, s[8:11], s26 offen lds
    s_add_u32 s24, s24, 128
    s_add_u32 s25, s25, 65536
    ds_read_b128 v[40:43], v56 offset:49152
    ds_read_b64_tr_b16 v[48:49], v64 offset:57344
    ds_read_b64_tr_b16 v[50:51], v64 offset:57856
    ds_read_b128 v[44:47], v57 offset:49152
    ds_read_b64_tr_b16 v[52:53], v64 offset:59392
    ds_read_b64_tr_b16 v[54:55], v64 offset:59904
    s_waitcnt lgkmcnt(3)
    v_mfma_f32_32x32x16_bf16 v[24:39], v[48:51], v[40:43], v[24:39]
    ds_read_b128 v[40:43], v58 offset:49152
    ds_read_b64_tr_b16 v[48:49], v64 offset:61440
    ds_read_b64_tr_b16 v[50:51], v64 offset:61952
    s_waitcnt lgkmcnt(3)
    v_mfma_f32_32x32x16_bf16 v[24:39], v[52:55], v[44:47], v[24:39]
    ds_read_b128 v[44:47], v59 offset:49152
    ds_read_b64_tr_b16 v[52:53], v64 offset:63488
    ds_read_b64_tr_b16 v[54:55], v64 offset:64000
    s_waitcnt lgkmcnt(3)
    v_mfma_f32_32x32x16_bf16 v[24:39], v[48:51], v[40:43], v[24:39]
    s_waitcnt lgkmcnt(0)
    v_mfma_f32_32x32x16_bf16 v[24:39], v[52:55], v[44:47], v[24:39]
    s_waitcnt vmcnt(24)
    s_barrier
    s_add_u32 m0, s27, 49152
    s_add_u32 s26, s24, 0
    buffer_load_dwordx4 v10, s[4:7], s26 offen lds
    s_add_u32 m0, s27, 53248
    s_add_u32 s26, s24, 262144
    buffer_load_dwordx4 v10, s[4:7], s26 offen lds
    s_add_u32 m0, s27, 57344
    s_add_u32 s26, s25, 0
    buffer_load_dwordx4 v11, s[8:11], s26 offen lds
    s_add_u32 m0, s27, 61440
    s_add_u32 s26, s25, 32768
    buffer_load_dwordx4 v11, s[8:11], s26 offen lds
    s_add_u32 s24, s24, 128
    s_add_u32 s25, s25, 65536
    ds_read_b128 v[40:43], v60 offset:0
    ds_read_b64_tr_b16 v[48:49], v65 offset:8192
    ds_read_b64_tr_b16 v[50:51], v65 offset:8704
    ds_read_b128 v[44:47], v61 offset:0
    ds_read_b64_tr_b16 v[52:53], v65 offset:10240
    ds_read_b64_tr_b16 v[54:55], v65 offset:10752
    s_waitcnt lgkmcnt(3)
    v_mfma_f32_32x32x16_bf16 v[24:39], v[48:51], v[40:43], v[24:39]
    ds_read_b128 v[40:43], v62 offset:0
    ds_read_b64_tr_b16 v[48:49], v65 offset:12288
    ds_read_b64_tr_b16 v[50:51], v65 offset:12800
    s_waitcnt lgkmcnt(3)
    v_mfma_f32_32x32x16_bf16 v[24:39], v[52:55], v[44:47], v[24:39]
    ds_read_b128 v[44:47], v63 offset:0
    ds_read_b64_tr_b16 v[52:53], v65 offset:14336
    ds_read_b64_tr_b16 v[54:55], v65 offset:14848
    s_waitcnt lgkmcnt(3)
    v_mfma_f32_32x32x16_bf16 v[24:39], v[48:51], v[40:43], v[24:39]
    s_waitcnt lgkmcnt(0)
    v_mfma_f32_32x32x16_bf16 v[24:39], v[52:55], v[44:47], v[24:39]
    s_waitcnt vmcnt(24)
    s_barrier
    s_add_u32 m0, s27, 65536
    s_add_u32 s26, s24, 0
    buffer_load_dwordx4 v10, s[4:7], s26 offen lds
    s_add_u32 m0, s27, 69632
    s_add_u32 s26, s24, 262144
    buffer_load_dwordx4 v10, s[4:7], s26 offen lds
    s_add_u32 m0, s27, 73728
    s_add_u32 s26, s25, 0
    buffer_load_dwordx4 v11, s[8:11], s26 offen lds
    s_add_u32 m0, s27, 77824
    s_add_u32 s26, s25, 32768
    buffer_load_dwordx4 v11, s[8:11], s26 offen lds
    s_add_u32 s24, s24, 128
    s_add_u32 s25, s25, 65536
    ds_read_b128 v[40:43], v60 offset:16384
    ds_read_b64_tr_b16 v[48:49], v65 offset:24576
    ds_read_b64_tr_b16 v[50:51], v65 offset:25088
    ds_read_b128 v[44:47], v61 offset:16384
    ds_read_b64_tr_b16 v[52:53], v65 offset:26624
    ds_read_b64_tr_b16 v[54:55], v65 offset:27136
    s_waitcnt lgkmcnt(3)
    v_mfma_f32_32x32x16_bf16 v[24:39], v[48:51], v[40:43], v[24:39]
    ds_read_b128 v[40:43], v62 offset:16384
    ds_read_b64_tr_b16 v[48:49], v65 offset:28672
    ds_read_b64_tr_b16 v[50:51], v65 offset:29184
    s_waitcnt lgkmcnt(3)
    v_mfma_f32_32x32x16_bf16 v[24:39], v[52:55], v[44:47], v[24:39]
    ds_read_b128 v[44:47], v63 offset:16384
    ds_read_b64_tr_b16 v[52:53], v65 offset:30720
    ds_read_b64_tr_b16 v[54:55], v65 offset:31232
    s_waitcnt lgkmcnt(3)
    v_mfma_f32_32x32x16_bf16 v[24:39], v[48:51], v[40:43], v[24:39]
    s_waitcnt lgkmcnt(0)
    v_mfma_f32_32x32x16_bf16 v[24:39], v[52:55], v[44:47], v[24:39]
    s_waitcnt vmcnt(24)
    s_barrier
    s_add_u32 m0, s27, 81920
    s_add_u32 s26, s24, 0
    buffer_load_dwordx4 v10, s[4:7], s26 offen lds
    s_add_u32 m0, s27, 86016
    s_add_u32 s26, s24, 262144
    buffer_load_dwordx4 v10, s[4:7], s26 offen lds
    s_add_u32 m0, s27, 90112
    s_add_u32 s26, s25, 0
    buffer_load_dwordx4 v11, s[8:11], s26 offen lds
    s_add_u32 m0, s27, 94208
    s_add_u32 s26, s25, 32768
    buffer_load_dwordx4 v11, s[8:11], s26 offen lds
    s_add_u32 s24, s24, 128
    s_add_u32 s25, s25, 65536
    ds_read_b128 v[40:43], v60 offset:32768
    ds_read_b64_tr_b16 v[48:49], v65 offset:40960
    ds_read_b64_tr_b16 v[50:51], v65 offset:41472
    ds_read_b128 v[44:47], v61 offset:32768
    ds_read_b64_tr_b16 v[52:53], v65 offset:43008
    ds_read_b64_tr_b16 v[54:55], v65 offset:43520
    s_waitcnt lgkmcnt(3)
    v_mfma_f32_32x32x16_bf16 v[24:39], v[48:51], v[40:43], v[24:39]
    ds_read_b128 v[40:43], v62 offset:32768
    ds_read_b64_tr_b16 v[48:49], v65 offset:45056
    ds_read_b64_tr_b16 v[50:51], v65 offset:45568
    s_waitcnt lgkmcnt(3)
    v_mfma_f32_32x32x16_bf16 v[24:39], v[52:55], v[44:47], v[24:39]
    ds_read_b128 v[44:47], v63 offset:32768
    ds_read_b64_tr_b16 v[52:53], v65 offset:47104
    ds_read_b64_tr_b16 v[54:55], v65 offset:47616
    s_waitcnt lgkmcnt(3)
    v_mfma_f32_32x32x16_bf16 v[24:39], v[48:51], v[40:43], v[24:39]
    s_waitcnt lgkmcnt(0)
    v_mfma_f32_32x32x16_bf16 v[24:39], v[52:55], v[44:47], v[24:39]
    s_waitcnt vmcnt(24)
    s_barrier
    s_add_u32 m0, s27, 98304
    s_add_u32 s26, s24, 0
    buffer_load_dwordx4 v10, s[4:7], s26 offen lds
    s_add_u32 m0, s27, 102400
    s_add_u32 s26, s24, 262144
    buffer_load_dwordx4 v10, s[4:7], s26 offen lds
    s_add_u32 m0, s27, 106496
    s_add_u32 s26, s25, 0
    buffer_load_dwordx4 v11, s[8:11], s26 offen lds
    s_add_u32 m0, s27, 110592
    s_add_u32 s26, s25, 32768
    buffer_load_dwordx4 v11, s[8:11], s26 offen lds
    s_add_u32 s24, s24, 128
    s_add_u32 s25, s25, 65536
    ds_read_b128 v[40:43], v60 offset:49152
    ds_read_b64_tr_b16 v[48:49], v65 offset:57344
    ds_read_b64_tr_b16 v[50:51], v65 offset:57856
    ds_read_b128 v[44:47], v61 offset:49152
    ds_read_b64_tr_b16 v[52:53], v65 offset:59392
    ds_read_b64_tr_b16 v[54:55], v65 offset:59904
    s_waitcnt lgkmcnt(3)
    v_mfma_f32_32x32x16_bf16 v[24:39], v[48:51], v[40:43], v[24:39]
    ds_read_b128 v[40:43], v62 offset:49152
    ds_read_b64_tr_b16 v[48:49], v65 offset:61440
    ds_read_b64_tr_b16 v[50:51], v65 offset:61952
    s_waitcnt lgkmcnt(3)
    v_mfma_f32_32x32x16_bf16 v[24:39], v[52:55], v[44:47], v[24:39]
    ds_read_b128 v[44:47], v63 offset:49152
    ds_read_b64_tr_b16 v[52:53], v65 offset:63488
    ds_read_b64_tr_b16 v[54:55], v65 offset:64000
    s_waitcnt lgkmcnt(3)
    v_mfma_f32_32x32x16_bf16 v[24:39], v[48:51], v[40:43], v[24:39]
    s_waitcnt lgkmcnt(0)
    v_mfma_f32_32x32x16_bf16 v[24:39], v[52:55], v[44:47], v[24:39]
    s_waitcnt vmcnt(24)
    s_barrier
    s_add_u32 m0, s27, 114688
    s_add_u32 s26, s24, 0
    buffer_load_dwordx4 v10, s[4:7], s26 offen lds
    s_add_u32 m0, s27, 118784
    s_add_u32 s26, s24, 262144
    buffer_load_dwordx4 v10, s[4:7], s26 offen lds
    s_add_u32 m0, s27, 122880
    s_add_u32 s26, s25, 0
    buffer_load_dwordx4 v11, s[8:11], s26 offen lds
    s_add_u32 m0, s27, 126976
    s_add_u32 s26, s25, 32768
    buffer_load_dwordx4 v11, s[8:11], s26 offen lds
    s_add_u32 s24, s24, 128
    s_add_u32 s25, s25, 65536
    ds_read_b128 v[40:43], v56 offset:0
    ds_read_b64_tr_b16 v[48:49], v64 offset:8192
    ds_read_b64_tr_b16 v[50:51], v64 offset:8704
    ds_read_b128 v[44:47], v57 offset:0
    ds_read_b64_tr_b16 v[52:53], v64 offset:10240
    ds_read_b64_tr_b16 v[54:55], v64 offset:10752
    s_waitcnt lgkmcnt(3)
    v_mfma_f32_32x32x16_bf16 v[24:39], v[48:51], v[40:43], v[24:39]
    ds_read_b128 v[40:43], v58 offset:0
    ds_read_b64_tr_b16 v[48:49], v64 offset:12288
    ds_read_b64_tr_b16 v[50:51], v64 offset:12800
    s_waitcnt lgkmcnt(3)
    v_mfma_f32_32x32x16_bf16 v[24:39], v[52:55], v[44:47], v[24:39]
    ds_read_b128 v[44:47], v59 offset:0
    ds_read_b64_tr_b16 v[52:53], v64 offset:14336
    ds_read_b64_tr_b16 v[54:55], v64 offset:14848
    s_waitcnt lgkmcnt(3)
    v_mfma_f32_32x32x16_bf16 v[24:39], v[48:51], v[40:43], v[24:39]
    s_waitcnt lgkmcnt(0)
    v_mfma_f32_32x32x16_bf16 v[24:39], v[52:55], v[44:47], v[24:39]
    s_waitcnt vmcnt(24)
    s_barrier
    ds_read_b128 v[40:43], v56 offset:16384
    ds_read_b64_tr_b16 v[48:49], v64 offset:24576
    ds_read_b64_tr_b16 v[50:51], v64 offset:25088
    ds_read_b128 v[44:47], v57 offset:16384
    ds_read_b64_tr_b16 v[52:53], v64 offset:26624
    ds_read_b64_tr_b16 v[54:55], v64 offset:27136
    s_waitcnt lgkmcnt(3)
    v_mfma_f32_32x32x16_bf16 v[24:39], v[48:51], v[40:43], v[24:39]
    ds_read_b128 v[40:43], v58 offset:16384
    ds_read_b64_tr_b16 v[48:49], v64 offset:28672
    ds_read_b64_tr_b16 v[50:51], v64 offset:29184
    s_waitcnt lgkmcnt(3)
    v_mfma_f32_32x32x16_bf16 v[24:39], v[52:55], v[44:47], v[24:39]
    ds_read_b128 v[44:47], v59 offset:16384
    ds_read_b64_tr_b16 v[52:53], v64 offset:30720
    ds_read_b64_tr_b16 v[54:55], v64 offset:31232
    s_waitcnt lgkmcnt(3)
    v_mfma_f32_32x32x16_bf16 v[24:39], v[48:51], v[40:43], v[24:39]
    s_waitcnt lgkmcnt(0)
    v_mfma_f32_32x32x16_bf16 v[24:39], v[52:55], v[44:47], v[24:39]
    s_waitcnt vmcnt(20)
    s_barrier
    ds_read_b128 v[40:43], v56 offset:32768
    ds_read_b64_tr_b16 v[48:49], v64 offset:40960
    ds_read_b64_tr_b16 v[50:51], v64 offset:41472
    ds_read_b128 v[44:47], v57 offset:32768
    ds_read_b64_tr_b16 v[52:53], v64 offset:43008
    ds_read_b64_tr_b16 v[54:55], v64 offset:43520
    s_waitcnt lgkmcnt(3)
    v_mfma_f32_32x32x16_bf16 v[24:39], v[48:51], v[40:43], v[24:39]
    ds_read_b128 v[40:43], v58 offset:32768
    ds_read_b64_tr_b16 v[48:49], v64 offset:45056
    ds_read_b64_tr_b16 v[50:51], v64 offset:45568
    s_waitcnt lgkmcnt(3)
    v_mfma_f32_32x32x16_bf16 v[24:39], v[52:55], v[44:47], v[24:39]
    ds_read_b128 v[44:47], v59 offset:32768
    ds_read_b64_tr_b16 v[52:53], v64 offset:47104
    ds_read_b64_tr_b16 v[54:55], v64 offset:47616
    s_waitcnt lgkmcnt(3)
    v_mfma_f32_32x32x16_bf16 v[24:39], v[48:51], v[40:43], v[24:39]
    s_waitcnt lgkmcnt(0)
    v_mfma_f32_32x32x16_bf16 v[24:39], v[52:55], v[44:47], v[24:39]
    s_waitcnt vmcnt(16)
    s_barrier
    ds_read_b128 v[40:43], v56 offset:49152
    ds_read_b64_tr_b16 v[48:49], v64 offset:57344
    ds_read_b64_tr_b16 v[50:51], v64 offset:57856
    ds_read_b128 v[44:47], v57 offset:49152
    ds_read_b64_tr_b16 v[52:53], v64 offset:59392
    ds_read_b64_tr_b16 v[54:55], v64 offset:59904
    s_waitcnt lgkmcnt(3)
    v_mfma_f32_32x32x16_bf16 v[24:39], v[48:51], v[40:43], v[24:39]
    ds_read_b128 v[40:43], v58 offset:49152
    ds_read_b64_tr_b16 v[48:49], v64 offset:61440
    ds_read_b64_tr_b16 v[50:51], v64 offset:61952
    s_waitcnt lgkmcnt(3)
    v_mfma_f32_32x32x16_bf16 v[24:39], v[52:55], v[44:47], v[24:39]
    ds_read_b128 v[44:47], v59 offset:49152
    ds_read_b64_tr_b16 v[52:53], v64 offset:63488
    ds_read_b64_tr_b16 v[54:55], v64 offset:64000
    s_waitcnt lgkmcnt(3)
    v_mfma_f32_32x32x16_bf16 v[24:39], v[48:51], v[40:43], v[24:39]
    s_waitcnt lgkmcnt(0)
    v_mfma_f32_32x32x16_bf16 v[24:39], v[52:55], v[44:47], v[24:39]
    s_waitcnt vmcnt(12)
    s_barrier
    ds_read_b128 v[40:43], v60 offset:0
    ds_read_b64_tr_b16 v[48:49], v65 offset:8192
    ds_read_b64_tr_b16 v[50:51], v65 offset:8704
    ds_read_b128 v[44:47], v61 offset:0
    ds_read_b64_tr_b16 v[52:53], v65 offset:10240
    ds_read_b64_tr_b16 v[54:55], v65 offset:10752
    s_waitcnt lgkmcnt(3)
    v_mfma_f32_32x32x16_bf16 v[24:39], v[48:51], v[40:43], v[24:39]
    ds_read_b128 v[40:43], v62 offset:0
    ds_read_b64_tr_b16 v[48:49], v65 offset:12288
    ds_read_b64_tr_b16 v[50:51], v65 offset:12800
    s_waitcnt lgkmcnt(3)
    v_mfma_f32_32x32x16_bf16 v[24:39], v[52:55], v[44:47], v[24:39]
    ds_read_b128 v[44:47], v63 offset:0
    ds_read_b64_tr_b16 v[52:53], v65 offset:14336
    ds_read_b64_tr_b16 v[54:55], v65 offset:14848
    s_waitcnt lgkmcnt(3)
    v_mfma_f32_32x32x16_bf16 v[24:39], v[48:51], v[40:43], v[24:39]
    s_waitcnt lgkmcnt(0)
    v_mfma_f32_32x32x16_bf16 v[24:39], v[52:55], v[44:47], v[24:39]
    s_waitcnt vmcnt(8)
    s_barrier
    ds_read_b128 v[40:43], v60 offset:16384
    ds_read_b64_tr_b16 v[48:49], v65 offset:24576
    ds_read_b64_tr_b16 v[50:51], v65 offset:25088
    ds_read_b128 v[44:47], v61 offset:16384
    ds_read_b64_tr_b16 v[52:53], v65 offset:26624
    ds_read_b64_tr_b16 v[54:55], v65 offset:27136
    s_waitcnt lgkmcnt(3)
    v_mfma_f32_32x32x16_bf16 v[24:39], v[48:51], v[40:43], v[24:39]
    ds_read_b128 v[40:43], v62 offset:16384
    ds_read_b64_tr_b16 v[48:49], v65 offset:28672
    ds_read_b64_tr_b16 v[50:51], v65 offset:29184
    s_waitcnt lgkmcnt(3)
    v_mfma_f32_32x32x16_bf16 v[24:39], v[52:55], v[44:47], v[24:39]
    ds_read_b128 v[44:47], v63 offset:16384
    ds_read_b64_tr_b16 v[52:53], v65 offset:30720
    ds_read_b64_tr_b16 v[54:55], v65 offset:31232
    s_waitcnt lgkmcnt(3)
    v_mfma_f32_32x32x16_bf16 v[24:39], v[48:51], v[40:43], v[24:39]
    s_waitcnt lgkmcnt(0)
    v_mfma_f32_32x32x16_bf16 v[24:39], v[52:55], v[44:47], v[24:39]
    s_waitcnt vmcnt(4)
    s_barrier
    ds_read_b128 v[40:43], v60 offset:32768
    ds_read_b64_tr_b16 v[48:49], v65 offset:40960
    ds_read_b64_tr_b16 v[50:51], v65 offset:41472
    ds_read_b128 v[44:47], v61 offset:32768
    ds_read_b64_tr_b16 v[52:53], v65 offset:43008
    ds_read_b64_tr_b16 v[54:55], v65 offset:43520
    s_waitcnt lgkmcnt(3)
    v_mfma_f32_32x32x16_bf16 v[24:39], v[48:51], v[40:43], v[24:39]
    ds_read_b128 v[40:43], v62 offset:32768
    ds_read_b64_tr_b16 v[48:49], v65 offset:45056
    ds_read_b64_tr_b16 v[50:51], v65 offset:45568
    s_waitcnt lgkmcnt(3)
    v_mfma_f32_32x32x16_bf16 v[24:39], v[52:55], v[44:47], v[24:39]
    ds_read_b128 v[44:47], v63 offset:32768
    ds_read_b64_tr_b16 v[52:53], v65 offset:47104
    ds_read_b64_tr_b16 v[54:55], v65 offset:47616
    s_waitcnt lgkmcnt(3)
    v_mfma_f32_32x32x16_bf16 v[24:39], v[48:51], v[40:43], v[24:39]
    s_waitcnt lgkmcnt(0)
    v_mfma_f32_32x32x16_bf16 v[24:39], v[52:55], v[44:47], v[24:39]
    s_waitcnt vmcnt(0)
    s_barrier
    ds_read_b128 v[40:43], v60 offset:49152
    ds_read_b64_tr_b16 v[48:49], v65 offset:57344
    ds_read_b64_tr_b16 v[50:51], v65 offset:57856
    ds_read_b128 v[44:47], v61 offset:49152
    ds_read_b64_tr_b16 v[52:53], v65 offset:59392
    ds_read_b64_tr_b16 v[54:55], v65 offset:59904
    s_waitcnt lgkmcnt(3)
    v_mfma_f32_32x32x16_bf16 v[24:39], v[48:51], v[40:43], v[24:39]
    ds_read_b128 v[40:43], v62 offset:49152
    ds_read_b64_tr_b16 v[48:49], v65 offset:61440
    ds_read_b64_tr_b16 v[50:51], v65 offset:61952
    s_waitcnt lgkmcnt(3)
    v_mfma_f32_32x32x16_bf16 v[24:39], v[52:55], v[44:47], v[24:39]
    ds_read_b128 v[44:47], v63 offset:49152
    ds_read_b64_tr_b16 v[52:53], v65 offset:63488
    ds_read_b64_tr_b16 v[54:55], v65 offset:64000
    s_waitcnt lgkmcnt(3)
    v_mfma_f32_32x32x16_bf16 v[24:39], v[48:51], v[40:43], v[24:39]
    s_waitcnt lgkmcnt(0)
    v_mfma_f32_32x32x16_bf16 v[24:39], v[52:55], v[44:47], v[24:39]
    v_and_b32 v12, 31, v1
    s_mul_i32 s23, s21, 32
    s_add_u32 s23, s23, s19
    v_add_u32 v12, s23, v12
    v_lshrrev_b32 v13, 5, v1
    v_lshlrev_b32 v13, 2, v13
    s_mul_i32 s23, s22, 32
    s_add_u32 s23, s23, s20
    v_add_u32 v13, s23, v13
    s_load_dwordx2 s[16:17], s[0:1], 112
    s_load_dwordx2 s[28:29], s[0:1], 0
    s_load_dwordx2 s[12:13], s[0:1], 112
    s_waitcnt lgkmcnt(0)
    s_add_u32 s12, s12, 0x2400000
    s_addc_u32 s13, s13, 0
    s_and_b32 s13, s13, 0xffff
    s_mov_b32 s14, 0x200000
    s_mov_b32 s15, 0x00020000
    s_and_b32 s29, s29, 0xffff
    s_mov_b32 s30, 0x200000
    s_mov_b32 s31, 0x00020000
    s_and_b32 s17, s17, 0xffff
    s_mov_b32 s18, 0x3000
    s_mov_b32 s19, 0x00020000
    v_mul_u32_u24 v14, 1024, v12
    v_lshlrev_b32 v15, 1, v13
    v_add_u32 v14, v14, v15
    v_lshlrev_b32 v15, 2, v13
    s_mov_b32 s24, 4096
    s_mov_b32 s23, 0
    buffer_load_dwordx4 v[70:73], v15, s[16:19], s24 offen offset:0
    buffer_load_dwordx2 v[74:75], v14, s[28:31], s23 offen offset:0
    s_waitcnt vmcnt(0)
    v_cvt_pk_bf16_f32 v66, v24, v24
    v_lshlrev_b32 v66, 16, v66
    v_mul_f32 v66, v66, v70
    v_cvt_pk_bf16_f32 v66, v66, v66
    v_lshlrev_b32 v66, 16, v66
    v_cvt_pk_bf16_f32 v67, v25, v25
    v_lshlrev_b32 v67, 16, v67
    v_mul_f32 v67, v67, v71
    v_cvt_pk_bf16_f32 v67, v67, v67
    v_lshlrev_b32 v67, 16, v67
    v_cvt_pk_bf16_f32 v68, v26, v26
    v_lshlrev_b32 v68, 16, v68
    v_mul_f32 v68, v68, v72
    v_cvt_pk_bf16_f32 v68, v68, v68
    v_lshlrev_b32 v68, 16, v68
    v_cvt_pk_bf16_f32 v69, v27, v27
    v_lshlrev_b32 v69, 16, v69
    v_mul_f32 v69, v69, v73
    v_cvt_pk_bf16_f32 v69, v69, v69
    v_lshlrev_b32 v69, 16, v69
    v_lshlrev_b32 v70, 16, v74
    v_and_b32 v71, 0xffff0000, v74
    v_lshlrev_b32 v72, 16, v75
    v_and_b32 v73, 0xffff0000, v75
    v_add_f32 v66, v66, v70
    v_add_f32 v67, v67, v71
    v_add_f32 v68, v68, v72
    v_add_f32 v69, v69, v73
    v_cvt_pk_bf16_f32 v66, v66, v67
    v_cvt_pk_bf16_f32 v67, v68, v69
    buffer_store_dwordx2 v[66:67], v14, s[12:15], s23 offen offset:0
    buffer_load_dwordx4 v[70:73], v15, s[16:19], s24 offen offset:32
    buffer_load_dwordx2 v[74:75], v14, s[28:31], s23 offen offset:16
    s_waitcnt vmcnt(0)
    v_cvt_pk_bf16_f32 v66, v28, v28
    v_lshlrev_b32 v66, 16, v66
    v_mul_f32 v66, v66, v70
    v_cvt_pk_bf16_f32 v66, v66, v66
    v_lshlrev_b32 v66, 16, v66
    v_cvt_pk_bf16_f32 v67, v29, v29
    v_lshlrev_b32 v67, 16, v67
    v_mul_f32 v67, v67, v71
    v_cvt_pk_bf16_f32 v67, v67, v67
    v_lshlrev_b32 v67, 16, v67
    v_cvt_pk_bf16_f32 v68, v30, v30
    v_lshlrev_b32 v68, 16, v68
    v_mul_f32 v68, v68, v72
    v_cvt_pk_bf16_f32 v68, v68, v68
    v_lshlrev_b32 v68, 16, v68
    v_cvt_pk_bf16_f32 v69, v31, v31
    v_lshlrev_b32 v69, 16, v69
    v_mul_f32 v69, v69, v73
    v_cvt_pk_bf16_f32 v69, v69, v69
    v_lshlrev_b32 v69, 16, v69
    v_lshlrev_b32 v70, 16, v74
    v_and_b32 v71, 0xffff0000, v74
    v_lshlrev_b32 v72, 16, v75
    v_and_b32 v73, 0xffff0000, v75
    v_add_f32 v66, v66, v70
    v_add_f32 v67, v67, v71
    v_add_f32 v68, v68, v72
    v_add_f32 v69, v69, v73
    v_cvt_pk_bf16_f32 v66, v66, v67
    v_cvt_pk_bf16_f32 v67, v68, v69
    buffer_store_dwordx2 v[66:67], v14, s[12:15], s23 offen offset:16
    buffer_load_dwordx4 v[70:73], v15, s[16:19], s24 offen offset:64
    buffer_load_dwordx2 v[74:75], v14, s[28:31], s23 offen offset:32
    s_waitcnt vmcnt(0)
    v_cvt_pk_bf16_f32 v66, v32, v32
    v_lshlrev_b32 v66, 16, v66
    v_mul_f32 v66, v66, v70
    v_cvt_pk_bf16_f32 v66, v66, v66
    v_lshlrev_b32 v66, 16, v66
    v_cvt_pk_bf16_f32 v67, v33, v33
    v_lshlrev_b32 v67, 16, v67
    v_mul_f32 v67, v67, v71
    v_cvt_pk_bf16_f32 v67, v67, v67
    v_lshlrev_b32 v67, 16, v67
    v_cvt_pk_bf16_f32 v68, v34, v34
    v_lshlrev_b32 v68, 16, v68
    v_mul_f32 v68, v68, v72
    v_cvt_pk_bf16_f32 v68, v68, v68
    v_lshlrev_b32 v68, 16, v68
    v_cvt_pk_bf16_f32 v69, v35, v35
    v_lshlrev_b32 v69, 16, v69
    v_mul_f32 v69, v69, v73
    v_cvt_pk_bf16_f32 v69, v69, v69
    v_lshlrev_b32 v69, 16, v69
    v_lshlrev_b32 v70, 16, v74
    v_and_b32 v71, 0xffff0000, v74
    v_lshlrev_b32 v72, 16, v75
    v_and_b32 v73, 0xffff0000, v75
    v_add_f32 v66, v66, v70
    v_add_f32 v67, v67, v71
    v_add_f32 v68, v68, v72
    v_add_f32 v69, v69, v73
    v_cvt_pk_bf16_f32 v66, v66, v67
    v_cvt_pk_bf16_f32 v67, v68, v69
    buffer_store_dwordx2 v[66:67], v14, s[12:15], s23 offen offset:32
    buffer_load_dwordx4 v[70:73], v15, s[16:19], s24 offen offset:96
    buffer_load_dwordx2 v[74:75], v14, s[28:31], s23 offen offset:48
    s_waitcnt vmcnt(0)
    v_cvt_pk_bf16_f32 v66, v36, v36
    v_lshlrev_b32 v66, 16, v66
    v_mul_f32 v66, v66, v70
    v_cvt_pk_bf16_f32 v66, v66, v66
    v_lshlrev_b32 v66, 16, v66
    v_cvt_pk_bf16_f32 v67, v37, v37
    v_lshlrev_b32 v67, 16, v67
    v_mul_f32 v67, v67, v71
    v_cvt_pk_bf16_f32 v67, v67, v67
    v_lshlrev_b32 v67, 16, v67
    v_cvt_pk_bf16_f32 v68, v38, v38
    v_lshlrev_b32 v68, 16, v68
    v_mul_f32 v68, v68, v72
    v_cvt_pk_bf16_f32 v68, v68, v68
    v_lshlrev_b32 v68, 16, v68
    v_cvt_pk_bf16_f32 v69, v39, v39
    v_lshlrev_b32 v69, 16, v69
    v_mul_f32 v69, v69, v73
    v_cvt_pk_bf16_f32 v69, v69, v69
    v_lshlrev_b32 v69, 16, v69
    v_lshlrev_b32 v70, 16, v74
    v_and_b32 v71, 0xffff0000, v74
    v_lshlrev_b32 v72, 16, v75
    v_and_b32 v73, 0xffff0000, v75
    v_add_f32 v66, v66, v70
    v_add_f32 v67, v67, v71
    v_add_f32 v68, v68, v72
    v_add_f32 v69, v69, v73
    v_cvt_pk_bf16_f32 v66, v66, v67
    v_cvt_pk_bf16_f32 v67, v68, v69
    buffer_store_dwordx2 v[66:67], v14, s[12:15], s23 offen offset:48
    s_nop 3
.Lend_gemmo_kernel:
    s_endpgm
.globl ln2_kernel
.p2align 8
.type ln2_kernel,@function
ln2_kernel:
    s_cmp_ge_u32 s2, 512
    s_cbranch_scc1 .Lend_ln2_kernel
    s_load_dwordx2 s[4:5], s[0:1], 112
    s_load_dwordx2 s[8:9], s[0:1], 112
    s_load_dwordx2 s[12:13], s[0:1], 112
    v_and_b32 v1, 63, v0
    v_lshrrev_b32 v2, 6, v0
    s_nop 0
    v_readfirstlane_b32 s3, v2
    s_waitcnt lgkmcnt(0)
    s_add_u32 s4, s4, 0x2400000
    s_addc_u32 s5, s5, 0
    s_and_b32 s5, s5, 0xffff
    s_mov_b32 s6, 0x200000
    s_mov_b32 s7, 0x00020000
    s_add_u32 s8, s8, 0x2600000
    s_addc_u32 s9, s9, 0
    s_and_b32 s9, s9, 0xffff
    s_mov_b32 s10, 0x200000
    s_mov_b32 s11, 0x00020000
    s_and_b32 s13, s13, 0xffff
    s_mov_b32 s14, 0x3000
    s_mov_b32 s15, 0x00020000
    s_lshl_b32 s16, s2, 2
    s_add_u32 s16, s16, s3
    s_lshl_b32 s16, s16, 10
    v_lshlrev_b32 v3, 4, v1
    buffer_load_dwordx4 v[4:7], v3, s[4:7], s16 offen
    v_lshlrev_b32 v8, 5, v1
    s_mov_b32 s17, 8192
    s_mov_b32 s18, 6144
    buffer_load_dwordx4 v[40:43], v8, s[12:15], s17 offen
    buffer_load_dwordx4 v[44:47], v8, s[12:15], s17 offen offset:16
    buffer_load_dwordx4 v[48:51], v8, s[12:15], s18 offen
    buffer_load_dwordx4 v[52:55], v8, s[12:15], s18 offen offset:16
    s_waitcnt vmcnt(4)
    v_lshlrev_b32 v16, 16, v4
    v_and_b32 v17, 0xffff0000, v4
    v_lshlrev_b32 v18, 16, v5
    v_and_b32 v19, 0xffff0000, v5
    v_lshlrev_b32 v20, 16, v6
    v_and_b32 v21, 0xffff0000, v6
    v_lshlrev_b32 v22, 16, v7
    v_and_b32 v23, 0xffff0000, v7
    v_add_f32 v30, v16, v17
    v_add_f32 v30, v30, v18
    v_add_f32 v30, v30, v19
    v_add_f32 v30, v30, v20
    v_add_f32 v30, v30, v21
    v_add_f32 v30, v30, v22
    v_add_f32 v30, v30, v23
    s_nop 1
    v_add_f32_dpp v30, v30, v30 quad_perm:[1,0,3,2] row_mask:0xf bank_mask:0xf
    s_nop 1
    v_add_f32_dpp v30, v30, v30 quad_perm:[2,3,0,1] row_mask:0xf bank_mask:0xf
    s_nop 1
    v_add_f32_dpp v30, v30, v30 row_half_mirror row_mask:0xf bank_mask:0xf
    s_nop 1
    v_add_f32_dpp v30, v30, v30 row_mirror row_mask:0xf bank_mask:0xf
    s_nop 1
    v_add_f32_dpp v30, v30, v30 row_bcast:15 row_mask:0xa bank_mask:0xf
    s_nop 1
    v_add_f32_dpp v30, v30, v30 row_bcast:31 row_mask:0xc bank_mask:0xf
    s_nop 0
    v_readlane_b32 s20, v30, 63
    s_nop 1
    v_mov_b32 v31, s20
    v_mul_f32 v31, 0x3b000000, v31
    v_sub_f32 v32, v16, v31
    v_mul_f32 v30, v32, v32
    v_sub_f32 v32, v17, v31
    v_fmac_f32 v30, v32, v32
    v_sub_f32 v32, v18, v31
    v_fmac_f32 v30, v32, v32
    v_sub_f32 v32, v19, v31
    v_fmac_f32 v30, v32, v32
    v_sub_f32 v32, v20, v31
    v_fmac_f32 v30, v32, v32
    v_sub_f32 v32, v21, v31
    v_fmac_f32 v30, v32, v32
    v_sub_f32 v32, v22, v31
    v_fmac_f32 v30, v32, v32
    v_sub_f32 v32, v23, v31
    v_fmac_f32 v30, v32, v32
    s_nop 1
    v_add_f32_dpp v30, v30, v30 quad_perm:[1,0,3,2] row_mask:0xf bank_mask:0xf
    s_nop 1
    v_add_f32_dpp v30, v30, v30 quad_perm:[2,3,0,1] row_mask:0xf bank_mask:0xf
    s_nop 1
    v_add_f32_dpp v30, v30, v30 row_half_mirror row_mask:0xf bank_mask:0xf
    s_nop 1
    v_add_f32_dpp v30, v30, v30 row_mirror row_mask:0xf bank_mask:0xf
    s_nop 1
    v_add_f32_dpp v30, v30, v30 row_bcast:15 row_mask:0xa bank_mask:0xf
    s_nop 1
    v_add_f32_dpp v30, v30, v30 row_bcast:31 row_mask:0xc bank_mask:0xf
    s_nop 0
    v_readlane_b32 s21, v30, 63
    s_nop 1
    v_mov_b32 v32, s21
    v_mul_f32 v32, 0x3b000000, v32
    v_cvt_pk_bf16_f32 v31, v31, v31
    v_lshlrev_b32 v31, 16, v31
    v_cvt_pk_bf16_f32 v32, v32, v32
    v_lshlrev_b32 v32, 16, v32
    v_add_f32 v32, 0x3727c5ac, v32
    v_cvt_pk_bf16_f32 v32, v32, v32
    v_lshlrev_b32 v32, 16, v32
    v_sqrt_f32 v32, v32
    s_nop 0
    v_cvt_pk_bf16_f32 v32, v32, v32
    v_lshlrev_b32 v32, 16, v32
    v_rcp_f32 v32, v32
    v_sub_f32 v16, v16, v31
    v_cvt_pk_bf16_f32 v16, v16, v16
    v_lshlrev_b32 v16, 16, v16
    v_mul_f32 v16, v16, v32
    v_cvt_pk_bf16_f32 v16, v16, v16
    v_lshlrev_b32 v16, 16, v16
    v_sub_f32 v17, v17, v31
    v_cvt_pk_bf16_f32 v17, v17, v17
    v_lshlrev_b32 v17, 16, v17
    v_mul_f32 v17, v17, v32
    v_cvt_pk_bf16_f32 v17, v17, v17
    v_lshlrev_b32 v17, 16, v17
    v_sub_f32 v18, v18, v31
    v_cvt_pk_bf16_f32 v18, v18, v18
    v_lshlrev_b32 v18, 16, v18
    v_mul_f32 v18, v18, v32
    v_cvt_pk_bf16_f32 v18, v18, v18
    v_lshlrev_b32 v18, 16, v18
    v_sub_f32 v19, v19, v31
    v_cvt_pk_bf16_f32 v19, v19, v19
    v_lshlrev_b32 v19, 16, v19
    v_mul_f32 v19, v19, v32
    v_cvt_pk_bf16_f32 v19, v19, v19
    v_lshlrev_b32 v19, 16, v19
    v_sub_f32 v20, v20, v31
    v_cvt_pk_bf16_f32 v20, v20, v20
    v_lshlrev_b32 v20, 16, v20
    v_mul_f32 v20, v20, v32
    v_cvt_pk_bf16_f32 v20, v20, v20
    v_lshlrev_b32 v20, 16, v20
    v_sub_f32 v21, v21, v31
    v_cvt_pk_bf16_f32 v21, v21, v21
    v_lshlrev_b32 v21, 16, v21
    v_mul_f32 v21, v21, v32
    v_cvt_pk_bf16_f32 v21, v21, v21
    v_lshlrev_b32 v21, 16, v21
    v_sub_f32 v22, v22, v31
    v_cvt_pk_bf16_f32 v22, v22, v22
    v_lshlrev_b32 v22, 16, v22
    v_mul_f32 v22, v22, v32
    v_cvt_pk_bf16_f32 v22, v22, v22
    v_lshlrev_b32 v22, 16, v22
    v_sub_f32 v23, v23, v31
    v_cvt_pk_bf16_f32 v23, v23, v23
    v_lshlrev_b32 v23, 16, v23
    v_mul_f32 v23, v23, v32
    v_cvt_pk_bf16_f32 v23, v23, v23
    v_lshlrev_b32 v23, 16, v23
    s_waitcnt vmcnt(0)
    v_add_f32 v40, 1.0, v40
    v_cvt_pk_bf16_f32 v40, v40, v40
    v_lshlrev_b32 v40, 16, v40
    v_add_f32 v41, 1.0, v41
    v_cvt_pk_bf16_f32 v41, v41, v41
    v_lshlrev_b32 v41, 16, v41
    v_add_f32 v42, 1.0, v42
    v_cvt_pk_bf16_f32 v42, v42, v42
    v_lshlrev_b32 v42, 16, v42
    v_add_f32 v43, 1.0, v43
    v_cvt_pk_bf16_f32 v43, v43, v43
    v_lshlrev_b32 v43, 16, v43
    v_add_f32 v44, 1.0, v44
    v_cvt_pk_bf16_f32 v44, v44, v44
    v_lshlrev_b32 v44, 16, v44
    v_add_f32 v45, 1.0, v45
    v_cvt_pk_bf16_f32 v45, v45, v45
    v_lshlrev_b32 v45, 16, v45
    v_add_f32 v46, 1.0, v46
    v_cvt_pk_bf16_f32 v46, v46, v46
    v_lshlrev_b32 v46, 16, v46
    v_add_f32 v47, 1.0, v47
    v_cvt_pk_bf16_f32 v47, v47, v47
    v_lshlrev_b32 v47, 16, v47
    v_mul_f32 v16, v16, v40
    v_cvt_pk_bf16_f32 v16, v16, v16
    v_lshlrev_b32 v16, 16, v16
    v_add_f32 v16, v16, v48
    v_mul_f32 v17, v17, v41
    v_cvt_pk_bf16_f32 v17, v17, v17
    v_lshlrev_b32 v17, 16, v17
    v_add_f32 v17, v17, v49
    v_mul_f32 v18, v18, v42
    v_cvt_pk_bf16_f32 v18, v18, v18
    v_lshlrev_b32 v18, 16, v18
    v_add_f32 v18, v18, v50
    v_mul_f32 v19, v19, v43
    v_cvt_pk_bf16_f32 v19, v19, v19
    v_lshlrev_b32 v19, 16, v19
    v_add_f32 v19, v19, v51
    v_mul_f32 v20, v20, v44
    v_cvt_pk_bf16_f32 v20, v20, v20
    v_lshlrev_b32 v20, 16, v20
    v_add_f32 v20, v20, v52
    v_mul_f32 v21, v21, v45
    v_cvt_pk_bf16_f32 v21, v21, v21
    v_lshlrev_b32 v21, 16, v21
    v_add_f32 v21, v21, v53
    v_mul_f32 v22, v22, v46
    v_cvt_pk_bf16_f32 v22, v22, v22
    v_lshlrev_b32 v22, 16, v22
    v_add_f32 v22, v22, v54
    v_mul_f32 v23, v23, v47
    v_cvt_pk_bf16_f32 v23, v23, v23
    v_lshlrev_b32 v23, 16, v23
    v_add_f32 v23, v23, v55
    v_cvt_pk_bf16_f32 v4, v16, v17
    v_cvt_pk_bf16_f32 v5, v18, v19
    v_cvt_pk_bf16_f32 v6, v20, v21
    v_cvt_pk_bf16_f32 v7, v22, v23
    buffer_store_dwordx4 v[4:7], v3, s[8:11], s16 offen
    s_nop 3
.Lend_ln2_kernel:
    s_endpgm
.globl gemmin_kernel
.p2align 8
.type gemmin_kernel,@function
gemmin_kernel:
    s_cmp_ge_u32 s2, 224
    s_cbranch_scc1 .Lend_gemmin_kernel
    s_load_dwordx2 s[4:5], s[0:1], 112
    s_load_dwordx2 s[8:9], s[0:1], 48
    v_and_b32 v1, 63, v0
    v_lshrrev_b32 v12, 6, v0
    s_nop 0
    v_readfirstlane_b32 s3, v12
    s_mov_b32 s29, 0
    s_mov_b32 s16, s2
    s_mul_hi_u32 s17, s16, 0x12492493
    s_mul_i32 s18, s17, 14
    s_sub_u32 s18, s16, s18
    s_mul_i32 s19, s17, 128
    s_mul_i32 s20, s18, 128
    s_and_b32 s21, s3, 1
    s_lshr_b32 s22, s3, 1
    s_waitcnt lgkmcnt(0)
    s_add_u32 s4, s4, 0x2600000
    s_addc_u32 s5, s5, 0
    s_and_b32 s5, s5, 0xffff
    s_mov_b32 s6, 0x200000
    s_mov_b32 s7, 0x00020000
    s_and_b32 s9, s9, 0xffff
    s_mov_b32 s10, 0x1c0000
    s_mov_b32 s11, 0x00020000
    v_lshrrev_b32 v12, 3, v1
    v_mul_u32_u24 v10, 1024, v12
    v_lshrrev_b32 v13, 4, v1
    s_and_b32 s23, s3, 1
    s_lshl_b32 s23, s23, 2
    v_add_u32 v13, s23, v13
    v_and_b32 v13, 7, v13
    v_and_b32 v14, 7, v1
    v_xor_b32 v14, v14, v13
    v_lshlrev_b32 v14, 4, v14
    v_add_u32 v10, v10, v14
    v_lshrrev_b32 v12, 4, v1
    v_mul_u32_u24 v11, 3584, v12
    v_and_b32 v13, 3, v12
    v_lshlrev_b32 v13, 2, v13
    v_and_b32 v14, 15, v1
    v_xor_b32 v14, v14, v13
    v_lshlrev_b32 v14, 4, v14
    v_add_u32 v11, v11, v14
    s_lshl_b32 s23, s3, 3
    s_add_u32 s23, s23, s19
    s_mul_i32 s24, s23, 1024
    s_mul_i32 s25, s3, 14336
    s_lshl_b32 s23, s20, 1
    s_add_u32 s25, s25, s23
    s_lshl_b32 s27, s3, 10
    s_add_u32 m0, s27, 0
    s_add_u32 s26, s24, 0
    buffer_load_dwordx4 v10, s[4:7], s26 offen lds
    s_add_u32 m0, s27, 4096
    s_add_u32 s26, s24, 32768
    buffer_load_dwordx4 v10, s[4:7], s26 offen lds
    s_add_u32 m0, s27, 8192
    s_add_u32 s26, s24, 65536
    buffer_load_dwordx4 v10, s[4:7], s26 offen lds
    s_add_u32 m0, s27, 12288
    s_add_u32 s26, s24, 98304
    buffer_load_dwordx4 v10, s[4:7], s26 offen lds
    s_add_u32 m0, s27, 16384
    s_add_u32 s26, s25, 0
    buffer_load_dwordx4 v11, s[8:11], s26 offen lds
    s_add_u32 m0, s27, 20480
    s_add_u32 s26, s25, 57344
    buffer_load_dwordx4 v11, s[8:11], s26 offen lds
    s_add_u32 m0, s27, 24576
    s_add_u32 s26, s25, 114688
    buffer_load_dwordx4 v11, s[8:11], s26 offen lds
    s_add_u32 m0, s27, 28672
    s_add_u32 s26, s25, 172032
    buffer_load_dwordx4 v11, s[8:11], s26 offen lds
    s_add_u32 s24, s24, 128
    s_add_u32 s25, s25, 229376
    s_add_u32 m0, s27, 32768
    s_add_u32 s26, s24, 0
    buffer_load_dwordx4 v10, s[4:7], s26 offen lds
    s_add_u32 m0, s27, 36864
    s_add_u32 s26, s24, 32768
    buffer_load_dwordx4 v10, s[4:7], s26 offen lds
    s_add_u32 m0, s27, 40960
    s_add_u32 s26, s24, 65536
    buffer_load_dwordx4 v10, s[4:7], s26 offen lds
    s_add_u32 m0, s27, 45056
    s_add_u32 s26, s24, 98304
    buffer_load_dwordx4 v10, s[4:7], s26 offen lds
    s_add_u32 m0, s27, 49152
    s_add_u32 s26, s25, 0
    buffer_load_dwordx4 v11, s[8:11], s26 offen lds
    s_add_u32 m0, s27, 53248
    s_add_u32 s26, s25, 57344
    buffer_load_dwordx4 v11, s[8:11], s26 offen lds
    s_add_u32 m0, s27, 57344
    s_add_u32 s26, s25, 114688
    buffer_load_dwordx4 v11, s[8:11], s26 offen lds
    s_add_u32 m0, s27, 61440
    s_add_u32 s26, s25, 172032
    buffer_load_dwordx4 v11, s[8:11], s26 offen lds
    s_add_u32 s24, s24, 128
    s_add_u32 s25, s25, 229376
    s_add_u32 m0, s27, 65536
    s_add_u32 s26, s24, 0
    buffer_load_dwordx4 v10, s[4:7], s26 offen lds
    s_add_u32 m0, s27, 69632
    s_add_u32 s26, s24, 32768
    buffer_load_dwordx4 v10, s[4:7], s26 offen lds
    s_add_u32 m0, s27, 73728
    s_add_u32 s26, s24, 65536
    buffer_load_dwordx4 v10, s[4:7], s26 offen lds
    s_add_u32 m0, s27, 77824
    s_add_u32 s26, s24, 98304
    buffer_load_dwordx4 v10, s[4:7], s26 offen lds
    s_add_u32 m0, s27, 81920
    s_add_u32 s26, s25, 0
    buffer_load_dwordx4 v11, s[8:11], s26 offen lds
    s_add_u32 m0, s27, 86016
    s_add_u32 s26, s25, 57344
    buffer_load_dwordx4 v11, s[8:11], s26 offen lds
    s_add_u32 m0, s27, 90112
    s_add_u32 s26, s25, 114688
    buffer_load_dwordx4 v11, s[8:11], s26 offen lds
    s_add_u32 m0, s27, 94208
    s_add_u32 s26, s25, 172032
    buffer_load_dwordx4 v11, s[8:11], s26 offen lds
    s_add_u32 s24, s24, 128
    s_add_u32 s25, s25, 229376
    v_and_b32 v12, 31, v1
    s_mul_i32 s23, s21, 64
    v_add_u32 v12, s23, v12
    v_lshrrev_b32 v13, 1, v12
    v_and_b32 v13, 7, v13
    v_lshrrev_b32 v14, 5, v1
    v_lshlrev_b32 v12, 7, v12
    v_add_u32 v15, 0, v14
    v_xor_b32 v15, v15, v13
    v_lshlrev_b32 v15, 4, v15
    v_add_u32 v120, v12, v15
    v_add_u32 v15, 2, v14
    v_xor_b32 v15, v15, v13
    v_lshlrev_b32 v15, 4, v15
    v_add_u32 v121, v12, v15
    v_add_u32 v15, 4, v14
    v_xor_b32 v15, v15, v13
    v_lshlrev_b32 v15, 4, v15
    v_add_u32 v122, v12, v15
    v_add_u32 v15, 6, v14
    v_xor_b32 v15, v15, v13
    v_lshlrev_b32 v15, 4, v15
    v_add_u32 v123, v12, v15
    v_lshrrev_b32 v12, 2, v1
    v_and_b32 v12, 3, v12
    v_lshrrev_b32 v13, 5, v1
    v_lshlrev_b32 v13, 3, v13
    v_add_u32 v13, v13, v12
    v_mul_u32_u24 v13, 256, v13
    v_lshrrev_b32 v14, 4, v1
    v_and_b32 v14, 1, v14
    v_lshlrev_b32 v14, 1, v14
    v_and_b32 v15, 3, v1
    v_lshrrev_b32 v16, 1, v15
    v_add_u32 v14, v14, v16
    v_and_b32 v15, 1, v15
    v_lshlrev_b32 v15, 3, v15
    v_add_u32 v13, v13, v15
    v_lshlrev_b32 v12, 2, v12
    s_mul_i32 s23, s22, 8
    s_add_u32 s23, s23, 0
    v_add_u32 v15, s23, v14
    v_xor_b32 v15, v15, v12
    v_lshlrev_b32 v15, 4, v15
    v_add_u32 v128, v13, v15
    s_mul_i32 s23, s22, 8
    s_add_u32 s23, s23, 4
    v_add_u32 v15, s23, v14
    v_xor_b32 v15, v15, v12
    v_lshlrev_b32 v15, 4, v15
    v_add_u32 v129, v13, v15
    v_add_u32 v124, 0x10000, v120
    v_add_u32 v125, 0x10000, v121
    v_add_u32 v126, 0x10000, v122
    v_add_u32 v127, 0x10000, v123
    v_add_u32 v130, 0x10000, v128
    v_add_u32 v131, 0x10000, v129
    s_waitcnt vmcnt(16)
    s_barrier
    s_add_u32 m0, s27, 98304
    s_add_u32 s26, s24, 0
    buffer_load_dwordx4 v10, s[4:7], s26 offen lds
    s_add_u32 m0, s27, 102400
    s_add_u32 s26, s24, 32768
    buffer_load_dwordx4 v10, s[4:7], s26 offen lds
    s_add_u32 m0, s27, 106496
    s_add_u32 s26, s24, 65536
    buffer_load_dwordx4 v10, s[4:7], s26 offen lds
    s_add_u32 m0, s27, 110592
    s_add_u32 s26, s24, 98304
    buffer_load_dwordx4 v10, s[4:7], s26 offen lds
    s_add_u32 m0, s27, 114688
    s_add_u32 s26, s25, 0
    buffer_load_dwordx4 v11, s[8:11], s26 offen lds
    s_add_u32 m0, s27, 118784
    s_add_u32 s26, s25, 57344
    buffer_load_dwordx4 v11, s[8:11], s26 offen lds
    s_add_u32 m0, s27, 122880
    s_add_u32 s26, s25, 114688
    buffer_load_dwordx4 v11, s[8:11], s26 offen lds
    s_add_u32 m0, s27, 126976
    s_add_u32 s26, s25, 172032
    buffer_load_dwordx4 v11, s[8:11], s26 offen lds
    s_add_u32 s24, s24, 128
    s_add_u32 s25, s25, 229376
    ds_read_b128 v[88:91], v120 offset:0
    ds_read_b128 v[92:95], v120 offset:4096
    ds_read_b64_tr_b16 v[104:105], v128 offset:16384
    ds_read_b64_tr_b16 v[106:107], v128 offset:17408
    ds_read_b64_tr_b16 v[108:109], v129 offset:16384
    ds_read_b64_tr_b16 v[110:111], v129 offset:17408
    ds_read_b128 v[96:99], v121 offset:0
    ds_read_b128 v[100:103], v121 offset:4096
    ds_read_b64_tr_b16 v[112:113], v128 offset:20480
    ds_read_b64_tr_b16 v[114:115], v128 offset:21504
    ds_read_b64_tr_b16 v[116:117], v129 offset:20480
    ds_read_b64_tr_b16 v[118:119], v129 offset:21504
    s_waitcnt lgkmcnt(6)
    v_mfma_f32_32x32x16_bf16 v[24:39], v[104:107], v[88:91], 0
    v_mfma_f32_32x32x16_bf16 v[40:55], v[104:107], v[92:95], 0
    v_mfma_f32_32x32x16_bf16 v[56:71], v[108:111], v[88:91], 0
    v_mfma_f32_32x32x16_bf16 v[72:87], v[108:111], v[92:95], 0
    ds_read_b128 v[88:91], v122 offset:0
    ds_read_b128 v[92:95], v122 offset:4096
    ds_read_b64_tr_b16 v[104:105], v128 offset:24576
    ds_read_b64_tr_b16 v[106:107], v128 offset:25600
    ds_read_b64_tr_b16 v[108:109], v129 offset:24576
    ds_read_b64_tr_b16 v[110:111], v129 offset:25600
    s_waitcnt lgkmcnt(6)
    v_mfma_f32_32x32x16_bf16 v[24:39], v[112:115], v[96:99], v[24:39]
    v_mfma_f32_32x32x16_bf16 v[40:55], v[112:115], v[100:103], v[40:55]
    v_mfma_f32_32x32x16_bf16 v[56:71], v[116:119], v[96:99], v[56:71]
    v_mfma_f32_32x32x16_bf16 v[72:87], v[116:119], v[100:103], v[72:87]
    ds_read_b128 v[96:99], v123 offset:0
    ds_read_b128 v[100:103], v123 offset:4096
    ds_read_b64_tr_b16 v[112:113], v128 offset:28672
    ds_read_b64_tr_b16 v[114:115], v128 offset:29696
    ds_read_b64_tr_b16 v[116:117], v129 offset:28672
    ds_read_b64_tr_b16 v[118:119], v129 offset:29696
    s_waitcnt lgkmcnt(6)
    v_mfma_f32_32x32x16_bf16 v[24:39], v[104:107], v[88:91], v[24:39]
    v_mfma_f32_32x32x16_bf16 v[40:55], v[104:107], v[92:95], v[40:55]
    v_mfma_f32_32x32x16_bf16 v[56:71], v[108:111], v[88:91], v[56:71]
    v_mfma_f32_32x32x16_bf16 v[72:87], v[108:111], v[92:95], v[72:87]
    s_waitcnt lgkmcnt(0)
    v_mfma_f32_32x32x16_bf16 v[24:39], v[112:115], v[96:99], v[24:39]
    v_mfma_f32_32x32x16_bf16 v[40:55], v[112:115], v[100:103], v[40:55]
    v_mfma_f32_32x32x16_bf16 v[56:71], v[116:119], v[96:99], v[56:71]
    v_mfma_f32_32x32x16_bf16 v[72:87], v[116:119], v[100:103], v[72:87]
    s_waitcnt vmcnt(16)
    s_barrier
    s_add_u32 m0, s27, 0
    s_add_u32 s26, s24, 0
    buffer_load_dwordx4 v10, s[4:7], s26 offen lds
    s_add_u32 m0, s27, 4096
    s_add_u32 s26, s24, 32768
    buffer_load_dwordx4 v10, s[4:7], s26 offen lds
    s_add_u32 m0, s27, 8192
    s_add_u32 s26, s24, 65536
    buffer_load_dwordx4 v10, s[4:7], s26 offen lds
    s_add_u32 m0, s27, 12288
    s_add_u32 s26, s24, 98304
    buffer_load_dwordx4 v10, s[4:7], s26 offen lds
    s_add_u32 m0, s27, 16384
    s_add_u32 s26, s25, 0
    buffer_load_dwordx4 v11, s[8:11], s26 offen lds
    s_add_u32 m0, s27, 20480
    s_add_u32 s26, s25, 57344
    buffer_load_dwordx4 v11, s[8:11], s26 offen lds
    s_add_u32 m0, s27, 24576
    s_add_u32 s26, s25, 114688
    buffer_load_dwordx4 v11, s[8:11], s26 offen lds
    s_add_u32 m0, s27, 28672
    s_add_u32 s26, s25, 172032
    buffer_load_dwordx4 v11, s[8:11], s26 offen lds
    s_add_u32 s24, s24, 128
    s_add_u32 s25, s25, 229376
    ds_read_b128 v[88:91], v120 offset:32768
    ds_read_b128 v[92:95], v120 offset:36864
    ds_read_b64_tr_b16 v[104:105], v128 offset:49152
    ds_read_b64_tr_b16 v[106:107], v128 offset:50176
    ds_read_b64_tr_b16 v[108:109], v129 offset:49152
    ds_read_b64_tr_b16 v[110:111], v129 offset:50176
    ds_read_b128 v[96:99], v121 offset:32768
    ds_read_b128 v[100:103], v121 offset:36864
    ds_read_b64_tr_b16 v[112:113], v128 offset:53248
    ds_read_b64_tr_b16 v[114:115], v128 offset:54272
    ds_read_b64_tr_b16 v[116:117], v129 offset:53248
    ds_read_b64_tr_b16 v[118:119], v129 offset:54272
    s_waitcnt lgkmcnt(6)
    v_mfma_f32_32x32x16_bf16 v[24:39], v[104:107], v[88:91], v[24:39]
    v_mfma_f32_32x32x16_bf16 v[40:55], v[104:107], v[92:95], v[40:55]
    v_mfma_f32_32x32x16_bf16 v[56:71], v[108:111], v[88:91], v[56:71]
    v_mfma_f32_32x32x16_bf16 v[72:87], v[108:111], v[92:95], v[72:87]
    ds_read_b128 v[88:91], v122 offset:32768
    ds_read_b128 v[92:95], v122 offset:36864
    ds_read_b64_tr_b16 v[104:105], v128 offset:57344
    ds_read_b64_tr_b16 v[106:107], v128 offset:58368
    ds_read_b64_tr_b16 v[108:109], v129 offset:57344
    ds_read_b64_tr_b16 v[110:111], v129 offset:58368
    s_waitcnt lgkmcnt(6)
    v_mfma_f32_32x32x16_bf16 v[24:39], v[112:115], v[96:99], v[24:39]
    v_mfma_f32_32x32x16_bf16 v[40:55], v[112:115], v[100:103], v[40:55]
    v_mfma_f32_32x32x16_bf16 v[56:71], v[116:119], v[96:99], v[56:71]
    v_mfma_f32_32x32x16_bf16 v[72:87], v[116:119], v[100:103], v[72:87]
    ds_read_b128 v[96:99], v123 offset:32768
    ds_read_b128 v[100:103], v123 offset:36864
    ds_read_b64_tr_b16 v[112:113], v128 offset:61440
    ds_read_b64_tr_b16 v[114:115], v128 offset:62464
    ds_read_b64_tr_b16 v[116:117], v129 offset:61440
    ds_read_b64_tr_b16 v[118:119], v129 offset:62464
    s_waitcnt lgkmcnt(6)
    v_mfma_f32_32x32x16_bf16 v[24:39], v[104:107], v[88:91], v[24:39]
    v_mfma_f32_32x32x16_bf16 v[40:55], v[104:107], v[92:95], v[40:55]
    v_mfma_f32_32x32x16_bf16 v[56:71], v[108:111], v[88:91], v[56:71]
    v_mfma_f32_32x32x16_bf16 v[72:87], v[108:111], v[92:95], v[72:87]
    s_waitcnt lgkmcnt(0)
    v_mfma_f32_32x32x16_bf16 v[24:39], v[112:115], v[96:99], v[24:39]
    v_mfma_f32_32x32x16_bf16 v[40:55], v[112:115], v[100:103], v[40:55]
    v_mfma_f32_32x32x16_bf16 v[56:71], v[116:119], v[96:99], v[56:71]
    v_mfma_f32_32x32x16_bf16 v[72:87], v[116:119], v[100:103], v[72:87]
    s_waitcnt vmcnt(16)
    s_barrier
    s_add_u32 m0, s27, 32768
    s_add_u32 s26, s24, 0
    buffer_load_dwordx4 v10, s[4:7], s26 offen lds
    s_add_u32 m0, s27, 36864
    s_add_u32 s26, s24, 32768
    buffer_load_dwordx4 v10, s[4:7], s26 offen lds
    s_add_u32 m0, s27, 40960
    s_add_u32 s26, s24, 65536
    buffer_load_dwordx4 v10, s[4:7], s26 offen lds
    s_add_u32 m0, s27, 45056
    s_add_u32 s26, s24, 98304
    buffer_load_dwordx4 v10, s[4:7], s26 offen lds
    s_add_u32 m0, s27, 49152
    s_add_u32 s26, s25, 0
    buffer_load_dwordx4 v11, s[8:11], s26 offen lds
    s_add_u32 m0, s27, 53248
    s_add_u32 s26, s25, 57344
    buffer_load_dwordx4 v11, s[8:11], s26 offen lds
    s_add_u32 m0, s27, 57344
    s_add_u32 s26, s25, 114688
    buffer_load_dwordx4 v11, s[8:11], s26 offen lds
    s_add_u32 m0, s27, 61440
    s_add_u32 s26, s25, 172032
    buffer_load_dwordx4 v11, s[8:11], s26 offen lds
    s_add_u32 s24, s24, 128
    s_add_u32 s25, s25, 229376
    ds_read_b128 v[88:91], v124 offset:0
    ds_read_b128 v[92:95], v124 offset:4096
    ds_read_b64_tr_b16 v[104:105], v130 offset:16384
    ds_read_b64_tr_b16 v[106:107], v130 offset:17408
    ds_read_b64_tr_b16 v[108:109], v131 offset:16384
    ds_read_b64_tr_b16 v[110:111], v131 offset:17408
    ds_read_b128 v[96:99], v125 offset:0
    ds_read_b128 v[100:103], v125 offset:4096
    ds_read_b64_tr_b16 v[112:113], v130 offset:20480
    ds_read_b64_tr_b16 v[114:115], v130 offset:21504
    ds_read_b64_tr_b16 v[116:117], v131 offset:20480
    ds_read_b64_tr_b16 v[118:119], v131 offset:21504
    s_waitcnt lgkmcnt(6)
    v_mfma_f32_32x32x16_bf16 v[24:39], v[104:107], v[88:91], v[24:39]
    v_mfma_f32_32x32x16_bf16 v[40:55], v[104:107], v[92:95], v[40:55]
    v_mfma_f32_32x32x16_bf16 v[56:71], v[108:111], v[88:91], v[56:71]
    v_mfma_f32_32x32x16_bf16 v[72:87], v[108:111], v[92:95], v[72:87]
    ds_read_b128 v[88:91], v126 offset:0
    ds_read_b128 v[92:95], v126 offset:4096
    ds_read_b64_tr_b16 v[104:105], v130 offset:24576
    ds_read_b64_tr_b16 v[106:107], v130 offset:25600
    ds_read_b64_tr_b16 v[108:109], v131 offset:24576
    ds_read_b64_tr_b16 v[110:111], v131 offset:25600
    s_waitcnt lgkmcnt(6)
    v_mfma_f32_32x32x16_bf16 v[24:39], v[112:115], v[96:99], v[24:39]
    v_mfma_f32_32x32x16_bf16 v[40:55], v[112:115], v[100:103], v[40:55]
    v_mfma_f32_32x32x16_bf16 v[56:71], v[116:119], v[96:99], v[56:71]
    v_mfma_f32_32x32x16_bf16 v[72:87], v[116:119], v[100:103], v[72:87]
    ds_read_b128 v[96:99], v127 offset:0
    ds_read_b128 v[100:103], v127 offset:4096
    ds_read_b64_tr_b16 v[112:113], v130 offset:28672
    ds_read_b64_tr_b16 v[114:115], v130 offset:29696
    ds_read_b64_tr_b16 v[116:117], v131 offset:28672
    ds_read_b64_tr_b16 v[118:119], v131 offset:29696
    s_waitcnt lgkmcnt(6)
    v_mfma_f32_32x32x16_bf16 v[24:39], v[104:107], v[88:91], v[24:39]
    v_mfma_f32_32x32x16_bf16 v[40:55], v[104:107], v[92:95], v[40:55]
    v_mfma_f32_32x32x16_bf16 v[56:71], v[108:111], v[88:91], v[56:71]
    v_mfma_f32_32x32x16_bf16 v[72:87], v[108:111], v[92:95], v[72:87]
    s_waitcnt lgkmcnt(0)
    v_mfma_f32_32x32x16_bf16 v[24:39], v[112:115], v[96:99], v[24:39]
    v_mfma_f32_32x32x16_bf16 v[40:55], v[112:115], v[100:103], v[40:55]
    v_mfma_f32_32x32x16_bf16 v[56:71], v[116:119], v[96:99], v[56:71]
    v_mfma_f32_32x32x16_bf16 v[72:87], v[116:119], v[100:103], v[72:87]
    s_waitcnt vmcnt(16)
    s_barrier
    s_add_u32 m0, s27, 65536
    s_add_u32 s26, s24, 0
    buffer_load_dwordx4 v10, s[4:7], s26 offen lds
    s_add_u32 m0, s27, 69632
    s_add_u32 s26, s24, 32768
    buffer_load_dwordx4 v10, s[4:7], s26 offen lds
    s_add_u32 m0, s27, 73728
    s_add_u32 s26, s24, 65536
    buffer_load_dwordx4 v10, s[4:7], s26 offen lds
    s_add_u32 m0, s27, 77824
    s_add_u32 s26, s24, 98304
    buffer_load_dwordx4 v10, s[4:7], s26 offen lds
    s_add_u32 m0, s27, 81920
    s_add_u32 s26, s25, 0
    buffer_load_dwordx4 v11, s[8:11], s26 offen lds
    s_add_u32 m0, s27, 86016
    s_add_u32 s26, s25, 57344
    buffer_load_dwordx4 v11, s[8:11], s26 offen lds
    s_add_u32 m0, s27, 90112
    s_add_u32 s26, s25, 114688
    buffer_load_dwordx4 v11, s[8:11], s26 offen lds
    s_add_u32 m0, s27, 94208
    s_add_u32 s26, s25, 172032
    buffer_load_dwordx4 v11, s[8:11], s26 offen lds
    s_add_u32 s24, s24, 128
    s_add_u32 s25, s25, 229376
    ds_read_b128 v[88:91], v124 offset:32768
    ds_read_b128 v[92:95], v124 offset:36864
    ds_read_b64_tr_b16 v[104:105], v130 offset:49152
    ds_read_b64_tr_b16 v[106:107], v130 offset:50176
    ds_read_b64_tr_b16 v[108:109], v131 offset:49152
    ds_read_b64_tr_b16 v[110:111], v131 offset:50176
    ds_read_b128 v[96:99], v125 offset:32768
    ds_read_b128 v[100:103], v125 offset:36864
    ds_read_b64_tr_b16 v[112:113], v130 offset:53248
    ds_read_b64_tr_b16 v[114:115], v130 offset:54272
    ds_read_b64_tr_b16 v[116:117], v131 offset:53248
    ds_read_b64_tr_b16 v[118:119], v131 offset:54272
    s_waitcnt lgkmcnt(6)
    v_mfma_f32_32x32x16_bf16 v[24:39], v[104:107], v[88:91], v[24:39]
    v_mfma_f32_32x32x16_bf16 v[40:55], v[104:107], v[92:95], v[40:55]
    v_mfma_f32_32x32x16_bf16 v[56:71], v[108:111], v[88:91], v[56:71]
    v_mfma_f32_32x32x16_bf16 v[72:87], v[108:111], v[92:95], v[72:87]
    ds_read_b128 v[88:91], v126 offset:32768
    ds_read_b128 v[92:95], v126 offset:36864
    ds_read_b64_tr_b16 v[104:105], v130 offset:57344
    ds_read_b64_tr_b16 v[106:107], v130 offset:58368
    ds_read_b64_tr_b16 v[108:109], v131 offset:57344
    ds_read_b64_tr_b16 v[110:111], v131 offset:58368
    s_waitcnt lgkmcnt(6)
    v_mfma_f32_32x32x16_bf16 v[24:39], v[112:115], v[96:99], v[24:39]
    v_mfma_f32_32x32x16_bf16 v[40:55], v[112:115], v[100:103], v[40:55]
    v_mfma_f32_32x32x16_bf16 v[56:71], v[116:119], v[96:99], v[56:71]
    v_mfma_f32_32x32x16_bf16 v[72:87], v[116:119], v[100:103], v[72:87]
    ds_read_b128 v[96:99], v127 offset:32768
    ds_read_b128 v[100:103], v127 offset:36864
    ds_read_b64_tr_b16 v[112:113], v130 offset:61440
    ds_read_b64_tr_b16 v[114:115], v130 offset:62464
    ds_read_b64_tr_b16 v[116:117], v131 offset:61440
    ds_read_b64_tr_b16 v[118:119], v131 offset:62464
    s_waitcnt lgkmcnt(6)
    v_mfma_f32_32x32x16_bf16 v[24:39], v[104:107], v[88:91], v[24:39]
    v_mfma_f32_32x32x16_bf16 v[40:55], v[104:107], v[92:95], v[40:55]
    v_mfma_f32_32x32x16_bf16 v[56:71], v[108:111], v[88:91], v[56:71]
    v_mfma_f32_32x32x16_bf16 v[72:87], v[108:111], v[92:95], v[72:87]
    s_waitcnt lgkmcnt(0)
    v_mfma_f32_32x32x16_bf16 v[24:39], v[112:115], v[96:99], v[24:39]
    v_mfma_f32_32x32x16_bf16 v[40:55], v[112:115], v[100:103], v[40:55]
    v_mfma_f32_32x32x16_bf16 v[56:71], v[116:119], v[96:99], v[56:71]
    v_mfma_f32_32x32x16_bf16 v[72:87], v[116:119], v[100:103], v[72:87]
    s_waitcnt vmcnt(16)
    s_barrier
    s_add_u32 m0, s27, 98304
    s_add_u32 s26, s24, 0
    buffer_load_dwordx4 v10, s[4:7], s26 offen lds
    s_add_u32 m0, s27, 102400
    s_add_u32 s26, s24, 32768
    buffer_load_dwordx4 v10, s[4:7], s26 offen lds
    s_add_u32 m0, s27, 106496
    s_add_u32 s26, s24, 65536
    buffer_load_dwordx4 v10, s[4:7], s26 offen lds
    s_add_u32 m0, s27, 110592
    s_add_u32 s26, s24, 98304
    buffer_load_dwordx4 v10, s[4:7], s26 offen lds
    s_add_u32 m0, s27, 114688
    s_add_u32 s26, s25, 0
    buffer_load_dwordx4 v11, s[8:11], s26 offen lds
    s_add_u32 m0, s27, 118784
    s_add_u32 s26, s25, 57344
    buffer_load_dwordx4 v11, s[8:11], s26 offen lds
    s_add_u32 m0, s27, 122880
    s_add_u32 s26, s25, 114688
    buffer_load_dwordx4 v11, s[8:11], s26 offen lds
    s_add_u32 m0, s27, 126976
    s_add_u32 s26, s25, 172032
    buffer_load_dwordx4 v11, s[8:11], s26 offen lds
    s_add_u32 s24, s24, 128
    s_add_u32 s25, s25, 229376
    ds_read_b128 v[88:91], v120 offset:0
    ds_read_b128 v[92:95], v120 offset:4096
    ds_read_b64_tr_b16 v[104:105], v128 offset:16384
    ds_read_b64_tr_b16 v[106:107], v128 offset:17408
    ds_read_b64_tr_b16 v[108:109], v129 offset:16384
    ds_read_b64_tr_b16 v[110:111], v129 offset:17408
    ds_read_b128 v[96:99], v121 offset:0
    ds_read_b128 v[100:103], v121 offset:4096
    ds_read_b64_tr_b16 v[112:113], v128 offset:20480
    ds_read_b64_tr_b16 v[114:115], v128 offset:21504
    ds_read_b64_tr_b16 v[116:117], v129 offset:20480
    ds_read_b64_tr_b16 v[118:119], v129 offset:21504
    s_waitcnt lgkmcnt(6)
    v_mfma_f32_32x32x16_bf16 v[24:39], v[104:107], v[88:91], v[24:39]
    v_mfma_f32_32x32x16_bf16 v[40:55], v[104:107], v[92:95], v[40:55]
    v_mfma_f32_32x32x16_bf16 v[56:71], v[108:111], v[88:91], v[56:71]
    v_mfma_f32_32x32x16_bf16 v[72:87], v[108:111], v[92:95], v[72:87]
    ds_read_b128 v[88:91], v122 offset:0
    ds_read_b128 v[92:95], v122 offset:4096
    ds_read_b64_tr_b16 v[104:105], v128 offset:24576
    ds_read_b64_tr_b16 v[106:107], v128 offset:25600
    ds_read_b64_tr_b16 v[108:109], v129 offset:24576
    ds_read_b64_tr_b16 v[110:111], v129 offset:25600
    s_waitcnt lgkmcnt(6)
    v_mfma_f32_32x32x16_bf16 v[24:39], v[112:115], v[96:99], v[24:39]
    v_mfma_f32_32x32x16_bf16 v[40:55], v[112:115], v[100:103], v[40:55]
    v_mfma_f32_32x32x16_bf16 v[56:71], v[116:119], v[96:99], v[56:71]
    v_mfma_f32_32x32x16_bf16 v[72:87], v[116:119], v[100:103], v[72:87]
    ds_read_b128 v[96:99], v123 offset:0
    ds_read_b128 v[100:103], v123 offset:4096
    ds_read_b64_tr_b16 v[112:113], v128 offset:28672
    ds_read_b64_tr_b16 v[114:115], v128 offset:29696
    ds_read_b64_tr_b16 v[116:117], v129 offset:28672
    ds_read_b64_tr_b16 v[118:119], v129 offset:29696
    s_waitcnt lgkmcnt(6)
    v_mfma_f32_32x32x16_bf16 v[24:39], v[104:107], v[88:91], v[24:39]
    v_mfma_f32_32x32x16_bf16 v[40:55], v[104:107], v[92:95], v[40:55]
    v_mfma_f32_32x32x16_bf16 v[56:71], v[108:111], v[88:91], v[56:71]
    v_mfma_f32_32x32x16_bf16 v[72:87], v[108:111], v[92:95], v[72:87]
    s_waitcnt lgkmcnt(0)
    v_mfma_f32_32x32x16_bf16 v[24:39], v[112:115], v[96:99], v[24:39]
    v_mfma_f32_32x32x16_bf16 v[40:55], v[112:115], v[100:103], v[40:55]
    v_mfma_f32_32x32x16_bf16 v[56:71], v[116:119], v[96:99], v[56:71]
    v_mfma_f32_32x32x16_bf16 v[72:87], v[116:119], v[100:103], v[72:87]
    s_waitcnt vmcnt(16)
    s_barrier
    ds_read_b128 v[88:91], v120 offset:32768
    ds_read_b128 v[92:95], v120 offset:36864
    ds_read_b64_tr_b16 v[104:105], v128 offset:49152
    ds_read_b64_tr_b16 v[106:107], v128 offset:50176
    ds_read_b64_tr_b16 v[108:109], v129 offset:49152
    ds_read_b64_tr_b16 v[110:111], v129 offset:50176
    ds_read_b128 v[96:99], v121 offset:32768
    ds_read_b128 v[100:103], v121 offset:36864
    ds_read_b64_tr_b16 v[112:113], v128 offset:53248
    ds_read_b64_tr_b16 v[114:115], v128 offset:54272
    ds_read_b64_tr_b16 v[116:117], v129 offset:53248
    ds_read_b64_tr_b16 v[118:119], v129 offset:54272
    s_waitcnt lgkmcnt(6)
    v_mfma_f32_32x32x16_bf16 v[24:39], v[104:107], v[88:91], v[24:39]
    v_mfma_f32_32x32x16_bf16 v[40:55], v[104:107], v[92:95], v[40:55]
    v_mfma_f32_32x32x16_bf16 v[56:71], v[108:111], v[88:91], v[56:71]
    v_mfma_f32_32x32x16_bf16 v[72:87], v[108:111], v[92:95], v[72:87]
    ds_read_b128 v[88:91], v122 offset:32768
    ds_read_b128 v[92:95], v122 offset:36864
    ds_read_b64_tr_b16 v[104:105], v128 offset:57344
    ds_read_b64_tr_b16 v[106:107], v128 offset:58368
    ds_read_b64_tr_b16 v[108:109], v129 offset:57344
    ds_read_b64_tr_b16 v[110:111], v129 offset:58368
    s_waitcnt lgkmcnt(6)
    v_mfma_f32_32x32x16_bf16 v[24:39], v[112:115], v[96:99], v[24:39]
    v_mfma_f32_32x32x16_bf16 v[40:55], v[112:115], v[100:103], v[40:55]
    v_mfma_f32_32x32x16_bf16 v[56:71], v[116:119], v[96:99], v[56:71]
    v_mfma_f32_32x32x16_bf16 v[72:87], v[116:119], v[100:103], v[72:87]
    ds_read_b128 v[96:99], v123 offset:32768
    ds_read_b128 v[100:103], v123 offset:36864
    ds_read_b64_tr_b16 v[112:113], v128 offset:61440
    ds_read_b64_tr_b16 v[114:115], v128 offset:62464
    ds_read_b64_tr_b16 v[116:117], v129 offset:61440
    ds_read_b64_tr_b16 v[118:119], v129 offset:62464
    s_waitcnt lgkmcnt(6)
    v_mfma_f32_32x32x16_bf16 v[24:39], v[104:107], v[88:91], v[24:39]
    v_mfma_f32_32x32x16_bf16 v[40:55], v[104:107], v[92:95], v[40:55]
    v_mfma_f32_32x32x16_bf16 v[56:71], v[108:111], v[88:91], v[56:71]
    v_mfma_f32_32x32x16_bf16 v[72:87], v[108:111], v[92:95], v[72:87]
    s_waitcnt lgkmcnt(0)
    v_mfma_f32_32x32x16_bf16 v[24:39], v[112:115], v[96:99], v[24:39]
    v_mfma_f32_32x32x16_bf16 v[40:55], v[112:115], v[100:103], v[40:55]
    v_mfma_f32_32x32x16_bf16 v[56:71], v[116:119], v[96:99], v[56:71]
    v_mfma_f32_32x32x16_bf16 v[72:87], v[116:119], v[100:103], v[72:87]
    s_waitcnt vmcnt(8)
    s_barrier
    ds_read_b128 v[88:91], v124 offset:0
    ds_read_b128 v[92:95], v124 offset:4096
    ds_read_b64_tr_b16 v[104:105], v130 offset:16384
    ds_read_b64_tr_b16 v[106:107], v130 offset:17408
    ds_read_b64_tr_b16 v[108:109], v131 offset:16384
    ds_read_b64_tr_b16 v[110:111], v131 offset:17408
    ds_read_b128 v[96:99], v125 offset:0
    ds_read_b128 v[100:103], v125 offset:4096
    ds_read_b64_tr_b16 v[112:113], v130 offset:20480
    ds_read_b64_tr_b16 v[114:115], v130 offset:21504
    ds_read_b64_tr_b16 v[116:117], v131 offset:20480
    ds_read_b64_tr_b16 v[118:119], v131 offset:21504
    s_waitcnt lgkmcnt(6)
    v_mfma_f32_32x32x16_bf16 v[24:39], v[104:107], v[88:91], v[24:39]
    v_mfma_f32_32x32x16_bf16 v[40:55], v[104:107], v[92:95], v[40:55]
    v_mfma_f32_32x32x16_bf16 v[56:71], v[108:111], v[88:91], v[56:71]
    v_mfma_f32_32x32x16_bf16 v[72:87], v[108:111], v[92:95], v[72:87]
    ds_read_b128 v[88:91], v126 offset:0
    ds_read_b128 v[92:95], v126 offset:4096
    ds_read_b64_tr_b16 v[104:105], v130 offset:24576
    ds_read_b64_tr_b16 v[106:107], v130 offset:25600
    ds_read_b64_tr_b16 v[108:109], v131 offset:24576
    ds_read_b64_tr_b16 v[110:111], v131 offset:25600
    s_waitcnt lgkmcnt(6)
    v_mfma_f32_32x32x16_bf16 v[24:39], v[112:115], v[96:99], v[24:39]
    v_mfma_f32_32x32x16_bf16 v[40:55], v[112:115], v[100:103], v[40:55]
    v_mfma_f32_32x32x16_bf16 v[56:71], v[116:119], v[96:99], v[56:71]
    v_mfma_f32_32x32x16_bf16 v[72:87], v[116:119], v[100:103], v[72:87]
    ds_read_b128 v[96:99], v127 offset:0
    ds_read_b128 v[100:103], v127 offset:4096
    ds_read_b64_tr_b16 v[112:113], v130 offset:28672
    ds_read_b64_tr_b16 v[114:115], v130 offset:29696
    ds_read_b64_tr_b16 v[116:117], v131 offset:28672
    ds_read_b64_tr_b16 v[118:119], v131 offset:29696
    s_waitcnt lgkmcnt(6)
    v_mfma_f32_32x32x16_bf16 v[24:39], v[104:107], v[88:91], v[24:39]
    v_mfma_f32_32x32x16_bf16 v[40:55], v[104:107], v[92:95], v[40:55]
    v_mfma_f32_32x32x16_bf16 v[56:71], v[108:111], v[88:91], v[56:71]
    v_mfma_f32_32x32x16_bf16 v[72:87], v[108:111], v[92:95], v[72:87]
    s_waitcnt lgkmcnt(0)
    v_mfma_f32_32x32x16_bf16 v[24:39], v[112:115], v[96:99], v[24:39]
    v_mfma_f32_32x32x16_bf16 v[40:55], v[112:115], v[100:103], v[40:55]
    v_mfma_f32_32x32x16_bf16 v[56:71], v[116:119], v[96:99], v[56:71]
    v_mfma_f32_32x32x16_bf16 v[72:87], v[116:119], v[100:103], v[72:87]
    s_waitcnt vmcnt(0)
    s_barrier
    ds_read_b128 v[88:91], v124 offset:32768
    ds_read_b128 v[92:95], v124 offset:36864
    ds_read_b64_tr_b16 v[104:105], v130 offset:49152
    ds_read_b64_tr_b16 v[106:107], v130 offset:50176
    ds_read_b64_tr_b16 v[108:109], v131 offset:49152
    ds_read_b64_tr_b16 v[110:111], v131 offset:50176
    ds_read_b128 v[96:99], v125 offset:32768
    ds_read_b128 v[100:103], v125 offset:36864
    ds_read_b64_tr_b16 v[112:113], v130 offset:53248
    ds_read_b64_tr_b16 v[114:115], v130 offset:54272
    ds_read_b64_tr_b16 v[116:117], v131 offset:53248
    ds_read_b64_tr_b16 v[118:119], v131 offset:54272
    s_waitcnt lgkmcnt(6)
    v_mfma_f32_32x32x16_bf16 v[24:39], v[104:107], v[88:91], v[24:39]
    v_mfma_f32_32x32x16_bf16 v[40:55], v[104:107], v[92:95], v[40:55]
    v_mfma_f32_32x32x16_bf16 v[56:71], v[108:111], v[88:91], v[56:71]
    v_mfma_f32_32x32x16_bf16 v[72:87], v[108:111], v[92:95], v[72:87]
    ds_read_b128 v[88:91], v126 offset:32768
    ds_read_b128 v[92:95], v126 offset:36864
    ds_read_b64_tr_b16 v[104:105], v130 offset:57344
    ds_read_b64_tr_b16 v[106:107], v130 offset:58368
    ds_read_b64_tr_b16 v[108:109], v131 offset:57344
    ds_read_b64_tr_b16 v[110:111], v131 offset:58368
    s_waitcnt lgkmcnt(6)
    v_mfma_f32_32x32x16_bf16 v[24:39], v[112:115], v[96:99], v[24:39]
    v_mfma_f32_32x32x16_bf16 v[40:55], v[112:115], v[100:103], v[40:55]
    v_mfma_f32_32x32x16_bf16 v[56:71], v[116:119], v[96:99], v[56:71]
    v_mfma_f32_32x32x16_bf16 v[72:87], v[116:119], v[100:103], v[72:87]
    ds_read_b128 v[96:99], v127 offset:32768
    ds_read_b128 v[100:103], v127 offset:36864
    ds_read_b64_tr_b16 v[112:113], v130 offset:61440
    ds_read_b64_tr_b16 v[114:115], v130 offset:62464
    ds_read_b64_tr_b16 v[116:117], v131 offset:61440
    ds_read_b64_tr_b16 v[118:119], v131 offset:62464
    s_waitcnt lgkmcnt(6)
    v_mfma_f32_32x32x16_bf16 v[24:39], v[104:107], v[88:91], v[24:39]
    v_mfma_f32_32x32x16_bf16 v[40:55], v[104:107], v[92:95], v[40:55]
    v_mfma_f32_32x32x16_bf16 v[56:71], v[108:111], v[88:91], v[56:71]
    v_mfma_f32_32x32x16_bf16 v[72:87], v[108:111], v[92:95], v[72:87]
    s_waitcnt lgkmcnt(0)
    v_mfma_f32_32x32x16_bf16 v[24:39], v[112:115], v[96:99], v[24:39]
    v_mfma_f32_32x32x16_bf16 v[40:55], v[112:115], v[100:103], v[40:55]
    v_mfma_f32_32x32x16_bf16 v[56:71], v[116:119], v[96:99], v[56:71]
    v_mfma_f32_32x32x16_bf16 v[72:87], v[116:119], v[100:103], v[72:87]
    v_and_b32 v12, 31, v1
    s_mul_i32 s23, s21, 64
    s_add_u32 s23, s23, s19
    v_add_u32 v12, s23, v12
    v_lshrrev_b32 v13, 5, v1
    v_lshlrev_b32 v13, 2, v13
    s_mul_i32 s23, s22, 64
    s_add_u32 s23, s23, s20
    v_add_u32 v13, s23, v13
    s_load_dwordx2 s[12:13], s[0:1], 112
    s_waitcnt lgkmcnt(0)
    s_add_u32 s12, s12, 0x2800000
    s_addc_u32 s13, s13, 0
    s_and_b32 s13, s13, 0xffff
    s_mov_b32 s14, 0x700000
    s_mov_b32 s15, 0x00020000
    v_mul_u32_u24 v14, 3584, v12
    v_lshlrev_b32 v15, 1, v13
    v_add_u32 v14, v14, v15
    s_mov_b32 s23, 0
    v_cvt_pk_bf16_f32 v132, v24, v24
    v_lshlrev_b32 v132, 16, v132
    v_mul_f32 v136, v132, v132
    v_mul_f32 v136, 0xbdd2d3e8, v136
    v_add_f32 v136, 0xc0135761, v136
    v_mul_f32 v136, v136, v132
    v_exp_f32 v136, v136
    s_nop 0
    v_add_f32 v136, 1.0, v136
    v_rcp_f32 v136, v136
    s_nop 0
    v_mul_f32 v132, v132, v136
    v_cvt_pk_bf16_f32 v133, v25, v25
    v_lshlrev_b32 v133, 16, v133
    v_mul_f32 v137, v133, v133
    v_mul_f32 v137, 0xbdd2d3e8, v137
    v_add_f32 v137, 0xc0135761, v137
    v_mul_f32 v137, v137, v133
    v_exp_f32 v137, v137
    s_nop 0
    v_add_f32 v137, 1.0, v137
    v_rcp_f32 v137, v137
    s_nop 0
    v_mul_f32 v133, v133, v137
    v_cvt_pk_bf16_f32 v134, v26, v26
    v_lshlrev_b32 v134, 16, v134
    v_mul_f32 v138, v134, v134
    v_mul_f32 v138, 0xbdd2d3e8, v138
    v_add_f32 v138, 0xc0135761, v138
    v_mul_f32 v138, v138, v134
    v_exp_f32 v138, v138
    s_nop 0
    v_add_f32 v138, 1.0, v138
    v_rcp_f32 v138, v138
    s_nop 0
    v_mul_f32 v134, v134, v138
    v_cvt_pk_bf16_f32 v135, v27, v27
    v_lshlrev_b32 v135, 16, v135
    v_mul_f32 v139, v135, v135
    v_mul_f32 v139, 0xbdd2d3e8, v139
    v_add_f32 v139, 0xc0135761, v139
    v_mul_f32 v139, v139, v135
    v_exp_f32 v139, v139
    s_nop 0
    v_add_f32 v139, 1.0, v139
    v_rcp_f32 v139, v139
    s_nop 0
    v_mul_f32 v135, v135, v139
    v_cvt_pk_bf16_f32 v132, v132, v133
    v_cvt_pk_bf16_f32 v133, v134, v135
    buffer_store_dwordx2 v[132:133], v14, s[12:15], s23 offen offset:0
    v_cvt_pk_bf16_f32 v132, v28, v28
    v_lshlrev_b32 v132, 16, v132
    v_mul_f32 v136, v132, v132
    v_mul_f32 v136, 0xbdd2d3e8, v136
    v_add_f32 v136, 0xc0135761, v136
    v_mul_f32 v136, v136, v132
    v_exp_f32 v136, v136
    s_nop 0
    v_add_f32 v136, 1.0, v136
    v_rcp_f32 v136, v136
    s_nop 0
    v_mul_f32 v132, v132, v136
    v_cvt_pk_bf16_f32 v133, v29, v29
    v_lshlrev_b32 v133, 16, v133
    v_mul_f32 v137, v133, v133
    v_mul_f32 v137, 0xbdd2d3e8, v137
    v_add_f32 v137, 0xc0135761, v137
    v_mul_f32 v137, v137, v133
    v_exp_f32 v137, v137
    s_nop 0
    v_add_f32 v137, 1.0, v137
    v_rcp_f32 v137, v137
    s_nop 0
    v_mul_f32 v133, v133, v137
    v_cvt_pk_bf16_f32 v134, v30, v30
    v_lshlrev_b32 v134, 16, v134
    v_mul_f32 v138, v134, v134
    v_mul_f32 v138, 0xbdd2d3e8, v138
    v_add_f32 v138, 0xc0135761, v138
    v_mul_f32 v138, v138, v134
    v_exp_f32 v138, v138
    s_nop 0
    v_add_f32 v138, 1.0, v138
    v_rcp_f32 v138, v138
    s_nop 0
    v_mul_f32 v134, v134, v138
    v_cvt_pk_bf16_f32 v135, v31, v31
    v_lshlrev_b32 v135, 16, v135
    v_mul_f32 v139, v135, v135
    v_mul_f32 v139, 0xbdd2d3e8, v139
    v_add_f32 v139, 0xc0135761, v139
    v_mul_f32 v139, v139, v135
    v_exp_f32 v139, v139
    s_nop 0
    v_add_f32 v139, 1.0, v139
    v_rcp_f32 v139, v139
    s_nop 0
    v_mul_f32 v135, v135, v139
    v_cvt_pk_bf16_f32 v132, v132, v133
    v_cvt_pk_bf16_f32 v133, v134, v135
    buffer_store_dwordx2 v[132:133], v14, s[12:15], s23 offen offset:16
    v_cvt_pk_bf16_f32 v132, v32, v32
    v_lshlrev_b32 v132, 16, v132
    v_mul_f32 v136, v132, v132
    v_mul_f32 v136, 0xbdd2d3e8, v136
    v_add_f32 v136, 0xc0135761, v136
    v_mul_f32 v136, v136, v132
    v_exp_f32 v136, v136
    s_nop 0
    v_add_f32 v136, 1.0, v136
    v_rcp_f32 v136, v136
    s_nop 0
    v_mul_f32 v132, v132, v136
    v_cvt_pk_bf16_f32 v133, v33, v33
    v_lshlrev_b32 v133, 16, v133
    v_mul_f32 v137, v133, v133
    v_mul_f32 v137, 0xbdd2d3e8, v137
    v_add_f32 v137, 0xc0135761, v137
    v_mul_f32 v137, v137, v133
    v_exp_f32 v137, v137
    s_nop 0
    v_add_f32 v137, 1.0, v137
    v_rcp_f32 v137, v137
    s_nop 0
    v_mul_f32 v133, v133, v137
    v_cvt_pk_bf16_f32 v134, v34, v34
    v_lshlrev_b32 v134, 16, v134
    v_mul_f32 v138, v134, v134
    v_mul_f32 v138, 0xbdd2d3e8, v138
    v_add_f32 v138, 0xc0135761, v138
    v_mul_f32 v138, v138, v134
    v_exp_f32 v138, v138
    s_nop 0
    v_add_f32 v138, 1.0, v138
    v_rcp_f32 v138, v138
    s_nop 0
    v_mul_f32 v134, v134, v138
    v_cvt_pk_bf16_f32 v135, v35, v35
    v_lshlrev_b32 v135, 16, v135
    v_mul_f32 v139, v135, v135
    v_mul_f32 v139, 0xbdd2d3e8, v139
    v_add_f32 v139, 0xc0135761, v139
    v_mul_f32 v139, v139, v135
    v_exp_f32 v139, v139
    s_nop 0
    v_add_f32 v139, 1.0, v139
    v_rcp_f32 v139, v139
    s_nop 0
    v_mul_f32 v135, v135, v139
    v_cvt_pk_bf16_f32 v132, v132, v133
    v_cvt_pk_bf16_f32 v133, v134, v135
    buffer_store_dwordx2 v[132:133], v14, s[12:15], s23 offen offset:32
    v_cvt_pk_bf16_f32 v132, v36, v36
    v_lshlrev_b32 v132, 16, v132
    v_mul_f32 v136, v132, v132
    v_mul_f32 v136, 0xbdd2d3e8, v136
    v_add_f32 v136, 0xc0135761, v136
    v_mul_f32 v136, v136, v132
    v_exp_f32 v136, v136
    s_nop 0
    v_add_f32 v136, 1.0, v136
    v_rcp_f32 v136, v136
    s_nop 0
    v_mul_f32 v132, v132, v136
    v_cvt_pk_bf16_f32 v133, v37, v37
    v_lshlrev_b32 v133, 16, v133
    v_mul_f32 v137, v133, v133
    v_mul_f32 v137, 0xbdd2d3e8, v137
    v_add_f32 v137, 0xc0135761, v137
    v_mul_f32 v137, v137, v133
    v_exp_f32 v137, v137
    s_nop 0
    v_add_f32 v137, 1.0, v137
    v_rcp_f32 v137, v137
    s_nop 0
    v_mul_f32 v133, v133, v137
    v_cvt_pk_bf16_f32 v134, v38, v38
    v_lshlrev_b32 v134, 16, v134
    v_mul_f32 v138, v134, v134
    v_mul_f32 v138, 0xbdd2d3e8, v138
    v_add_f32 v138, 0xc0135761, v138
    v_mul_f32 v138, v138, v134
    v_exp_f32 v138, v138
    s_nop 0
    v_add_f32 v138, 1.0, v138
    v_rcp_f32 v138, v138
    s_nop 0
    v_mul_f32 v134, v134, v138
    v_cvt_pk_bf16_f32 v135, v39, v39
    v_lshlrev_b32 v135, 16, v135
    v_mul_f32 v139, v135, v135
    v_mul_f32 v139, 0xbdd2d3e8, v139
    v_add_f32 v139, 0xc0135761, v139
    v_mul_f32 v139, v139, v135
    v_exp_f32 v139, v139
    s_nop 0
    v_add_f32 v139, 1.0, v139
    v_rcp_f32 v139, v139
    s_nop 0
    v_mul_f32 v135, v135, v139
    v_cvt_pk_bf16_f32 v132, v132, v133
    v_cvt_pk_bf16_f32 v133, v134, v135
    buffer_store_dwordx2 v[132:133], v14, s[12:15], s23 offen offset:48
    v_cvt_pk_bf16_f32 v132, v56, v56
    v_lshlrev_b32 v132, 16, v132
    v_mul_f32 v136, v132, v132
    v_mul_f32 v136, 0xbdd2d3e8, v136
    v_add_f32 v136, 0xc0135761, v136
    v_mul_f32 v136, v136, v132
    v_exp_f32 v136, v136
    s_nop 0
    v_add_f32 v136, 1.0, v136
    v_rcp_f32 v136, v136
    s_nop 0
    v_mul_f32 v132, v132, v136
    v_cvt_pk_bf16_f32 v133, v57, v57
    v_lshlrev_b32 v133, 16, v133
    v_mul_f32 v137, v133, v133
    v_mul_f32 v137, 0xbdd2d3e8, v137
    v_add_f32 v137, 0xc0135761, v137
    v_mul_f32 v137, v137, v133
    v_exp_f32 v137, v137
    s_nop 0
    v_add_f32 v137, 1.0, v137
    v_rcp_f32 v137, v137
    s_nop 0
    v_mul_f32 v133, v133, v137
    v_cvt_pk_bf16_f32 v134, v58, v58
    v_lshlrev_b32 v134, 16, v134
    v_mul_f32 v138, v134, v134
    v_mul_f32 v138, 0xbdd2d3e8, v138
    v_add_f32 v138, 0xc0135761, v138
    v_mul_f32 v138, v138, v134
    v_exp_f32 v138, v138
    s_nop 0
    v_add_f32 v138, 1.0, v138
    v_rcp_f32 v138, v138
    s_nop 0
    v_mul_f32 v134, v134, v138
    v_cvt_pk_bf16_f32 v135, v59, v59
    v_lshlrev_b32 v135, 16, v135
    v_mul_f32 v139, v135, v135
    v_mul_f32 v139, 0xbdd2d3e8, v139
    v_add_f32 v139, 0xc0135761, v139
    v_mul_f32 v139, v139, v135
    v_exp_f32 v139, v139
    s_nop 0
    v_add_f32 v139, 1.0, v139
    v_rcp_f32 v139, v139
    s_nop 0
    v_mul_f32 v135, v135, v139
    v_cvt_pk_bf16_f32 v132, v132, v133
    v_cvt_pk_bf16_f32 v133, v134, v135
    buffer_store_dwordx2 v[132:133], v14, s[12:15], s23 offen offset:64
    v_cvt_pk_bf16_f32 v132, v60, v60
    v_lshlrev_b32 v132, 16, v132
    v_mul_f32 v136, v132, v132
    v_mul_f32 v136, 0xbdd2d3e8, v136
    v_add_f32 v136, 0xc0135761, v136
    v_mul_f32 v136, v136, v132
    v_exp_f32 v136, v136
    s_nop 0
    v_add_f32 v136, 1.0, v136
    v_rcp_f32 v136, v136
    s_nop 0
    v_mul_f32 v132, v132, v136
    v_cvt_pk_bf16_f32 v133, v61, v61
    v_lshlrev_b32 v133, 16, v133
    v_mul_f32 v137, v133, v133
    v_mul_f32 v137, 0xbdd2d3e8, v137
    v_add_f32 v137, 0xc0135761, v137
    v_mul_f32 v137, v137, v133
    v_exp_f32 v137, v137
    s_nop 0
    v_add_f32 v137, 1.0, v137
    v_rcp_f32 v137, v137
    s_nop 0
    v_mul_f32 v133, v133, v137
    v_cvt_pk_bf16_f32 v134, v62, v62
    v_lshlrev_b32 v134, 16, v134
    v_mul_f32 v138, v134, v134
    v_mul_f32 v138, 0xbdd2d3e8, v138
    v_add_f32 v138, 0xc0135761, v138
    v_mul_f32 v138, v138, v134
    v_exp_f32 v138, v138
    s_nop 0
    v_add_f32 v138, 1.0, v138
    v_rcp_f32 v138, v138
    s_nop 0
    v_mul_f32 v134, v134, v138
    v_cvt_pk_bf16_f32 v135, v63, v63
    v_lshlrev_b32 v135, 16, v135
    v_mul_f32 v139, v135, v135
    v_mul_f32 v139, 0xbdd2d3e8, v139
    v_add_f32 v139, 0xc0135761, v139
    v_mul_f32 v139, v139, v135
    v_exp_f32 v139, v139
    s_nop 0
    v_add_f32 v139, 1.0, v139
    v_rcp_f32 v139, v139
    s_nop 0
    v_mul_f32 v135, v135, v139
    v_cvt_pk_bf16_f32 v132, v132, v133
    v_cvt_pk_bf16_f32 v133, v134, v135
    buffer_store_dwordx2 v[132:133], v14, s[12:15], s23 offen offset:80
    v_cvt_pk_bf16_f32 v132, v64, v64
    v_lshlrev_b32 v132, 16, v132
    v_mul_f32 v136, v132, v132
    v_mul_f32 v136, 0xbdd2d3e8, v136
    v_add_f32 v136, 0xc0135761, v136
    v_mul_f32 v136, v136, v132
    v_exp_f32 v136, v136
    s_nop 0
    v_add_f32 v136, 1.0, v136
    v_rcp_f32 v136, v136
    s_nop 0
    v_mul_f32 v132, v132, v136
    v_cvt_pk_bf16_f32 v133, v65, v65
    v_lshlrev_b32 v133, 16, v133
    v_mul_f32 v137, v133, v133
    v_mul_f32 v137, 0xbdd2d3e8, v137
    v_add_f32 v137, 0xc0135761, v137
    v_mul_f32 v137, v137, v133
    v_exp_f32 v137, v137
    s_nop 0
    v_add_f32 v137, 1.0, v137
    v_rcp_f32 v137, v137
    s_nop 0
    v_mul_f32 v133, v133, v137
    v_cvt_pk_bf16_f32 v134, v66, v66
    v_lshlrev_b32 v134, 16, v134
    v_mul_f32 v138, v134, v134
    v_mul_f32 v138, 0xbdd2d3e8, v138
    v_add_f32 v138, 0xc0135761, v138
    v_mul_f32 v138, v138, v134
    v_exp_f32 v138, v138
    s_nop 0
    v_add_f32 v138, 1.0, v138
    v_rcp_f32 v138, v138
    s_nop 0
    v_mul_f32 v134, v134, v138
    v_cvt_pk_bf16_f32 v135, v67, v67
    v_lshlrev_b32 v135, 16, v135
    v_mul_f32 v139, v135, v135
    v_mul_f32 v139, 0xbdd2d3e8, v139
    v_add_f32 v139, 0xc0135761, v139
    v_mul_f32 v139, v139, v135
    v_exp_f32 v139, v139
    s_nop 0
    v_add_f32 v139, 1.0, v139
    v_rcp_f32 v139, v139
    s_nop 0
    v_mul_f32 v135, v135, v139
    v_cvt_pk_bf16_f32 v132, v132, v133
    v_cvt_pk_bf16_f32 v133, v134, v135
    buffer_store_dwordx2 v[132:133], v14, s[12:15], s23 offen offset:96
    v_cvt_pk_bf16_f32 v132, v68, v68
    v_lshlrev_b32 v132, 16, v132
    v_mul_f32 v136, v132, v132
    v_mul_f32 v136, 0xbdd2d3e8, v136
    v_add_f32 v136, 0xc0135761, v136
    v_mul_f32 v136, v136, v132
    v_exp_f32 v136, v136
    s_nop 0
    v_add_f32 v136, 1.0, v136
    v_rcp_f32 v136, v136
    s_nop 0
    v_mul_f32 v132, v132, v136
    v_cvt_pk_bf16_f32 v133, v69, v69
    v_lshlrev_b32 v133, 16, v133
    v_mul_f32 v137, v133, v133
    v_mul_f32 v137, 0xbdd2d3e8, v137
    v_add_f32 v137, 0xc0135761, v137
    v_mul_f32 v137, v137, v133
    v_exp_f32 v137, v137
    s_nop 0
    v_add_f32 v137, 1.0, v137
    v_rcp_f32 v137, v137
    s_nop 0
    v_mul_f32 v133, v133, v137
    v_cvt_pk_bf16_f32 v134, v70, v70
    v_lshlrev_b32 v134, 16, v134
    v_mul_f32 v138, v134, v134
    v_mul_f32 v138, 0xbdd2d3e8, v138
    v_add_f32 v138, 0xc0135761, v138
    v_mul_f32 v138, v138, v134
    v_exp_f32 v138, v138
    s_nop 0
    v_add_f32 v138, 1.0, v138
    v_rcp_f32 v138, v138
    s_nop 0
    v_mul_f32 v134, v134, v138
    v_cvt_pk_bf16_f32 v135, v71, v71
    v_lshlrev_b32 v135, 16, v135
    v_mul_f32 v139, v135, v135
    v_mul_f32 v139, 0xbdd2d3e8, v139
    v_add_f32 v139, 0xc0135761, v139
    v_mul_f32 v139, v139, v135
    v_exp_f32 v139, v139
    s_nop 0
    v_add_f32 v139, 1.0, v139
    v_rcp_f32 v139, v139
    s_nop 0
    v_mul_f32 v135, v135, v139
    v_cvt_pk_bf16_f32 v132, v132, v133
    v_cvt_pk_bf16_f32 v133, v134, v135
    buffer_store_dwordx2 v[132:133], v14, s[12:15], s23 offen offset:112
    s_mov_b32 s23, 114688
    v_cvt_pk_bf16_f32 v132, v40, v40
    v_lshlrev_b32 v132, 16, v132
    v_mul_f32 v136, v132, v132
    v_mul_f32 v136, 0xbdd2d3e8, v136
    v_add_f32 v136, 0xc0135761, v136
    v_mul_f32 v136, v136, v132
    v_exp_f32 v136, v136
    s_nop 0
    v_add_f32 v136, 1.0, v136
    v_rcp_f32 v136, v136
    s_nop 0
    v_mul_f32 v132, v132, v136
    v_cvt_pk_bf16_f32 v133, v41, v41
    v_lshlrev_b32 v133, 16, v133
    v_mul_f32 v137, v133, v133
    v_mul_f32 v137, 0xbdd2d3e8, v137
    v_add_f32 v137, 0xc0135761, v137
    v_mul_f32 v137, v137, v133
    v_exp_f32 v137, v137
    s_nop 0
    v_add_f32 v137, 1.0, v137
    v_rcp_f32 v137, v137
    s_nop 0
    v_mul_f32 v133, v133, v137
    v_cvt_pk_bf16_f32 v134, v42, v42
    v_lshlrev_b32 v134, 16, v134
    v_mul_f32 v138, v134, v134
    v_mul_f32 v138, 0xbdd2d3e8, v138
    v_add_f32 v138, 0xc0135761, v138
    v_mul_f32 v138, v138, v134
    v_exp_f32 v138, v138
    s_nop 0
    v_add_f32 v138, 1.0, v138
    v_rcp_f32 v138, v138
    s_nop 0
    v_mul_f32 v134, v134, v138
    v_cvt_pk_bf16_f32 v135, v43, v43
    v_lshlrev_b32 v135, 16, v135
    v_mul_f32 v139, v135, v135
    v_mul_f32 v139, 0xbdd2d3e8, v139
    v_add_f32 v139, 0xc0135761, v139
    v_mul_f32 v139, v139, v135
    v_exp_f32 v139, v139
    s_nop 0
    v_add_f32 v139, 1.0, v139
    v_rcp_f32 v139, v139
    s_nop 0
    v_mul_f32 v135, v135, v139
    v_cvt_pk_bf16_f32 v132, v132, v133
    v_cvt_pk_bf16_f32 v133, v134, v135
    buffer_store_dwordx2 v[132:133], v14, s[12:15], s23 offen offset:0
    v_cvt_pk_bf16_f32 v132, v44, v44
    v_lshlrev_b32 v132, 16, v132
    v_mul_f32 v136, v132, v132
    v_mul_f32 v136, 0xbdd2d3e8, v136
    v_add_f32 v136, 0xc0135761, v136
    v_mul_f32 v136, v136, v132
    v_exp_f32 v136, v136
    s_nop 0
    v_add_f32 v136, 1.0, v136
    v_rcp_f32 v136, v136
    s_nop 0
    v_mul_f32 v132, v132, v136
    v_cvt_pk_bf16_f32 v133, v45, v45
    v_lshlrev_b32 v133, 16, v133
    v_mul_f32 v137, v133, v133
    v_mul_f32 v137, 0xbdd2d3e8, v137
    v_add_f32 v137, 0xc0135761, v137
    v_mul_f32 v137, v137, v133
    v_exp_f32 v137, v137
    s_nop 0
    v_add_f32 v137, 1.0, v137
    v_rcp_f32 v137, v137
    s_nop 0
    v_mul_f32 v133, v133, v137
    v_cvt_pk_bf16_f32 v134, v46, v46
    v_lshlrev_b32 v134, 16, v134
    v_mul_f32 v138, v134, v134
    v_mul_f32 v138, 0xbdd2d3e8, v138
    v_add_f32 v138, 0xc0135761, v138
    v_mul_f32 v138, v138, v134
    v_exp_f32 v138, v138
    s_nop 0
    v_add_f32 v138, 1.0, v138
    v_rcp_f32 v138, v138
    s_nop 0
    v_mul_f32 v134, v134, v138
    v_cvt_pk_bf16_f32 v135, v47, v47
    v_lshlrev_b32 v135, 16, v135
    v_mul_f32 v139, v135, v135
    v_mul_f32 v139, 0xbdd2d3e8, v139
    v_add_f32 v139, 0xc0135761, v139
    v_mul_f32 v139, v139, v135
    v_exp_f32 v139, v139
    s_nop 0
    v_add_f32 v139, 1.0, v139
    v_rcp_f32 v139, v139
    s_nop 0
    v_mul_f32 v135, v135, v139
    v_cvt_pk_bf16_f32 v132, v132, v133
    v_cvt_pk_bf16_f32 v133, v134, v135
    buffer_store_dwordx2 v[132:133], v14, s[12:15], s23 offen offset:16
    v_cvt_pk_bf16_f32 v132, v48, v48
    v_lshlrev_b32 v132, 16, v132
    v_mul_f32 v136, v132, v132
    v_mul_f32 v136, 0xbdd2d3e8, v136
    v_add_f32 v136, 0xc0135761, v136
    v_mul_f32 v136, v136, v132
    v_exp_f32 v136, v136
    s_nop 0
    v_add_f32 v136, 1.0, v136
    v_rcp_f32 v136, v136
    s_nop 0
    v_mul_f32 v132, v132, v136
    v_cvt_pk_bf16_f32 v133, v49, v49
    v_lshlrev_b32 v133, 16, v133
    v_mul_f32 v137, v133, v133
    v_mul_f32 v137, 0xbdd2d3e8, v137
    v_add_f32 v137, 0xc0135761, v137
    v_mul_f32 v137, v137, v133
    v_exp_f32 v137, v137
    s_nop 0
    v_add_f32 v137, 1.0, v137
    v_rcp_f32 v137, v137
    s_nop 0
    v_mul_f32 v133, v133, v137
    v_cvt_pk_bf16_f32 v134, v50, v50
    v_lshlrev_b32 v134, 16, v134
    v_mul_f32 v138, v134, v134
    v_mul_f32 v138, 0xbdd2d3e8, v138
    v_add_f32 v138, 0xc0135761, v138
    v_mul_f32 v138, v138, v134
    v_exp_f32 v138, v138
    s_nop 0
    v_add_f32 v138, 1.0, v138
    v_rcp_f32 v138, v138
    s_nop 0
    v_mul_f32 v134, v134, v138
    v_cvt_pk_bf16_f32 v135, v51, v51
    v_lshlrev_b32 v135, 16, v135
    v_mul_f32 v139, v135, v135
    v_mul_f32 v139, 0xbdd2d3e8, v139
    v_add_f32 v139, 0xc0135761, v139
    v_mul_f32 v139, v139, v135
    v_exp_f32 v139, v139
    s_nop 0
    v_add_f32 v139, 1.0, v139
    v_rcp_f32 v139, v139
    s_nop 0
    v_mul_f32 v135, v135, v139
    v_cvt_pk_bf16_f32 v132, v132, v133
    v_cvt_pk_bf16_f32 v133, v134, v135
    buffer_store_dwordx2 v[132:133], v14, s[12:15], s23 offen offset:32
    v_cvt_pk_bf16_f32 v132, v52, v52
    v_lshlrev_b32 v132, 16, v132
    v_mul_f32 v136, v132, v132
    v_mul_f32 v136, 0xbdd2d3e8, v136
    v_add_f32 v136, 0xc0135761, v136
    v_mul_f32 v136, v136, v132
    v_exp_f32 v136, v136
    s_nop 0
    v_add_f32 v136, 1.0, v136
    v_rcp_f32 v136, v136
    s_nop 0
    v_mul_f32 v132, v132, v136
    v_cvt_pk_bf16_f32 v133, v53, v53
    v_lshlrev_b32 v133, 16, v133
    v_mul_f32 v137, v133, v133
    v_mul_f32 v137, 0xbdd2d3e8, v137
    v_add_f32 v137, 0xc0135761, v137
    v_mul_f32 v137, v137, v133
    v_exp_f32 v137, v137
    s_nop 0
    v_add_f32 v137, 1.0, v137
    v_rcp_f32 v137, v137
    s_nop 0
    v_mul_f32 v133, v133, v137
    v_cvt_pk_bf16_f32 v134, v54, v54
    v_lshlrev_b32 v134, 16, v134
    v_mul_f32 v138, v134, v134
    v_mul_f32 v138, 0xbdd2d3e8, v138
    v_add_f32 v138, 0xc0135761, v138
    v_mul_f32 v138, v138, v134
    v_exp_f32 v138, v138
    s_nop 0
    v_add_f32 v138, 1.0, v138
    v_rcp_f32 v138, v138
    s_nop 0
    v_mul_f32 v134, v134, v138
    v_cvt_pk_bf16_f32 v135, v55, v55
    v_lshlrev_b32 v135, 16, v135
    v_mul_f32 v139, v135, v135
    v_mul_f32 v139, 0xbdd2d3e8, v139
    v_add_f32 v139, 0xc0135761, v139
    v_mul_f32 v139, v139, v135
    v_exp_f32 v139, v139
    s_nop 0
    v_add_f32 v139, 1.0, v139
    v_rcp_f32 v139, v139
    s_nop 0
    v_mul_f32 v135, v135, v139
    v_cvt_pk_bf16_f32 v132, v132, v133
    v_cvt_pk_bf16_f32 v133, v134, v135
    buffer_store_dwordx2 v[132:133], v14, s[12:15], s23 offen offset:48
    v_cvt_pk_bf16_f32 v132, v72, v72
    v_lshlrev_b32 v132, 16, v132
    v_mul_f32 v136, v132, v132
    v_mul_f32 v136, 0xbdd2d3e8, v136
    v_add_f32 v136, 0xc0135761, v136
    v_mul_f32 v136, v136, v132
    v_exp_f32 v136, v136
    s_nop 0
    v_add_f32 v136, 1.0, v136
    v_rcp_f32 v136, v136
    s_nop 0
    v_mul_f32 v132, v132, v136
    v_cvt_pk_bf16_f32 v133, v73, v73
    v_lshlrev_b32 v133, 16, v133
    v_mul_f32 v137, v133, v133
    v_mul_f32 v137, 0xbdd2d3e8, v137
    v_add_f32 v137, 0xc0135761, v137
    v_mul_f32 v137, v137, v133
    v_exp_f32 v137, v137
    s_nop 0
    v_add_f32 v137, 1.0, v137
    v_rcp_f32 v137, v137
    s_nop 0
    v_mul_f32 v133, v133, v137
    v_cvt_pk_bf16_f32 v134, v74, v74
    v_lshlrev_b32 v134, 16, v134
    v_mul_f32 v138, v134, v134
    v_mul_f32 v138, 0xbdd2d3e8, v138
    v_add_f32 v138, 0xc0135761, v138
    v_mul_f32 v138, v138, v134
    v_exp_f32 v138, v138
    s_nop 0
    v_add_f32 v138, 1.0, v138
    v_rcp_f32 v138, v138
    s_nop 0
    v_mul_f32 v134, v134, v138
    v_cvt_pk_bf16_f32 v135, v75, v75
    v_lshlrev_b32 v135, 16, v135
    v_mul_f32 v139, v135, v135
    v_mul_f32 v139, 0xbdd2d3e8, v139
    v_add_f32 v139, 0xc0135761, v139
    v_mul_f32 v139, v139, v135
    v_exp_f32 v139, v139
    s_nop 0
    v_add_f32 v139, 1.0, v139
    v_rcp_f32 v139, v139
    s_nop 0
    v_mul_f32 v135, v135, v139
    v_cvt_pk_bf16_f32 v132, v132, v133
    v_cvt_pk_bf16_f32 v133, v134, v135
    buffer_store_dwordx2 v[132:133], v14, s[12:15], s23 offen offset:64
    v_cvt_pk_bf16_f32 v132, v76, v76
    v_lshlrev_b32 v132, 16, v132
    v_mul_f32 v136, v132, v132
    v_mul_f32 v136, 0xbdd2d3e8, v136
    v_add_f32 v136, 0xc0135761, v136
    v_mul_f32 v136, v136, v132
    v_exp_f32 v136, v136
    s_nop 0
    v_add_f32 v136, 1.0, v136
    v_rcp_f32 v136, v136
    s_nop 0
    v_mul_f32 v132, v132, v136
    v_cvt_pk_bf16_f32 v133, v77, v77
    v_lshlrev_b32 v133, 16, v133
    v_mul_f32 v137, v133, v133
    v_mul_f32 v137, 0xbdd2d3e8, v137
    v_add_f32 v137, 0xc0135761, v137
    v_mul_f32 v137, v137, v133
    v_exp_f32 v137, v137
    s_nop 0
    v_add_f32 v137, 1.0, v137
    v_rcp_f32 v137, v137
    s_nop 0
    v_mul_f32 v133, v133, v137
    v_cvt_pk_bf16_f32 v134, v78, v78
    v_lshlrev_b32 v134, 16, v134
    v_mul_f32 v138, v134, v134
    v_mul_f32 v138, 0xbdd2d3e8, v138
    v_add_f32 v138, 0xc0135761, v138
    v_mul_f32 v138, v138, v134
    v_exp_f32 v138, v138
    s_nop 0
    v_add_f32 v138, 1.0, v138
    v_rcp_f32 v138, v138
    s_nop 0
    v_mul_f32 v134, v134, v138
    v_cvt_pk_bf16_f32 v135, v79, v79
    v_lshlrev_b32 v135, 16, v135
    v_mul_f32 v139, v135, v135
    v_mul_f32 v139, 0xbdd2d3e8, v139
    v_add_f32 v139, 0xc0135761, v139
    v_mul_f32 v139, v139, v135
    v_exp_f32 v139, v139
    s_nop 0
    v_add_f32 v139, 1.0, v139
    v_rcp_f32 v139, v139
    s_nop 0
    v_mul_f32 v135, v135, v139
    v_cvt_pk_bf16_f32 v132, v132, v133
    v_cvt_pk_bf16_f32 v133, v134, v135
    buffer_store_dwordx2 v[132:133], v14, s[12:15], s23 offen offset:80
    v_cvt_pk_bf16_f32 v132, v80, v80
    v_lshlrev_b32 v132, 16, v132
    v_mul_f32 v136, v132, v132
    v_mul_f32 v136, 0xbdd2d3e8, v136
    v_add_f32 v136, 0xc0135761, v136
    v_mul_f32 v136, v136, v132
    v_exp_f32 v136, v136
    s_nop 0
    v_add_f32 v136, 1.0, v136
    v_rcp_f32 v136, v136
    s_nop 0
    v_mul_f32 v132, v132, v136
    v_cvt_pk_bf16_f32 v133, v81, v81
    v_lshlrev_b32 v133, 16, v133
    v_mul_f32 v137, v133, v133
    v_mul_f32 v137, 0xbdd2d3e8, v137
    v_add_f32 v137, 0xc0135761, v137
    v_mul_f32 v137, v137, v133
    v_exp_f32 v137, v137
    s_nop 0
    v_add_f32 v137, 1.0, v137
    v_rcp_f32 v137, v137
    s_nop 0
    v_mul_f32 v133, v133, v137
    v_cvt_pk_bf16_f32 v134, v82, v82
    v_lshlrev_b32 v134, 16, v134
    v_mul_f32 v138, v134, v134
    v_mul_f32 v138, 0xbdd2d3e8, v138
    v_add_f32 v138, 0xc0135761, v138
    v_mul_f32 v138, v138, v134
    v_exp_f32 v138, v138
    s_nop 0
    v_add_f32 v138, 1.0, v138
    v_rcp_f32 v138, v138
    s_nop 0
    v_mul_f32 v134, v134, v138
    v_cvt_pk_bf16_f32 v135, v83, v83
    v_lshlrev_b32 v135, 16, v135
    v_mul_f32 v139, v135, v135
    v_mul_f32 v139, 0xbdd2d3e8, v139
    v_add_f32 v139, 0xc0135761, v139
    v_mul_f32 v139, v139, v135
    v_exp_f32 v139, v139
    s_nop 0
    v_add_f32 v139, 1.0, v139
    v_rcp_f32 v139, v139
    s_nop 0
    v_mul_f32 v135, v135, v139
    v_cvt_pk_bf16_f32 v132, v132, v133
    v_cvt_pk_bf16_f32 v133, v134, v135
    buffer_store_dwordx2 v[132:133], v14, s[12:15], s23 offen offset:96
    v_cvt_pk_bf16_f32 v132, v84, v84
    v_lshlrev_b32 v132, 16, v132
    v_mul_f32 v136, v132, v132
    v_mul_f32 v136, 0xbdd2d3e8, v136
    v_add_f32 v136, 0xc0135761, v136
    v_mul_f32 v136, v136, v132
    v_exp_f32 v136, v136
    s_nop 0
    v_add_f32 v136, 1.0, v136
    v_rcp_f32 v136, v136
    s_nop 0
    v_mul_f32 v132, v132, v136
    v_cvt_pk_bf16_f32 v133, v85, v85
    v_lshlrev_b32 v133, 16, v133
    v_mul_f32 v137, v133, v133
    v_mul_f32 v137, 0xbdd2d3e8, v137
    v_add_f32 v137, 0xc0135761, v137
    v_mul_f32 v137, v137, v133
    v_exp_f32 v137, v137
    s_nop 0
    v_add_f32 v137, 1.0, v137
    v_rcp_f32 v137, v137
    s_nop 0
    v_mul_f32 v133, v133, v137
    v_cvt_pk_bf16_f32 v134, v86, v86
    v_lshlrev_b32 v134, 16, v134
    v_mul_f32 v138, v134, v134
    v_mul_f32 v138, 0xbdd2d3e8, v138
    v_add_f32 v138, 0xc0135761, v138
    v_mul_f32 v138, v138, v134
    v_exp_f32 v138, v138
    s_nop 0
    v_add_f32 v138, 1.0, v138
    v_rcp_f32 v138, v138
    s_nop 0
    v_mul_f32 v134, v134, v138
    v_cvt_pk_bf16_f32 v135, v87, v87
    v_lshlrev_b32 v135, 16, v135
    v_mul_f32 v139, v135, v135
    v_mul_f32 v139, 0xbdd2d3e8, v139
    v_add_f32 v139, 0xc0135761, v139
    v_mul_f32 v139, v139, v135
    v_exp_f32 v139, v139
    s_nop 0
    v_add_f32 v139, 1.0, v139
    v_rcp_f32 v139, v139
    s_nop 0
    v_mul_f32 v135, v135, v139
    v_cvt_pk_bf16_f32 v132, v132, v133
    v_cvt_pk_bf16_f32 v133, v134, v135
    buffer_store_dwordx2 v[132:133], v14, s[12:15], s23 offen offset:112
    s_nop 3
.Lend_gemmin_kernel:
    s_endpgm
.globl ln3_kernel
.p2align 8
.type ln3_kernel,@function
ln3_kernel:
    s_cmp_ge_u32 s2, 512
    s_cbranch_scc1 .Lend_ln3_kernel
    s_load_dwordx2 s[4:5], s[0:1], 112
    s_load_dwordx2 s[8:9], s[0:1], 112
    v_and_b32 v1, 63, v0
    v_lshrrev_b32 v2, 6, v0
    s_nop 0
    v_readfirstlane_b32 s3, v2
    s_waitcnt lgkmcnt(0)
    s_add_u32 s4, s4, 0x2800000
    s_addc_u32 s5, s5, 0
    s_and_b32 s5, s5, 0xffff
    s_mov_b32 s6, 0x700000
    s_mov_b32 s7, 0x00020000
    s_add_u32 s8, s8, 0x3000000
    s_addc_u32 s9, s9, 0
    s_and_b32 s9, s9, 0xffff
    s_mov_b32 s10, 0x380000
    s_mov_b32 s11, 0x00020000
    s_lshl_b32 s16, s2, 2
    s_add_u32 s16, s16, s3
    s_mul_i32 s17, s16, 3584
    s_add_u32 s17, s17, 1792
    s_mul_i32 s18, s16, 1792
    v_mul_u32_u24 v3, 28, v1
    buffer_load_dwordx4 v[4:7], v3, s[4:7], s17 offen
    buffer_load_dwordx3 v[8:10], v3, s[4:7], s17 offen offset:16
    s_waitcnt vmcnt(0)
    v_lshlrev_b32 v40, 16, v4
    v_and_b32 v41, 0xffff0000, v4
    v_lshlrev_b32 v42, 16, v5
    v_and_b32 v43, 0xffff0000, v5
    v_lshlrev_b32 v44, 16, v6
    v_and_b32 v45, 0xffff0000, v6
    v_lshlrev_b32 v46, 16, v7
    v_and_b32 v47, 0xffff0000, v7
    v_lshlrev_b32 v48, 16, v8
    v_and_b32 v49, 0xffff0000, v8
    v_lshlrev_b32 v50, 16, v9
    v_and_b32 v51, 0xffff0000, v9
    v_lshlrev_b32 v52, 16, v10
    v_and_b32 v53, 0xffff0000, v10
    v_add_f32 v30, v40, v41
    v_add_f32 v30, v30, v42
    v_add_f32 v30, v30, v43
    v_add_f32 v30, v30, v44
    v_add_f32 v30, v30, v45
    v_add_f32 v30, v30, v46
    v_add_f32 v30, v30, v47
    v_add_f32 v30, v30, v48
    v_add_f32 v30, v30, v49
    v_add_f32 v30, v30, v50
    v_add_f32 v30, v30, v51
    v_add_f32 v30, v30, v52
    v_add_f32 v30, v30, v53
    s_nop 1
    v_add_f32_dpp v30, v30, v30 quad_perm:[1,0,3,2] row_mask:0xf bank_mask:0xf
    s_nop 1
    v_add_f32_dpp v30, v30, v30 quad_perm:[2,3,0,1] row_mask:0xf bank_mask:0xf
    s_nop 1
    v_add_f32_dpp v30, v30, v30 row_half_mirror row_mask:0xf bank_mask:0xf
    s_nop 1
    v_add_f32_dpp v30, v30, v30 row_mirror row_mask:0xf bank_mask:0xf
    s_nop 1
    v_add_f32_dpp v30, v30, v30 row_bcast:15 row_mask:0xa bank_mask:0xf
    s_nop 1
    v_add_f32_dpp v30, v30, v30 row_bcast:31 row_mask:0xc bank_mask:0xf
    s_nop 0
    v_readlane_b32 s20, v30, 63
    s_nop 1
    v_mov_b32 v31, s20
    v_mul_f32 v31, 0x3a924925, v31
    v_sub_f32 v32, v40, v31
    v_mul_f32 v30, v32, v32
    v_sub_f32 v32, v41, v31
    v_fmac_f32 v30, v32, v32
    v_sub_f32 v32, v42, v31
    v_fmac_f32 v30, v32, v32
    v_sub_f32 v32, v43, v31
    v_fmac_f32 v30, v32, v32
    v_sub_f32 v32, v44, v31
    v_fmac_f32 v30, v32, v32
    v_sub_f32 v32, v45, v31
    v_fmac_f32 v30, v32, v32
    v_sub_f32 v32, v46, v31
    v_fmac_f32 v30, v32, v32
    v_sub_f32 v32, v47, v31
    v_fmac_f32 v30, v32, v32
    v_sub_f32 v32, v48, v31
    v_fmac_f32 v30, v32, v32
    v_sub_f32 v32, v49, v31
    v_fmac_f32 v30, v32, v32
    v_sub_f32 v32, v50, v31
    v_fmac_f32 v30, v32, v32
    v_sub_f32 v32, v51, v31
    v_fmac_f32 v30, v32, v32
    v_sub_f32 v32, v52, v31
    v_fmac_f32 v30, v32, v32
    v_sub_f32 v32, v53, v31
    v_fmac_f32 v30, v32, v32
    s_nop 1
    v_add_f32_dpp v30, v30, v30 quad_perm:[1,0,3,2] row_mask:0xf bank_mask:0xf
    s_nop 1
    v_add_f32_dpp v30, v30, v30 quad_perm:[2,3,0,1] row_mask:0xf bank_mask:0xf
    s_nop 1
    v_add_f32_dpp v30, v30, v30 row_half_mirror row_mask:0xf bank_mask:0xf
    s_nop 1
    v_add_f32_dpp v30, v30, v30 row_mirror row_mask:0xf bank_mask:0xf
    s_nop 1
    v_add_f32_dpp v30, v30, v30 row_bcast:15 row_mask:0xa bank_mask:0xf
    s_nop 1
    v_add_f32_dpp v30, v30, v30 row_bcast:31 row_mask:0xc bank_mask:0xf
    s_nop 0
    v_readlane_b32 s21, v30, 63
    s_nop 1
    v_mov_b32 v32, s21
    v_mul_f32 v32, 0x3a924925, v32
    v_cvt_pk_bf16_f32 v31, v31, v31
    v_lshlrev_b32 v31, 16, v31
    v_cvt_pk_bf16_f32 v32, v32, v32
    v_lshlrev_b32 v32, 16, v32
    v_add_f32 v32, 0x3727c5ac, v32
    v_cvt_pk_bf16_f32 v32, v32, v32
    v_lshlrev_b32 v32, 16, v32
    v_sqrt_f32 v32, v32
    s_nop 0
    v_cvt_pk_bf16_f32 v32, v32, v32
    v_lshlrev_b32 v32, 16, v32
    v_rcp_f32 v32, v32
    v_sub_f32 v40, v40, v31
    v_cvt_pk_bf16_f32 v40, v40, v40
    v_lshlrev_b32 v40, 16, v40
    v_mul_f32 v40, v40, v32
    v_cvt_pk_bf16_f32 v40, v40, v40
    v_lshlrev_b32 v40, 16, v40
    v_sub_f32 v41, v41, v31
    v_cvt_pk_bf16_f32 v41, v41, v41
    v_lshlrev_b32 v41, 16, v41
    v_mul_f32 v41, v41, v32
    v_cvt_pk_bf16_f32 v41, v41, v41
    v_lshlrev_b32 v41, 16, v41
    v_sub_f32 v42, v42, v31
    v_cvt_pk_bf16_f32 v42, v42, v42
    v_lshlrev_b32 v42, 16, v42
    v_mul_f32 v42, v42, v32
    v_cvt_pk_bf16_f32 v42, v42, v42
    v_lshlrev_b32 v42, 16, v42
    v_sub_f32 v43, v43, v31
    v_cvt_pk_bf16_f32 v43, v43, v43
    v_lshlrev_b32 v43, 16, v43
    v_mul_f32 v43, v43, v32
    v_cvt_pk_bf16_f32 v43, v43, v43
    v_lshlrev_b32 v43, 16, v43
    v_sub_f32 v44, v44, v31
    v_cvt_pk_bf16_f32 v44, v44, v44
    v_lshlrev_b32 v44, 16, v44
    v_mul_f32 v44, v44, v32
    v_cvt_pk_bf16_f32 v44, v44, v44
    v_lshlrev_b32 v44, 16, v44
    v_sub_f32 v45, v45, v31
    v_cvt_pk_bf16_f32 v45, v45, v45
    v_lshlrev_b32 v45, 16, v45
    v_mul_f32 v45, v45, v32
    v_cvt_pk_bf16_f32 v45, v45, v45
    v_lshlrev_b32 v45, 16, v45
    v_sub_f32 v46, v46, v31
    v_cvt_pk_bf16_f32 v46, v46, v46
    v_lshlrev_b32 v46, 16, v46
    v_mul_f32 v46, v46, v32
    v_cvt_pk_bf16_f32 v46, v46, v46
    v_lshlrev_b32 v46, 16, v46
    v_sub_f32 v47, v47, v31
    v_cvt_pk_bf16_f32 v47, v47, v47
    v_lshlrev_b32 v47, 16, v47
    v_mul_f32 v47, v47, v32
    v_cvt_pk_bf16_f32 v47, v47, v47
    v_lshlrev_b32 v47, 16, v47
    v_sub_f32 v48, v48, v31
    v_cvt_pk_bf16_f32 v48, v48, v48
    v_lshlrev_b32 v48, 16, v48
    v_mul_f32 v48, v48, v32
    v_cvt_pk_bf16_f32 v48, v48, v48
    v_lshlrev_b32 v48, 16, v48
    v_sub_f32 v49, v49, v31
    v_cvt_pk_bf16_f32 v49, v49, v49
    v_lshlrev_b32 v49, 16, v49
    v_mul_f32 v49, v49, v32
    v_cvt_pk_bf16_f32 v49, v49, v49
    v_lshlrev_b32 v49, 16, v49
    v_sub_f32 v50, v50, v31
    v_cvt_pk_bf16_f32 v50, v50, v50
    v_lshlrev_b32 v50, 16, v50
    v_mul_f32 v50, v50, v32
    v_cvt_pk_bf16_f32 v50, v50, v50
    v_lshlrev_b32 v50, 16, v50
    v_sub_f32 v51, v51, v31
    v_cvt_pk_bf16_f32 v51, v51, v51
    v_lshlrev_b32 v51, 16, v51
    v_mul_f32 v51, v51, v32
    v_cvt_pk_bf16_f32 v51, v51, v51
    v_lshlrev_b32 v51, 16, v51
    v_sub_f32 v52, v52, v31
    v_cvt_pk_bf16_f32 v52, v52, v52
    v_lshlrev_b32 v52, 16, v52
    v_mul_f32 v52, v52, v32
    v_cvt_pk_bf16_f32 v52, v52, v52
    v_lshlrev_b32 v52, 16, v52
    v_sub_f32 v53, v53, v31
    v_cvt_pk_bf16_f32 v53, v53, v53
    v_lshlrev_b32 v53, 16, v53
    v_mul_f32 v53, v53, v32
    v_cvt_pk_bf16_f32 v53, v53, v53
    v_lshlrev_b32 v53, 16, v53
    v_cvt_pk_bf16_f32 v4, v40, v41
    v_cvt_pk_bf16_f32 v5, v42, v43
    v_cvt_pk_bf16_f32 v6, v44, v45
    v_cvt_pk_bf16_f32 v7, v46, v47
    v_cvt_pk_bf16_f32 v8, v48, v49
    v_cvt_pk_bf16_f32 v9, v50, v51
    v_cvt_pk_bf16_f32 v10, v52, v53
    buffer_store_dwordx4 v[4:7], v3, s[8:11], s18 offen
    buffer_store_dwordx3 v[8:10], v3, s[8:11], s18 offen offset:16
    s_nop 2
.Lend_ln3_kernel:
    s_endpgm
.globl gemmsp_kernel
.p2align 8
.type gemmsp_kernel,@function
gemmsp_kernel:
    s_cmp_ge_u32 s2, 224
    s_cbranch_scc1 .Lend_gemmsp_kernel
    s_load_dwordx2 s[4:5], s[0:1], 56
    s_load_dwordx2 s[8:9], s[0:1], 112
    v_and_b32 v1, 63, v0
    v_lshrrev_b32 v12, 6, v0
    s_nop 0
    v_readfirstlane_b32 s3, v12
    s_mov_b32 s29, 0
    s_mov_b32 s16, s2
    s_mul_hi_u32 s17, s16, 0x24924925
    s_mul_i32 s18, s17, 7
    s_sub_u32 s18, s16, s18
    s_mul_i32 s19, s17, 64
    s_mul_i32 s20, s18, 128
    s_and_b32 s21, s3, 1
    s_lshr_b32 s22, s3, 1
    s_waitcnt lgkmcnt(0)
    s_and_b32 s5, s5, 0xffff
    s_mov_b32 s6, 0x800000
    s_mov_b32 s7, 0x00020000
    s_add_u32 s8, s8, 0x3000000
    s_addc_u32 s9, s9, 0
    s_and_b32 s9, s9, 0xffff
    s_mov_b32 s10, 0x380000
    s_mov_b32 s11, 0x00020000
    v_lshrrev_b32 v12, 3, v1
    v_mul_u32_u24 v10, 4096, v12
    v_lshrrev_b32 v13, 4, v1
    s_and_b32 s23, s3, 1
    s_lshl_b32 s23, s23, 2
    v_add_u32 v13, s23, v13
    v_and_b32 v13, 7, v13
    v_and_b32 v14, 7, v1
    v_xor_b32 v14, v14, v13
    v_lshlrev_b32 v14, 4, v14
    v_add_u32 v10, v10, v14
    v_lshrrev_b32 v12, 4, v1
    v_mul_u32_u24 v11, 1792, v12
    v_and_b32 v13, 3, v12
    v_lshlrev_b32 v13, 2, v13
    v_and_b32 v14, 15, v1
    v_xor_b32 v14, v14, v13
    v_lshlrev_b32 v14, 4, v14
    v_add_u32 v11, v11, v14
    s_lshl_b32 s23, s3, 3
    s_add_u32 s23, s23, s19
    s_mul_i32 s24, s23, 4096
    s_mul_i32 s25, s3, 7168
    s_lshl_b32 s23, s20, 1
    s_add_u32 s25, s25, s23
    s_lshl_b32 s27, s3, 10
    s_add_u32 m0, s27, 0
    s_add_u32 s26, s24, 0
    buffer_load_dwordx4 v10, s[4:7], s26 offen lds
    s_add_u32 m0, s27, 4096
    s_add_u32 s26, s24, 131072
    buffer_load_dwordx4 v10, s[4:7], s26 offen lds
    s_add_u32 m0, s27, 8192
    s_add_u32 s26, s25, 0
    buffer_load_dwordx4 v11, s[8:11], s26 offen lds
    s_add_u32 m0, s27, 12288
    s_add_u32 s26, s25, 28672
    buffer_load_dwordx4 v11, s[8:11], s26 offen lds
    s_add_u32 m0, s27, 16384
    s_add_u32 s26, s25, 57344
    buffer_load_dwordx4 v11, s[8:11], s26 offen lds
    s_add_u32 m0, s27, 20480
    s_add_u32 s26, s25, 86016
    buffer_load_dwordx4 v11, s[8:11], s26 offen lds
    s_add_u32 s24, s24, 128
    s_add_u32 s25, s25, 114688
    s_add_u32 m0, s27, 24576
    s_add_u32 s26, s24, 0
    buffer_load_dwordx4 v10, s[4:7], s26 offen lds
    s_add_u32 m0, s27, 28672
    s_add_u32 s26, s24, 131072
    buffer_load_dwordx4 v10, s[4:7], s26 offen lds
    s_add_u32 m0, s27, 32768
    s_add_u32 s26, s25, 0
    buffer_load_dwordx4 v11, s[8:11], s26 offen lds
    s_add_u32 m0, s27, 36864
    s_add_u32 s26, s25, 28672
    buffer_load_dwordx4 v11, s[8:11], s26 offen lds
    s_add_u32 m0, s27, 40960
    s_add_u32 s26, s25, 57344
    buffer_load_dwordx4 v11, s[8:11], s26 offen lds
    s_add_u32 m0, s27, 45056
    s_add_u32 s26, s25, 86016
    buffer_load_dwordx4 v11, s[8:11], s26 offen lds
    s_add_u32 s24, s24, 128
    s_add_u32 s25, s25, 114688
    s_add_u32 m0, s27, 49152
    s_add_u32 s26, s24, 0
    buffer_load_dwordx4 v10, s[4:7], s26 offen lds
    s_add_u32 m0, s27, 53248
    s_add_u32 s26, s24, 131072
    buffer_load_dwordx4 v10, s[4:7], s26 offen lds
    s_add_u32 m0, s27, 57344
    s_add_u32 s26, s25, 0
    buffer_load_dwordx4 v11, s[8:11], s26 offen lds
    s_add_u32 m0, s27, 61440
    s_add_u32 s26, s25, 28672
    buffer_load_dwordx4 v11, s[8:11], s26 offen lds
    s_add_u32 m0, s27, 65536
    s_add_u32 s26, s25, 57344
    buffer_load_dwordx4 v11, s[8:11], s26 offen lds
    s_add_u32 m0, s27, 69632
    s_add_u32 s26, s25, 86016
    buffer_load_dwordx4 v11, s[8:11], s26 offen lds
    s_add_u32 s24, s24, 128
    s_add_u32 s25, s25, 114688
    s_add_u32 m0, s27, 73728
    s_add_u32 s26, s24, 0
    buffer_load_dwordx4 v10, s[4:7], s26 offen lds
    s_add_u32 m0, s27, 77824
    s_add_u32 s26, s24, 131072
    buffer_load_dwordx4 v10, s[4:7], s26 offen lds
    s_add_u32 m0, s27, 81920
    s_add_u32 s26, s25, 0
    buffer_load_dwordx4 v11, s[8:11], s26 offen lds
    s_add_u32 m0, s27, 86016
    s_add_u32 s26, s25, 28672
    buffer_load_dwordx4 v11, s[8:11], s26 offen lds
    s_add_u32 m0, s27, 90112
    s_add_u32 s26, s25, 57344
    buffer_load_dwordx4 v11, s[8:11], s26 offen lds
    s_add_u32 m0, s27, 94208
    s_add_u32 s26, s25, 86016
    buffer_load_dwordx4 v11, s[8:11], s26 offen lds
    s_add_u32 s24, s24, 128
    s_add_u32 s25, s25, 114688
    s_add_u32 m0, s27, 98304
    s_add_u32 s26, s24, 0
    buffer_load_dwordx4 v10, s[4:7], s26 offen lds
    s_add_u32 m0, s27, 102400
    s_add_u32 s26, s24, 131072
    buffer_load_dwordx4 v10, s[4:7], s26 offen lds
    s_add_u32 m0, s27, 106496
    s_add_u32 s26, s25, 0
    buffer_load_dwordx4 v11, s[8:11], s26 offen lds
    s_add_u32 m0, s27, 110592
    s_add_u32 s26, s25, 28672
    buffer_load_dwordx4 v11, s[8:11], s26 offen lds
    s_add_u32 m0, s27, 114688
    s_add_u32 s26, s25, 57344
    buffer_load_dwordx4 v11, s[8:11], s26 offen lds
    s_add_u32 m0, s27, 118784
    s_add_u32 s26, s25, 86016
    buffer_load_dwordx4 v11, s[8:11], s26 offen lds
    s_add_u32 s24, s24, 128
    s_add_u32 s25, s25, 114688
    v_and_b32 v12, 31, v1
    s_mul_i32 s23, s21, 32
    v_add_u32 v12, s23, v12
    v_lshrrev_b32 v13, 1, v12
    v_and_b32 v13, 7, v13
    v_lshrrev_b32 v14, 5, v1
    v_lshlrev_b32 v12, 7, v12
    v_add_u32 v15, 0, v14
    v_xor_b32 v15, v15, v13
    v_lshlrev_b32 v15, 4, v15
    v_add_u32 v80, v12, v15
    v_add_u32 v15, 2, v14
    v_xor_b32 v15, v15, v13
    v_lshlrev_b32 v15, 4, v15
    v_add_u32 v81, v12, v15
    v_add_u32 v15, 4, v14
    v_xor_b32 v15, v15, v13
    v_lshlrev_b32 v15, 4, v15
    v_add_u32 v82, v12, v15
    v_add_u32 v15, 6, v14
    v_xor_b32 v15, v15, v13
    v_lshlrev_b32 v15, 4, v15
    v_add_u32 v83, v12, v15
    v_lshrrev_b32 v12, 2, v1
    v_and_b32 v12, 3, v12
    v_lshrrev_b32 v13, 5, v1
    v_lshlrev_b32 v13, 3, v13
    v_add_u32 v13, v13, v12
    v_mul_u32_u24 v13, 256, v13
    v_lshrrev_b32 v14, 4, v1
    v_and_b32 v14, 1, v14
    v_lshlrev_b32 v14, 1, v14
    v_and_b32 v15, 3, v1
    v_lshrrev_b32 v16, 1, v15
    v_add_u32 v14, v14, v16
    v_and_b32 v15, 1, v15
    v_lshlrev_b32 v15, 3, v15
    v_add_u32 v13, v13, v15
    v_lshlrev_b32 v12, 2, v12
    s_mul_i32 s23, s22, 8
    s_add_u32 s23, s23, 0
    v_add_u32 v15, s23, v14
    v_xor_b32 v15, v15, v12
    v_lshlrev_b32 v15, 4, v15
    v_add_u32 v92, v13, v15
    s_mul_i32 s23, s22, 8
    s_add_u32 s23, s23, 4
    v_add_u32 v15, s23, v14
    v_xor_b32 v15, v15, v12
    v_lshlrev_b32 v15, 4, v15
    v_add_u32 v93, v13, v15
    v_add_u32 v84, 0x10000, v80
    v_add_u32 v85, 0x10000, v81
    v_add_u32 v86, 0x10000, v82
    v_add_u32 v87, 0x10000, v83
    v_add_u32 v94, 0x10000, v92
    v_add_u32 v95, 0x10000, v93
    v_add_u32 v88, 0x20000, v80
    v_add_u32 v89, 0x20000, v81
    v_add_u32 v90, 0x20000, v82
    v_add_u32 v91, 0x20000, v83
    v_add_u32 v96, 0x20000, v92
    v_add_u32 v97, 0x20000, v93
    s_waitcnt vmcnt(24)
    s_barrier
    s_add_u32 m0, s27, 122880
    s_add_u32 s26, s24, 0
    buffer_load_dwordx4 v10, s[4:7], s26 offen lds
    s_add_u32 m0, s27, 126976
    s_add_u32 s26, s24, 131072
    buffer_load_dwordx4 v10, s[4:7], s26 offen lds
    s_add_u32 m0, s27, 131072
    s_add_u32 s26, s25, 0
    buffer_load_dwordx4 v11, s[8:11], s26 offen lds
    s_add_u32 m0, s27, 135168
    s_add_u32 s26, s25, 28672
    buffer_load_dwordx4 v11, s[8:11], s26 offen lds
    s_add_u32 m0, s27, 139264
    s_add_u32 s26, s25, 57344
    buffer_load_dwordx4 v11, s[8:11], s26 offen lds
    s_add_u32 m0, s27, 143360
    s_add_u32 s26, s25, 86016
    buffer_load_dwordx4 v11, s[8:11], s26 offen lds
    s_add_u32 s24, s24, 128
    s_add_u32 s25, s25, 114688
    ds_read_b128 v[56:59], v80 offset:0
    ds_read_b64_tr_b16 v[64:65], v92 offset:8192
    ds_read_b64_tr_b16 v[66:67], v92 offset:9216
    ds_read_b64_tr_b16 v[68:69], v93 offset:8192
    ds_read_b64_tr_b16 v[70:71], v93 offset:9216
    ds_read_b128 v[60:63], v81 offset:0
    ds_read_b64_tr_b16 v[72:73], v92 offset:12288
    ds_read_b64_tr_b16 v[74:75], v92 offset:13312
    ds_read_b64_tr_b16 v[76:77], v93 offset:12288
    ds_read_b64_tr_b16 v[78:79], v93 offset:13312
    s_waitcnt lgkmcnt(5)
    v_mfma_f32_32x32x16_bf16 v[24:39], v[64:67], v[56:59], 0
    v_mfma_f32_32x32x16_bf16 v[40:55], v[68:71], v[56:59], 0
    ds_read_b128 v[56:59], v82 offset:0
    ds_read_b64_tr_b16 v[64:65], v92 offset:16384
    ds_read_b64_tr_b16 v[66:67], v92 offset:17408
    ds_read_b64_tr_b16 v[68:69], v93 offset:16384
    ds_read_b64_tr_b16 v[70:71], v93 offset:17408
    s_waitcnt lgkmcnt(5)
    v_mfma_f32_32x32x16_bf16 v[24:39], v[72:75], v[60:63], v[24:39]
    v_mfma_f32_32x32x16_bf16 v[40:55], v[76:79], v[60:63], v[40:55]
    ds_read_b128 v[60:63], v83 offset:0
    ds_read_b64_tr_b16 v[72:73], v92 offset:20480
    ds_read_b64_tr_b16 v[74:75], v92 offset:21504
    ds_read_b64_tr_b16 v[76:77], v93 offset:20480
    ds_read_b64_tr_b16 v[78:79], v93 offset:21504
    s_waitcnt lgkmcnt(5)
    v_mfma_f32_32x32x16_bf16 v[24:39], v[64:67], v[56:59], v[24:39]
    v_mfma_f32_32x32x16_bf16 v[40:55], v[68:71], v[56:59], v[40:55]
    s_waitcnt lgkmcnt(0)
    v_mfma_f32_32x32x16_bf16 v[24:39], v[72:75], v[60:63], v[24:39]
    v_mfma_f32_32x32x16_bf16 v[40:55], v[76:79], v[60:63], v[40:55]
    s_waitcnt vmcnt(24)
    s_barrier
    s_add_u32 m0, s27, 0
    s_add_u32 s26, s24, 0
    buffer_load_dwordx4 v10, s[4:7], s26 offen lds
    s_add_u32 m0, s27, 4096
    s_add_u32 s26, s24, 131072
    buffer_load_dwordx4 v10, s[4:7], s26 offen lds
    s_add_u32 m0, s27, 8192
    s_add_u32 s26, s25, 0
    buffer_load_dwordx4 v11, s[8:11], s26 offen lds
    s_add_u32 m0, s27, 12288
    s_add_u32 s26, s25, 28672
    buffer_load_dwordx4 v11, s[8:11], s26 offen lds
    s_add_u32 m0, s27, 16384
    s_add_u32 s26, s25, 57344
    buffer_load_dwordx4 v11, s[8:11], s26 offen lds
    s_add_u32 m0, s27, 20480
    s_add_u32 s26, s25, 86016
    buffer_load_dwordx4 v11, s[8:11], s26 offen lds
    s_add_u32 s24, s24, 128
    s_add_u32 s25, s25, 114688
    ds_read_b128 v[56:59], v80 offset:24576
    ds_read_b64_tr_b16 v[64:65], v92 offset:32768
    ds_read_b64_tr_b16 v[66:67], v92 offset:33792
    ds_read_b64_tr_b16 v[68:69], v93 offset:32768
    ds_read_b64_tr_b16 v[70:71], v93 offset:33792
    ds_read_b128 v[60:63], v81 offset:24576
    ds_read_b64_tr_b16 v[72:73], v92 offset:36864
    ds_read_b64_tr_b16 v[74:75], v92 offset:37888
    ds_read_b64_tr_b16 v[76:77], v93 offset:36864
    ds_read_b64_tr_b16 v[78:79], v93 offset:37888
    s_waitcnt lgkmcnt(5)
    v_mfma_f32_32x32x16_bf16 v[24:39], v[64:67], v[56:59], v[24:39]
    v_mfma_f32_32x32x16_bf16 v[40:55], v[68:71], v[56:59], v[40:55]
    ds_read_b128 v[56:59], v82 offset:24576
    ds_read_b64_tr_b16 v[64:65], v92 offset:40960
    ds_read_b64_tr_b16 v[66:67], v92 offset:41984
    ds_read_b64_tr_b16 v[68:69], v93 offset:40960
    ds_read_b64_tr_b16 v[70:71], v93 offset:41984
    s_waitcnt lgkmcnt(5)
    v_mfma_f32_32x32x16_bf16 v[24:39], v[72:75], v[60:63], v[24:39]
    v_mfma_f32_32x32x16_bf16 v[40:55], v[76:79], v[60:63], v[40:55]
    ds_read_b128 v[60:63], v83 offset:24576
    ds_read_b64_tr_b16 v[72:73], v92 offset:45056
    ds_read_b64_tr_b16 v[74:75], v92 offset:46080
    ds_read_b64_tr_b16 v[76:77], v93 offset:45056
    ds_read_b64_tr_b16 v[78:79], v93 offset:46080
    s_waitcnt lgkmcnt(5)
    v_mfma_f32_32x32x16_bf16 v[24:39], v[64:67], v[56:59], v[24:39]
    v_mfma_f32_32x32x16_bf16 v[40:55], v[68:71], v[56:59], v[40:55]
    s_waitcnt lgkmcnt(0)
    v_mfma_f32_32x32x16_bf16 v[24:39], v[72:75], v[60:63], v[24:39]
    v_mfma_f32_32x32x16_bf16 v[40:55], v[76:79], v[60:63], v[40:55]
    s_waitcnt vmcnt(24)
    s_barrier
    s_add_u32 m0, s27, 24576
    s_add_u32 s26, s24, 0
    buffer_load_dwordx4 v10, s[4:7], s26 offen lds
    s_add_u32 m0, s27, 28672
    s_add_u32 s26, s24, 131072
    buffer_load_dwordx4 v10, s[4:7], s26 offen lds
    s_add_u32 m0, s27, 32768
    s_add_u32 s26, s25, 0
    buffer_load_dwordx4 v11, s[8:11], s26 offen lds
    s_add_u32 m0, s27, 36864
    s_add_u32 s26, s25, 28672
    buffer_load_dwordx4 v11, s[8:11], s26 offen lds
    s_add_u32 m0, s27, 40960
    s_add_u32 s26, s25, 57344
    buffer_load_dwordx4 v11, s[8:11], s26 offen lds
    s_add_u32 m0, s27, 45056
    s_add_u32 s26, s25, 86016
    buffer_load_dwordx4 v11, s[8:11], s26 offen lds
    s_add_u32 s24, s24, 128
    s_add_u32 s25, s25, 114688
    ds_read_b128 v[56:59], v80 offset:49152
    ds_read_b64_tr_b16 v[64:65], v92 offset:57344
    ds_read_b64_tr_b16 v[66:67], v92 offset:58368
    ds_read_b64_tr_b16 v[68:69], v93 offset:57344
    ds_read_b64_tr_b16 v[70:71], v93 offset:58368
    ds_read_b128 v[60:63], v81 offset:49152
    ds_read_b64_tr_b16 v[72:73], v92 offset:61440
    ds_read_b64_tr_b16 v[74:75], v92 offset:62464
    ds_read_b64_tr_b16 v[76:77], v93 offset:61440
    ds_read_b64_tr_b16 v[78:79], v93 offset:62464
    s_waitcnt lgkmcnt(5)
    v_mfma_f32_32x32x16_bf16 v[24:39], v[64:67], v[56:59], v[24:39]
    v_mfma_f32_32x32x16_bf16 v[40:55], v[68:71], v[56:59], v[40:55]
    ds_read_b128 v[56:59], v82 offset:49152
    ds_read_b64_tr_b16 v[64:65], v94 offset:0
    ds_read_b64_tr_b16 v[66:67], v94 offset:1024
    ds_read_b64_tr_b16 v[68:69], v95 offset:0
    ds_read_b64_tr_b16 v[70:71], v95 offset:1024
    s_waitcnt lgkmcnt(5)
    v_mfma_f32_32x32x16_bf16 v[24:39], v[72:75], v[60:63], v[24:39]
    v_mfma_f32_32x32x16_bf16 v[40:55], v[76:79], v[60:63], v[40:55]
    ds_read_b128 v[60:63], v83 offset:49152
    ds_read_b64_tr_b16 v[72:73], v94 offset:4096
    ds_read_b64_tr_b16 v[74:75], v94 offset:5120
    ds_read_b64_tr_b16 v[76:77], v95 offset:4096
    ds_read_b64_tr_b16 v[78:79], v95 offset:5120
    s_waitcnt lgkmcnt(5)
    v_mfma_f32_32x32x16_bf16 v[24:39], v[64:67], v[56:59], v[24:39]
    v_mfma_f32_32x32x16_bf16 v[40:55], v[68:71], v[56:59], v[40:55]
    s_waitcnt lgkmcnt(0)
    v_mfma_f32_32x32x16_bf16 v[24:39], v[72:75], v[60:63], v[24:39]
    v_mfma_f32_32x32x16_bf16 v[40:55], v[76:79], v[60:63], v[40:55]
    s_waitcnt vmcnt(24)
    s_barrier
    s_add_u32 m0, s27, 49152
    s_add_u32 s26, s24, 0
    buffer_load_dwordx4 v10, s[4:7], s26 offen lds
    s_add_u32 m0, s27, 53248
    s_add_u32 s26, s24, 131072
    buffer_load_dwordx4 v10, s[4:7], s26 offen lds
    s_add_u32 m0, s27, 57344
    s_add_u32 s26, s25, 0
    buffer_load_dwordx4 v11, s[8:11], s26 offen lds
    s_add_u32 m0, s27, 61440
    s_add_u32 s26, s25, 28672
    buffer_load_dwordx4 v11, s[8:11], s26 offen lds
    s_add_u32 m0, s27, 65536
    s_add_u32 s26, s25, 57344
    buffer_load_dwordx4 v11, s[8:11], s26 offen lds
    s_add_u32 m0, s27, 69632
    s_add_u32 s26, s25, 86016
    buffer_load_dwordx4 v11, s[8:11], s26 offen lds
    s_add_u32 s24, s24, 128
    s_add_u32 s25, s25, 114688
    ds_read_b128 v[56:59], v84 offset:8192
    ds_read_b64_tr_b16 v[64:65], v94 offset:16384
    ds_read_b64_tr_b16 v[66:67], v94 offset:17408
    ds_read_b64_tr_b16 v[68:69], v95 offset:16384
    ds_read_b64_tr_b16 v[70:71], v95 offset:17408
    ds_read_b128 v[60:63], v85 offset:8192
    ds_read_b64_tr_b16 v[72:73], v94 offset:20480
    ds_read_b64_tr_b16 v[74:75], v94 offset:21504
    ds_read_b64_tr_b16 v[76:77], v95 offset:20480
    ds_read_b64_tr_b16 v[78:79], v95 offset:21504
    s_waitcnt lgkmcnt(5)
    v_mfma_f32_32x32x16_bf16 v[24:39], v[64:67], v[56:59], v[24:39]
    v_mfma_f32_32x32x16_bf16 v[40:55], v[68:71], v[56:59], v[40:55]
    ds_read_b128 v[56:59], v86 offset:8192
    ds_read_b64_tr_b16 v[64:65], v94 offset:24576
    ds_read_b64_tr_b16 v[66:67], v94 offset:25600
    ds_read_b64_tr_b16 v[68:69], v95 offset:24576
    ds_read_b64_tr_b16 v[70:71], v95 offset:25600
    s_waitcnt lgkmcnt(5)
    v_mfma_f32_32x32x16_bf16 v[24:39], v[72:75], v[60:63], v[24:39]
    v_mfma_f32_32x32x16_bf16 v[40:55], v[76:79], v[60:63], v[40:55]
    ds_read_b128 v[60:63], v87 offset:8192
    ds_read_b64_tr_b16 v[72:73], v94 offset:28672
    ds_read_b64_tr_b16 v[74:75], v94 offset:29696
    ds_read_b64_tr_b16 v[76:77], v95 offset:28672
    ds_read_b64_tr_b16 v[78:79], v95 offset:29696
    s_waitcnt lgkmcnt(5)
    v_mfma_f32_32x32x16_bf16 v[24:39], v[64:67], v[56:59], v[24:39]
    v_mfma_f32_32x32x16_bf16 v[40:55], v[68:71], v[56:59], v[40:55]
    s_waitcnt lgkmcnt(0)
    v_mfma_f32_32x32x16_bf16 v[24:39], v[72:75], v[60:63], v[24:39]
    v_mfma_f32_32x32x16_bf16 v[40:55], v[76:79], v[60:63], v[40:55]
    s_waitcnt vmcnt(24)
    s_barrier
    s_add_u32 m0, s27, 73728
    s_add_u32 s26, s24, 0
    buffer_load_dwordx4 v10, s[4:7], s26 offen lds
    s_add_u32 m0, s27, 77824
    s_add_u32 s26, s24, 131072
    buffer_load_dwordx4 v10, s[4:7], s26 offen lds
    s_add_u32 m0, s27, 81920
    s_add_u32 s26, s25, 0
    buffer_load_dwordx4 v11, s[8:11], s26 offen lds
    s_add_u32 m0, s27, 86016
    s_add_u32 s26, s25, 28672
    buffer_load_dwordx4 v11, s[8:11], s26 offen lds
    s_add_u32 m0, s27, 90112
    s_add_u32 s26, s25, 57344
    buffer_load_dwordx4 v11, s[8:11], s26 offen lds
    s_add_u32 m0, s27, 94208
    s_add_u32 s26, s25, 86016
    buffer_load_dwordx4 v11, s[8:11], s26 offen lds
    s_add_u32 s24, s24, 128
    s_add_u32 s25, s25, 114688
    ds_read_b128 v[56:59], v84 offset:32768
    ds_read_b64_tr_b16 v[64:65], v94 offset:40960
    ds_read_b64_tr_b16 v[66:67], v94 offset:41984
    ds_read_b64_tr_b16 v[68:69], v95 offset:40960
    ds_read_b64_tr_b16 v[70:71], v95 offset:41984
    ds_read_b128 v[60:63], v85 offset:32768
    ds_read_b64_tr_b16 v[72:73], v94 offset:45056
    ds_read_b64_tr_b16 v[74:75], v94 offset:46080
    ds_read_b64_tr_b16 v[76:77], v95 offset:45056
    ds_read_b64_tr_b16 v[78:79], v95 offset:46080
    s_waitcnt lgkmcnt(5)
    v_mfma_f32_32x32x16_bf16 v[24:39], v[64:67], v[56:59], v[24:39]
    v_mfma_f32_32x32x16_bf16 v[40:55], v[68:71], v[56:59], v[40:55]
    ds_read_b128 v[56:59], v86 offset:32768
    ds_read_b64_tr_b16 v[64:65], v94 offset:49152
    ds_read_b64_tr_b16 v[66:67], v94 offset:50176
    ds_read_b64_tr_b16 v[68:69], v95 offset:49152
    ds_read_b64_tr_b16 v[70:71], v95 offset:50176
    s_waitcnt lgkmcnt(5)
    v_mfma_f32_32x32x16_bf16 v[24:39], v[72:75], v[60:63], v[24:39]
    v_mfma_f32_32x32x16_bf16 v[40:55], v[76:79], v[60:63], v[40:55]
    ds_read_b128 v[60:63], v87 offset:32768
    ds_read_b64_tr_b16 v[72:73], v94 offset:53248
    ds_read_b64_tr_b16 v[74:75], v94 offset:54272
    ds_read_b64_tr_b16 v[76:77], v95 offset:53248
    ds_read_b64_tr_b16 v[78:79], v95 offset:54272
    s_waitcnt lgkmcnt(5)
    v_mfma_f32_32x32x16_bf16 v[24:39], v[64:67], v[56:59], v[24:39]
    v_mfma_f32_32x32x16_bf16 v[40:55], v[68:71], v[56:59], v[40:55]
    s_waitcnt lgkmcnt(0)
    v_mfma_f32_32x32x16_bf16 v[24:39], v[72:75], v[60:63], v[24:39]
    v_mfma_f32_32x32x16_bf16 v[40:55], v[76:79], v[60:63], v[40:55]
    s_waitcnt vmcnt(24)
    s_barrier
    s_add_u32 m0, s27, 98304
    s_add_u32 s26, s24, 0
    buffer_load_dwordx4 v10, s[4:7], s26 offen lds
    s_add_u32 m0, s27, 102400
    s_add_u32 s26, s24, 131072
    buffer_load_dwordx4 v10, s[4:7], s26 offen lds
    s_add_u32 m0, s27, 106496
    s_add_u32 s26, s25, 0
    buffer_load_dwordx4 v11, s[8:11], s26 offen lds
    s_add_u32 m0, s27, 110592
    s_add_u32 s26, s25, 28672
    buffer_load_dwordx4 v11, s[8:11], s26 offen lds
    s_add_u32 m0, s27, 114688
    s_add_u32 s26, s25, 57344
    buffer_load_dwordx4 v11, s[8:11], s26 offen lds
    s_add_u32 m0, s27, 118784
    s_add_u32 s26, s25, 86016
    buffer_load_dwordx4 v11, s[8:11], s26 offen lds
    s_add_u32 s24, s24, 128
    s_add_u32 s25, s25, 114688
    ds_read_b128 v[56:59], v84 offset:57344
    ds_read_b64_tr_b16 v[64:65], v96 offset:0
    ds_read_b64_tr_b16 v[66:67], v96 offset:1024
    ds_read_b64_tr_b16 v[68:69], v97 offset:0
    ds_read_b64_tr_b16 v[70:71], v97 offset:1024
    ds_read_b128 v[60:63], v85 offset:57344
    ds_read_b64_tr_b16 v[72:73], v96 offset:4096
    ds_read_b64_tr_b16 v[74:75], v96 offset:5120
    ds_read_b64_tr_b16 v[76:77], v97 offset:4096
    ds_read_b64_tr_b16 v[78:79], v97 offset:5120
    s_waitcnt lgkmcnt(5)
    v_mfma_f32_32x32x16_bf16 v[24:39], v[64:67], v[56:59], v[24:39]
    v_mfma_f32_32x32x16_bf16 v[40:55], v[68:71], v[56:59], v[40:55]
    ds_read_b128 v[56:59], v86 offset:57344
    ds_read_b64_tr_b16 v[64:65], v96 offset:8192
    ds_read_b64_tr_b16 v[66:67], v96 offset:9216
    ds_read_b64_tr_b16 v[68:69], v97 offset:8192
    ds_read_b64_tr_b16 v[70:71], v97 offset:9216
    s_waitcnt lgkmcnt(5)
    v_mfma_f32_32x32x16_bf16 v[24:39], v[72:75], v[60:63], v[24:39]
    v_mfma_f32_32x32x16_bf16 v[40:55], v[76:79], v[60:63], v[40:55]
    ds_read_b128 v[60:63], v87 offset:57344
    ds_read_b64_tr_b16 v[72:73], v96 offset:12288
    ds_read_b64_tr_b16 v[74:75], v96 offset:13312
    ds_read_b64_tr_b16 v[76:77], v97 offset:12288
    ds_read_b64_tr_b16 v[78:79], v97 offset:13312
    s_waitcnt lgkmcnt(5)
    v_mfma_f32_32x32x16_bf16 v[24:39], v[64:67], v[56:59], v[24:39]
    v_mfma_f32_32x32x16_bf16 v[40:55], v[68:71], v[56:59], v[40:55]
    s_waitcnt lgkmcnt(0)
    v_mfma_f32_32x32x16_bf16 v[24:39], v[72:75], v[60:63], v[24:39]
    v_mfma_f32_32x32x16_bf16 v[40:55], v[76:79], v[60:63], v[40:55]
    s_waitcnt vmcnt(24)
    s_barrier
    s_add_u32 m0, s27, 122880
    s_add_u32 s26, s24, 0
    buffer_load_dwordx4 v10, s[4:7], s26 offen lds
    s_add_u32 m0, s27, 126976
    s_add_u32 s26, s24, 131072
    buffer_load_dwordx4 v10, s[4:7], s26 offen lds
    s_add_u32 m0, s27, 131072
    s_add_u32 s26, s25, 0
    buffer_load_dwordx4 v11, s[8:11], s26 offen lds
    s_add_u32 m0, s27, 135168
    s_add_u32 s26, s25, 28672
    buffer_load_dwordx4 v11, s[8:11], s26 offen lds
    s_add_u32 m0, s27, 139264
    s_add_u32 s26, s25, 57344
    buffer_load_dwordx4 v11, s[8:11], s26 offen lds
    s_add_u32 m0, s27, 143360
    s_add_u32 s26, s25, 86016
    buffer_load_dwordx4 v11, s[8:11], s26 offen lds
    s_add_u32 s24, s24, 128
    s_add_u32 s25, s25, 114688
    ds_read_b128 v[56:59], v80 offset:0
    ds_read_b64_tr_b16 v[64:65], v92 offset:8192
    ds_read_b64_tr_b16 v[66:67], v92 offset:9216
    ds_read_b64_tr_b16 v[68:69], v93 offset:8192
    ds_read_b64_tr_b16 v[70:71], v93 offset:9216
    ds_read_b128 v[60:63], v81 offset:0
    ds_read_b64_tr_b16 v[72:73], v92 offset:12288
    ds_read_b64_tr_b16 v[74:75], v92 offset:13312
    ds_read_b64_tr_b16 v[76:77], v93 offset:12288
    ds_read_b64_tr_b16 v[78:79], v93 offset:13312
    s_waitcnt lgkmcnt(5)
    v_mfma_f32_32x32x16_bf16 v[24:39], v[64:67], v[56:59], v[24:39]
    v_mfma_f32_32x32x16_bf16 v[40:55], v[68:71], v[56:59], v[40:55]
    ds_read_b128 v[56:59], v82 offset:0
    ds_read_b64_tr_b16 v[64:65], v92 offset:16384
    ds_read_b64_tr_b16 v[66:67], v92 offset:17408
    ds_read_b64_tr_b16 v[68:69], v93 offset:16384
    ds_read_b64_tr_b16 v[70:71], v93 offset:17408
    s_waitcnt lgkmcnt(5)
    v_mfma_f32_32x32x16_bf16 v[24:39], v[72:75], v[60:63], v[24:39]
    v_mfma_f32_32x32x16_bf16 v[40:55], v[76:79], v[60:63], v[40:55]
    ds_read_b128 v[60:63], v83 offset:0
    ds_read_b64_tr_b16 v[72:73], v92 offset:20480
    ds_read_b64_tr_b16 v[74:75], v92 offset:21504
    ds_read_b64_tr_b16 v[76:77], v93 offset:20480
    ds_read_b64_tr_b16 v[78:79], v93 offset:21504
    s_waitcnt lgkmcnt(5)
    v_mfma_f32_32x32x16_bf16 v[24:39], v[64:67], v[56:59], v[24:39]
    v_mfma_f32_32x32x16_bf16 v[40:55], v[68:71], v[56:59], v[40:55]
    s_waitcnt lgkmcnt(0)
    v_mfma_f32_32x32x16_bf16 v[24:39], v[72:75], v[60:63], v[24:39]
    v_mfma_f32_32x32x16_bf16 v[40:55], v[76:79], v[60:63], v[40:55]
    s_waitcnt vmcnt(24)
    s_barrier
    s_add_u32 m0, s27, 0
    s_add_u32 s26, s24, 0
    buffer_load_dwordx4 v10, s[4:7], s26 offen lds
    s_add_u32 m0, s27, 4096
    s_add_u32 s26, s24, 131072
    buffer_load_dwordx4 v10, s[4:7], s26 offen lds
    s_add_u32 m0, s27, 8192
    s_add_u32 s26, s25, 0
    buffer_load_dwordx4 v11, s[8:11], s26 offen lds
    s_add_u32 m0, s27, 12288
    s_add_u32 s26, s25, 28672
    buffer_load_dwordx4 v11, s[8:11], s26 offen lds
    s_add_u32 m0, s27, 16384
    s_add_u32 s26, s25, 57344
    buffer_load_dwordx4 v11, s[8:11], s26 offen lds
    s_add_u32 m0, s27, 20480
    s_add_u32 s26, s25, 86016
    buffer_load_dwordx4 v11, s[8:11], s26 offen lds
    s_add_u32 s24, s24, 128
    s_add_u32 s25, s25, 114688
    ds_read_b128 v[56:59], v80 offset:24576
    ds_read_b64_tr_b16 v[64:65], v92 offset:32768
    ds_read_b64_tr_b16 v[66:67], v92 offset:33792
    ds_read_b64_tr_b16 v[68:69], v93 offset:32768
    ds_read_b64_tr_b16 v[70:71], v93 offset:33792
    ds_read_b128 v[60:63], v81 offset:24576
    ds_read_b64_tr_b16 v[72:73], v92 offset:36864
    ds_read_b64_tr_b16 v[74:75], v92 offset:37888
    ds_read_b64_tr_b16 v[76:77], v93 offset:36864
    ds_read_b64_tr_b16 v[78:79], v93 offset:37888
    s_waitcnt lgkmcnt(5)
    v_mfma_f32_32x32x16_bf16 v[24:39], v[64:67], v[56:59], v[24:39]
    v_mfma_f32_32x32x16_bf16 v[40:55], v[68:71], v[56:59], v[40:55]
    ds_read_b128 v[56:59], v82 offset:24576
    ds_read_b64_tr_b16 v[64:65], v92 offset:40960
    ds_read_b64_tr_b16 v[66:67], v92 offset:41984
    ds_read_b64_tr_b16 v[68:69], v93 offset:40960
    ds_read_b64_tr_b16 v[70:71], v93 offset:41984
    s_waitcnt lgkmcnt(5)
    v_mfma_f32_32x32x16_bf16 v[24:39], v[72:75], v[60:63], v[24:39]
    v_mfma_f32_32x32x16_bf16 v[40:55], v[76:79], v[60:63], v[40:55]
    ds_read_b128 v[60:63], v83 offset:24576
    ds_read_b64_tr_b16 v[72:73], v92 offset:45056
    ds_read_b64_tr_b16 v[74:75], v92 offset:46080
    ds_read_b64_tr_b16 v[76:77], v93 offset:45056
    ds_read_b64_tr_b16 v[78:79], v93 offset:46080
    s_waitcnt lgkmcnt(5)
    v_mfma_f32_32x32x16_bf16 v[24:39], v[64:67], v[56:59], v[24:39]
    v_mfma_f32_32x32x16_bf16 v[40:55], v[68:71], v[56:59], v[40:55]
    s_waitcnt lgkmcnt(0)
    v_mfma_f32_32x32x16_bf16 v[24:39], v[72:75], v[60:63], v[24:39]
    v_mfma_f32_32x32x16_bf16 v[40:55], v[76:79], v[60:63], v[40:55]
    s_waitcnt vmcnt(24)
    s_barrier
    s_add_u32 m0, s27, 24576
    s_add_u32 s26, s24, 0
    buffer_load_dwordx4 v10, s[4:7], s26 offen lds
    s_add_u32 m0, s27, 28672
    s_add_u32 s26, s24, 131072
    buffer_load_dwordx4 v10, s[4:7], s26 offen lds
    s_add_u32 m0, s27, 32768
    s_add_u32 s26, s25, 0
    buffer_load_dwordx4 v11, s[8:11], s26 offen lds
    s_add_u32 m0, s27, 36864
    s_add_u32 s26, s25, 28672
    buffer_load_dwordx4 v11, s[8:11], s26 offen lds
    s_add_u32 m0, s27, 40960
    s_add_u32 s26, s25, 57344
    buffer_load_dwordx4 v11, s[8:11], s26 offen lds
    s_add_u32 m0, s27, 45056
    s_add_u32 s26, s25, 86016
    buffer_load_dwordx4 v11, s[8:11], s26 offen lds
    s_add_u32 s24, s24, 128
    s_add_u32 s25, s25, 114688
    ds_read_b128 v[56:59], v80 offset:49152
    ds_read_b64_tr_b16 v[64:65], v92 offset:57344
    ds_read_b64_tr_b16 v[66:67], v92 offset:58368
    ds_read_b64_tr_b16 v[68:69], v93 offset:57344
    ds_read_b64_tr_b16 v[70:71], v93 offset:58368
    ds_read_b128 v[60:63], v81 offset:49152
    ds_read_b64_tr_b16 v[72:73], v92 offset:61440
    ds_read_b64_tr_b16 v[74:75], v92 offset:62464
    ds_read_b64_tr_b16 v[76:77], v93 offset:61440
    ds_read_b64_tr_b16 v[78:79], v93 offset:62464
    s_waitcnt lgkmcnt(5)
    v_mfma_f32_32x32x16_bf16 v[24:39], v[64:67], v[56:59], v[24:39]
    v_mfma_f32_32x32x16_bf16 v[40:55], v[68:71], v[56:59], v[40:55]
    ds_read_b128 v[56:59], v82 offset:49152
    ds_read_b64_tr_b16 v[64:65], v94 offset:0
    ds_read_b64_tr_b16 v[66:67], v94 offset:1024
    ds_read_b64_tr_b16 v[68:69], v95 offset:0
    ds_read_b64_tr_b16 v[70:71], v95 offset:1024
    s_waitcnt lgkmcnt(5)
    v_mfma_f32_32x32x16_bf16 v[24:39], v[72:75], v[60:63], v[24:39]
    v_mfma_f32_32x32x16_bf16 v[40:55], v[76:79], v[60:63], v[40:55]
    ds_read_b128 v[60:63], v83 offset:49152
    ds_read_b64_tr_b16 v[72:73], v94 offset:4096
    ds_read_b64_tr_b16 v[74:75], v94 offset:5120
    ds_read_b64_tr_b16 v[76:77], v95 offset:4096
    ds_read_b64_tr_b16 v[78:79], v95 offset:5120
    s_waitcnt lgkmcnt(5)
    v_mfma_f32_32x32x16_bf16 v[24:39], v[64:67], v[56:59], v[24:39]
    v_mfma_f32_32x32x16_bf16 v[40:55], v[68:71], v[56:59], v[40:55]
    s_waitcnt lgkmcnt(0)
    v_mfma_f32_32x32x16_bf16 v[24:39], v[72:75], v[60:63], v[24:39]
    v_mfma_f32_32x32x16_bf16 v[40:55], v[76:79], v[60:63], v[40:55]
    s_waitcnt vmcnt(24)
    s_barrier
    s_add_u32 m0, s27, 49152
    s_add_u32 s26, s24, 0
    buffer_load_dwordx4 v10, s[4:7], s26 offen lds
    s_add_u32 m0, s27, 53248
    s_add_u32 s26, s24, 131072
    buffer_load_dwordx4 v10, s[4:7], s26 offen lds
    s_add_u32 m0, s27, 57344
    s_add_u32 s26, s25, 0
    buffer_load_dwordx4 v11, s[8:11], s26 offen lds
    s_add_u32 m0, s27, 61440
    s_add_u32 s26, s25, 28672
    buffer_load_dwordx4 v11, s[8:11], s26 offen lds
    s_add_u32 m0, s27, 65536
    s_add_u32 s26, s25, 57344
    buffer_load_dwordx4 v11, s[8:11], s26 offen lds
    s_add_u32 m0, s27, 69632
    s_add_u32 s26, s25, 86016
    buffer_load_dwordx4 v11, s[8:11], s26 offen lds
    s_add_u32 s24, s24, 128
    s_add_u32 s25, s25, 114688
    ds_read_b128 v[56:59], v84 offset:8192
    ds_read_b64_tr_b16 v[64:65], v94 offset:16384
    ds_read_b64_tr_b16 v[66:67], v94 offset:17408
    ds_read_b64_tr_b16 v[68:69], v95 offset:16384
    ds_read_b64_tr_b16 v[70:71], v95 offset:17408
    ds_read_b128 v[60:63], v85 offset:8192
    ds_read_b64_tr_b16 v[72:73], v94 offset:20480
    ds_read_b64_tr_b16 v[74:75], v94 offset:21504
    ds_read_b64_tr_b16 v[76:77], v95 offset:20480
    ds_read_b64_tr_b16 v[78:79], v95 offset:21504
    s_waitcnt lgkmcnt(5)
    v_mfma_f32_32x32x16_bf16 v[24:39], v[64:67], v[56:59], v[24:39]
    v_mfma_f32_32x32x16_bf16 v[40:55], v[68:71], v[56:59], v[40:55]
    ds_read_b128 v[56:59], v86 offset:8192
    ds_read_b64_tr_b16 v[64:65], v94 offset:24576
    ds_read_b64_tr_b16 v[66:67], v94 offset:25600
    ds_read_b64_tr_b16 v[68:69], v95 offset:24576
    ds_read_b64_tr_b16 v[70:71], v95 offset:25600
    s_waitcnt lgkmcnt(5)
    v_mfma_f32_32x32x16_bf16 v[24:39], v[72:75], v[60:63], v[24:39]
    v_mfma_f32_32x32x16_bf16 v[40:55], v[76:79], v[60:63], v[40:55]
    ds_read_b128 v[60:63], v87 offset:8192
    ds_read_b64_tr_b16 v[72:73], v94 offset:28672
    ds_read_b64_tr_b16 v[74:75], v94 offset:29696
    ds_read_b64_tr_b16 v[76:77], v95 offset:28672
    ds_read_b64_tr_b16 v[78:79], v95 offset:29696
    s_waitcnt lgkmcnt(5)
    v_mfma_f32_32x32x16_bf16 v[24:39], v[64:67], v[56:59], v[24:39]
    v_mfma_f32_32x32x16_bf16 v[40:55], v[68:71], v[56:59], v[40:55]
    s_waitcnt lgkmcnt(0)
    v_mfma_f32_32x32x16_bf16 v[24:39], v[72:75], v[60:63], v[24:39]
    v_mfma_f32_32x32x16_bf16 v[40:55], v[76:79], v[60:63], v[40:55]
    s_waitcnt vmcnt(24)
    s_barrier
    s_add_u32 m0, s27, 73728
    s_add_u32 s26, s24, 0
    buffer_load_dwordx4 v10, s[4:7], s26 offen lds
    s_add_u32 m0, s27, 77824
    s_add_u32 s26, s24, 131072
    buffer_load_dwordx4 v10, s[4:7], s26 offen lds
    s_add_u32 m0, s27, 81920
    s_add_u32 s26, s25, 0
    buffer_load_dwordx4 v11, s[8:11], s26 offen lds
    s_add_u32 m0, s27, 86016
    s_add_u32 s26, s25, 28672
    buffer_load_dwordx4 v11, s[8:11], s26 offen lds
    s_add_u32 m0, s27, 90112
    s_add_u32 s26, s25, 57344
    buffer_load_dwordx4 v11, s[8:11], s26 offen lds
    s_add_u32 m0, s27, 94208
    s_add_u32 s26, s25, 86016
    buffer_load_dwordx4 v11, s[8:11], s26 offen lds
    s_add_u32 s24, s24, 128
    s_add_u32 s25, s25, 114688
    ds_read_b128 v[56:59], v84 offset:32768
    ds_read_b64_tr_b16 v[64:65], v94 offset:40960
    ds_read_b64_tr_b16 v[66:67], v94 offset:41984
    ds_read_b64_tr_b16 v[68:69], v95 offset:40960
    ds_read_b64_tr_b16 v[70:71], v95 offset:41984
    ds_read_b128 v[60:63], v85 offset:32768
    ds_read_b64_tr_b16 v[72:73], v94 offset:45056
    ds_read_b64_tr_b16 v[74:75], v94 offset:46080
    ds_read_b64_tr_b16 v[76:77], v95 offset:45056
    ds_read_b64_tr_b16 v[78:79], v95 offset:46080
    s_waitcnt lgkmcnt(5)
    v_mfma_f32_32x32x16_bf16 v[24:39], v[64:67], v[56:59], v[24:39]
    v_mfma_f32_32x32x16_bf16 v[40:55], v[68:71], v[56:59], v[40:55]
    ds_read_b128 v[56:59], v86 offset:32768
    ds_read_b64_tr_b16 v[64:65], v94 offset:49152
    ds_read_b64_tr_b16 v[66:67], v94 offset:50176
    ds_read_b64_tr_b16 v[68:69], v95 offset:49152
    ds_read_b64_tr_b16 v[70:71], v95 offset:50176
    s_waitcnt lgkmcnt(5)
    v_mfma_f32_32x32x16_bf16 v[24:39], v[72:75], v[60:63], v[24:39]
    v_mfma_f32_32x32x16_bf16 v[40:55], v[76:79], v[60:63], v[40:55]
    ds_read_b128 v[60:63], v87 offset:32768
    ds_read_b64_tr_b16 v[72:73], v94 offset:53248
    ds_read_b64_tr_b16 v[74:75], v94 offset:54272
    ds_read_b64_tr_b16 v[76:77], v95 offset:53248
    ds_read_b64_tr_b16 v[78:79], v95 offset:54272
    s_waitcnt lgkmcnt(5)
    v_mfma_f32_32x32x16_bf16 v[24:39], v[64:67], v[56:59], v[24:39]
    v_mfma_f32_32x32x16_bf16 v[40:55], v[68:71], v[56:59], v[40:55]
    s_waitcnt lgkmcnt(0)
    v_mfma_f32_32x32x16_bf16 v[24:39], v[72:75], v[60:63], v[24:39]
    v_mfma_f32_32x32x16_bf16 v[40:55], v[76:79], v[60:63], v[40:55]
    s_waitcnt vmcnt(24)
    s_barrier
    s_add_u32 m0, s27, 98304
    s_add_u32 s26, s24, 0
    buffer_load_dwordx4 v10, s[4:7], s26 offen lds
    s_add_u32 m0, s27, 102400
    s_add_u32 s26, s24, 131072
    buffer_load_dwordx4 v10, s[4:7], s26 offen lds
    s_add_u32 m0, s27, 106496
    s_add_u32 s26, s25, 0
    buffer_load_dwordx4 v11, s[8:11], s26 offen lds
    s_add_u32 m0, s27, 110592
    s_add_u32 s26, s25, 28672
    buffer_load_dwordx4 v11, s[8:11], s26 offen lds
    s_add_u32 m0, s27, 114688
    s_add_u32 s26, s25, 57344
    buffer_load_dwordx4 v11, s[8:11], s26 offen lds
    s_add_u32 m0, s27, 118784
    s_add_u32 s26, s25, 86016
    buffer_load_dwordx4 v11, s[8:11], s26 offen lds
    s_add_u32 s24, s24, 128
    s_add_u32 s25, s25, 114688
    ds_read_b128 v[56:59], v84 offset:57344
    ds_read_b64_tr_b16 v[64:65], v96 offset:0
    ds_read_b64_tr_b16 v[66:67], v96 offset:1024
    ds_read_b64_tr_b16 v[68:69], v97 offset:0
    ds_read_b64_tr_b16 v[70:71], v97 offset:1024
    ds_read_b128 v[60:63], v85 offset:57344
    ds_read_b64_tr_b16 v[72:73], v96 offset:4096
    ds_read_b64_tr_b16 v[74:75], v96 offset:5120
    ds_read_b64_tr_b16 v[76:77], v97 offset:4096
    ds_read_b64_tr_b16 v[78:79], v97 offset:5120
    s_waitcnt lgkmcnt(5)
    v_mfma_f32_32x32x16_bf16 v[24:39], v[64:67], v[56:59], v[24:39]
    v_mfma_f32_32x32x16_bf16 v[40:55], v[68:71], v[56:59], v[40:55]
    ds_read_b128 v[56:59], v86 offset:57344
    ds_read_b64_tr_b16 v[64:65], v96 offset:8192
    ds_read_b64_tr_b16 v[66:67], v96 offset:9216
    ds_read_b64_tr_b16 v[68:69], v97 offset:8192
    ds_read_b64_tr_b16 v[70:71], v97 offset:9216
    s_waitcnt lgkmcnt(5)
    v_mfma_f32_32x32x16_bf16 v[24:39], v[72:75], v[60:63], v[24:39]
    v_mfma_f32_32x32x16_bf16 v[40:55], v[76:79], v[60:63], v[40:55]
    ds_read_b128 v[60:63], v87 offset:57344
    ds_read_b64_tr_b16 v[72:73], v96 offset:12288
    ds_read_b64_tr_b16 v[74:75], v96 offset:13312
    ds_read_b64_tr_b16 v[76:77], v97 offset:12288
    ds_read_b64_tr_b16 v[78:79], v97 offset:13312
    s_waitcnt lgkmcnt(5)
    v_mfma_f32_32x32x16_bf16 v[24:39], v[64:67], v[56:59], v[24:39]
    v_mfma_f32_32x32x16_bf16 v[40:55], v[68:71], v[56:59], v[40:55]
    s_waitcnt lgkmcnt(0)
    v_mfma_f32_32x32x16_bf16 v[24:39], v[72:75], v[60:63], v[24:39]
    v_mfma_f32_32x32x16_bf16 v[40:55], v[76:79], v[60:63], v[40:55]
    s_waitcnt vmcnt(24)
    s_barrier
    s_add_u32 m0, s27, 122880
    s_add_u32 s26, s24, 0
    buffer_load_dwordx4 v10, s[4:7], s26 offen lds
    s_add_u32 m0, s27, 126976
    s_add_u32 s26, s24, 131072
    buffer_load_dwordx4 v10, s[4:7], s26 offen lds
    s_add_u32 m0, s27, 131072
    s_add_u32 s26, s25, 0
    buffer_load_dwordx4 v11, s[8:11], s26 offen lds
    s_add_u32 m0, s27, 135168
    s_add_u32 s26, s25, 28672
    buffer_load_dwordx4 v11, s[8:11], s26 offen lds
    s_add_u32 m0, s27, 139264
    s_add_u32 s26, s25, 57344
    buffer_load_dwordx4 v11, s[8:11], s26 offen lds
    s_add_u32 m0, s27, 143360
    s_add_u32 s26, s25, 86016
    buffer_load_dwordx4 v11, s[8:11], s26 offen lds
    s_add_u32 s24, s24, 128
    s_add_u32 s25, s25, 114688
    ds_read_b128 v[56:59], v80 offset:0
    ds_read_b64_tr_b16 v[64:65], v92 offset:8192
    ds_read_b64_tr_b16 v[66:67], v92 offset:9216
    ds_read_b64_tr_b16 v[68:69], v93 offset:8192
    ds_read_b64_tr_b16 v[70:71], v93 offset:9216
    ds_read_b128 v[60:63], v81 offset:0
    ds_read_b64_tr_b16 v[72:73], v92 offset:12288
    ds_read_b64_tr_b16 v[74:75], v92 offset:13312
    ds_read_b64_tr_b16 v[76:77], v93 offset:12288
    ds_read_b64_tr_b16 v[78:79], v93 offset:13312
    s_waitcnt lgkmcnt(5)
    v_mfma_f32_32x32x16_bf16 v[24:39], v[64:67], v[56:59], v[24:39]
    v_mfma_f32_32x32x16_bf16 v[40:55], v[68:71], v[56:59], v[40:55]
    ds_read_b128 v[56:59], v82 offset:0
    ds_read_b64_tr_b16 v[64:65], v92 offset:16384
    ds_read_b64_tr_b16 v[66:67], v92 offset:17408
    ds_read_b64_tr_b16 v[68:69], v93 offset:16384
    ds_read_b64_tr_b16 v[70:71], v93 offset:17408
    s_waitcnt lgkmcnt(5)
    v_mfma_f32_32x32x16_bf16 v[24:39], v[72:75], v[60:63], v[24:39]
    v_mfma_f32_32x32x16_bf16 v[40:55], v[76:79], v[60:63], v[40:55]
    ds_read_b128 v[60:63], v83 offset:0
    ds_read_b64_tr_b16 v[72:73], v92 offset:20480
    ds_read_b64_tr_b16 v[74:75], v92 offset:21504
    ds_read_b64_tr_b16 v[76:77], v93 offset:20480
    ds_read_b64_tr_b16 v[78:79], v93 offset:21504
    s_waitcnt lgkmcnt(5)
    v_mfma_f32_32x32x16_bf16 v[24:39], v[64:67], v[56:59], v[24:39]
    v_mfma_f32_32x32x16_bf16 v[40:55], v[68:71], v[56:59], v[40:55]
    s_waitcnt lgkmcnt(0)
    v_mfma_f32_32x32x16_bf16 v[24:39], v[72:75], v[60:63], v[24:39]
    v_mfma_f32_32x32x16_bf16 v[40:55], v[76:79], v[60:63], v[40:55]
    s_waitcnt vmcnt(24)
    s_barrier
    s_add_u32 m0, s27, 0
    s_add_u32 s26, s24, 0
    buffer_load_dwordx4 v10, s[4:7], s26 offen lds
    s_add_u32 m0, s27, 4096
    s_add_u32 s26, s24, 131072
    buffer_load_dwordx4 v10, s[4:7], s26 offen lds
    s_add_u32 m0, s27, 8192
    s_add_u32 s26, s25, 0
    buffer_load_dwordx4 v11, s[8:11], s26 offen lds
    s_add_u32 m0, s27, 12288
    s_add_u32 s26, s25, 28672
    buffer_load_dwordx4 v11, s[8:11], s26 offen lds
    s_add_u32 m0, s27, 16384
    s_add_u32 s26, s25, 57344
    buffer_load_dwordx4 v11, s[8:11], s26 offen lds
    s_add_u32 m0, s27, 20480
    s_add_u32 s26, s25, 86016
    buffer_load_dwordx4 v11, s[8:11], s26 offen lds
    s_add_u32 s24, s24, 128
    s_add_u32 s25, s25, 114688
    ds_read_b128 v[56:59], v80 offset:24576
    ds_read_b64_tr_b16 v[64:65], v92 offset:32768
    ds_read_b64_tr_b16 v[66:67], v92 offset:33792
    ds_read_b64_tr_b16 v[68:69], v93 offset:32768
    ds_read_b64_tr_b16 v[70:71], v93 offset:33792
    ds_read_b128 v[60:63], v81 offset:24576
    ds_read_b64_tr_b16 v[72:73], v92 offset:36864
    ds_read_b64_tr_b16 v[74:75], v92 offset:37888
    ds_read_b64_tr_b16 v[76:77], v93 offset:36864
    ds_read_b64_tr_b16 v[78:79], v93 offset:37888
    s_waitcnt lgkmcnt(5)
    v_mfma_f32_32x32x16_bf16 v[24:39], v[64:67], v[56:59], v[24:39]
    v_mfma_f32_32x32x16_bf16 v[40:55], v[68:71], v[56:59], v[40:55]
    ds_read_b128 v[56:59], v82 offset:24576
    ds_read_b64_tr_b16 v[64:65], v92 offset:40960
    ds_read_b64_tr_b16 v[66:67], v92 offset:41984
    ds_read_b64_tr_b16 v[68:69], v93 offset:40960
    ds_read_b64_tr_b16 v[70:71], v93 offset:41984
    s_waitcnt lgkmcnt(5)
    v_mfma_f32_32x32x16_bf16 v[24:39], v[72:75], v[60:63], v[24:39]
    v_mfma_f32_32x32x16_bf16 v[40:55], v[76:79], v[60:63], v[40:55]
    ds_read_b128 v[60:63], v83 offset:24576
    ds_read_b64_tr_b16 v[72:73], v92 offset:45056
    ds_read_b64_tr_b16 v[74:75], v92 offset:46080
    ds_read_b64_tr_b16 v[76:77], v93 offset:45056
    ds_read_b64_tr_b16 v[78:79], v93 offset:46080
    s_waitcnt lgkmcnt(5)
    v_mfma_f32_32x32x16_bf16 v[24:39], v[64:67], v[56:59], v[24:39]
    v_mfma_f32_32x32x16_bf16 v[40:55], v[68:71], v[56:59], v[40:55]
    s_waitcnt lgkmcnt(0)
    v_mfma_f32_32x32x16_bf16 v[24:39], v[72:75], v[60:63], v[24:39]
    v_mfma_f32_32x32x16_bf16 v[40:55], v[76:79], v[60:63], v[40:55]
    s_waitcnt vmcnt(24)
    s_barrier
    s_add_u32 m0, s27, 24576
    s_add_u32 s26, s24, 0
    buffer_load_dwordx4 v10, s[4:7], s26 offen lds
    s_add_u32 m0, s27, 28672
    s_add_u32 s26, s24, 131072
    buffer_load_dwordx4 v10, s[4:7], s26 offen lds
    s_add_u32 m0, s27, 32768
    s_add_u32 s26, s25, 0
    buffer_load_dwordx4 v11, s[8:11], s26 offen lds
    s_add_u32 m0, s27, 36864
    s_add_u32 s26, s25, 28672
    buffer_load_dwordx4 v11, s[8:11], s26 offen lds
    s_add_u32 m0, s27, 40960
    s_add_u32 s26, s25, 57344
    buffer_load_dwordx4 v11, s[8:11], s26 offen lds
    s_add_u32 m0, s27, 45056
    s_add_u32 s26, s25, 86016
    buffer_load_dwordx4 v11, s[8:11], s26 offen lds
    s_add_u32 s24, s24, 128
    s_add_u32 s25, s25, 114688
    ds_read_b128 v[56:59], v80 offset:49152
    ds_read_b64_tr_b16 v[64:65], v92 offset:57344
    ds_read_b64_tr_b16 v[66:67], v92 offset:58368
    ds_read_b64_tr_b16 v[68:69], v93 offset:57344
    ds_read_b64_tr_b16 v[70:71], v93 offset:58368
    ds_read_b128 v[60:63], v81 offset:49152
    ds_read_b64_tr_b16 v[72:73], v92 offset:61440
    ds_read_b64_tr_b16 v[74:75], v92 offset:62464
    ds_read_b64_tr_b16 v[76:77], v93 offset:61440
    ds_read_b64_tr_b16 v[78:79], v93 offset:62464
    s_waitcnt lgkmcnt(5)
    v_mfma_f32_32x32x16_bf16 v[24:39], v[64:67], v[56:59], v[24:39]
    v_mfma_f32_32x32x16_bf16 v[40:55], v[68:71], v[56:59], v[40:55]
    ds_read_b128 v[56:59], v82 offset:49152
    ds_read_b64_tr_b16 v[64:65], v94 offset:0
    ds_read_b64_tr_b16 v[66:67], v94 offset:1024
    ds_read_b64_tr_b16 v[68:69], v95 offset:0
    ds_read_b64_tr_b16 v[70:71], v95 offset:1024
    s_waitcnt lgkmcnt(5)
    v_mfma_f32_32x32x16_bf16 v[24:39], v[72:75], v[60:63], v[24:39]
    v_mfma_f32_32x32x16_bf16 v[40:55], v[76:79], v[60:63], v[40:55]
    ds_read_b128 v[60:63], v83 offset:49152
    ds_read_b64_tr_b16 v[72:73], v94 offset:4096
    ds_read_b64_tr_b16 v[74:75], v94 offset:5120
    ds_read_b64_tr_b16 v[76:77], v95 offset:4096
    ds_read_b64_tr_b16 v[78:79], v95 offset:5120
    s_waitcnt lgkmcnt(5)
    v_mfma_f32_32x32x16_bf16 v[24:39], v[64:67], v[56:59], v[24:39]
    v_mfma_f32_32x32x16_bf16 v[40:55], v[68:71], v[56:59], v[40:55]
    s_waitcnt lgkmcnt(0)
    v_mfma_f32_32x32x16_bf16 v[24:39], v[72:75], v[60:63], v[24:39]
    v_mfma_f32_32x32x16_bf16 v[40:55], v[76:79], v[60:63], v[40:55]
    s_waitcnt vmcnt(24)
    s_barrier
    s_add_u32 m0, s27, 49152
    s_add_u32 s26, s24, 0
    buffer_load_dwordx4 v10, s[4:7], s26 offen lds
    s_add_u32 m0, s27, 53248
    s_add_u32 s26, s24, 131072
    buffer_load_dwordx4 v10, s[4:7], s26 offen lds
    s_add_u32 m0, s27, 57344
    s_add_u32 s26, s25, 0
    buffer_load_dwordx4 v11, s[8:11], s26 offen lds
    s_add_u32 m0, s27, 61440
    s_add_u32 s26, s25, 28672
    buffer_load_dwordx4 v11, s[8:11], s26 offen lds
    s_add_u32 m0, s27, 65536
    s_add_u32 s26, s25, 57344
    buffer_load_dwordx4 v11, s[8:11], s26 offen lds
    s_add_u32 m0, s27, 69632
    s_add_u32 s26, s25, 86016
    buffer_load_dwordx4 v11, s[8:11], s26 offen lds
    s_add_u32 s24, s24, 128
    s_add_u32 s25, s25, 114688
    ds_read_b128 v[56:59], v84 offset:8192
    ds_read_b64_tr_b16 v[64:65], v94 offset:16384
    ds_read_b64_tr_b16 v[66:67], v94 offset:17408
    ds_read_b64_tr_b16 v[68:69], v95 offset:16384
    ds_read_b64_tr_b16 v[70:71], v95 offset:17408
    ds_read_b128 v[60:63], v85 offset:8192
    ds_read_b64_tr_b16 v[72:73], v94 offset:20480
    ds_read_b64_tr_b16 v[74:75], v94 offset:21504
    ds_read_b64_tr_b16 v[76:77], v95 offset:20480
    ds_read_b64_tr_b16 v[78:79], v95 offset:21504
    s_waitcnt lgkmcnt(5)
    v_mfma_f32_32x32x16_bf16 v[24:39], v[64:67], v[56:59], v[24:39]
    v_mfma_f32_32x32x16_bf16 v[40:55], v[68:71], v[56:59], v[40:55]
    ds_read_b128 v[56:59], v86 offset:8192
    ds_read_b64_tr_b16 v[64:65], v94 offset:24576
    ds_read_b64_tr_b16 v[66:67], v94 offset:25600
    ds_read_b64_tr_b16 v[68:69], v95 offset:24576
    ds_read_b64_tr_b16 v[70:71], v95 offset:25600
    s_waitcnt lgkmcnt(5)
    v_mfma_f32_32x32x16_bf16 v[24:39], v[72:75], v[60:63], v[24:39]
    v_mfma_f32_32x32x16_bf16 v[40:55], v[76:79], v[60:63], v[40:55]
    ds_read_b128 v[60:63], v87 offset:8192
    ds_read_b64_tr_b16 v[72:73], v94 offset:28672
    ds_read_b64_tr_b16 v[74:75], v94 offset:29696
    ds_read_b64_tr_b16 v[76:77], v95 offset:28672
    ds_read_b64_tr_b16 v[78:79], v95 offset:29696
    s_waitcnt lgkmcnt(5)
    v_mfma_f32_32x32x16_bf16 v[24:39], v[64:67], v[56:59], v[24:39]
    v_mfma_f32_32x32x16_bf16 v[40:55], v[68:71], v[56:59], v[40:55]
    s_waitcnt lgkmcnt(0)
    v_mfma_f32_32x32x16_bf16 v[24:39], v[72:75], v[60:63], v[24:39]
    v_mfma_f32_32x32x16_bf16 v[40:55], v[76:79], v[60:63], v[40:55]
    s_waitcnt vmcnt(24)
    s_barrier
    s_add_u32 m0, s27, 73728
    s_add_u32 s26, s24, 0
    buffer_load_dwordx4 v10, s[4:7], s26 offen lds
    s_add_u32 m0, s27, 77824
    s_add_u32 s26, s24, 131072
    buffer_load_dwordx4 v10, s[4:7], s26 offen lds
    s_add_u32 m0, s27, 81920
    s_add_u32 s26, s25, 0
    buffer_load_dwordx4 v11, s[8:11], s26 offen lds
    s_add_u32 m0, s27, 86016
    s_add_u32 s26, s25, 28672
    buffer_load_dwordx4 v11, s[8:11], s26 offen lds
    s_add_u32 m0, s27, 90112
    s_add_u32 s26, s25, 57344
    buffer_load_dwordx4 v11, s[8:11], s26 offen lds
    s_add_u32 m0, s27, 94208
    s_add_u32 s26, s25, 86016
    buffer_load_dwordx4 v11, s[8:11], s26 offen lds
    s_add_u32 s24, s24, 128
    s_add_u32 s25, s25, 114688
    ds_read_b128 v[56:59], v84 offset:32768
    ds_read_b64_tr_b16 v[64:65], v94 offset:40960
    ds_read_b64_tr_b16 v[66:67], v94 offset:41984
    ds_read_b64_tr_b16 v[68:69], v95 offset:40960
    ds_read_b64_tr_b16 v[70:71], v95 offset:41984
    ds_read_b128 v[60:63], v85 offset:32768
    ds_read_b64_tr_b16 v[72:73], v94 offset:45056
    ds_read_b64_tr_b16 v[74:75], v94 offset:46080
    ds_read_b64_tr_b16 v[76:77], v95 offset:45056
    ds_read_b64_tr_b16 v[78:79], v95 offset:46080
    s_waitcnt lgkmcnt(5)
    v_mfma_f32_32x32x16_bf16 v[24:39], v[64:67], v[56:59], v[24:39]
    v_mfma_f32_32x32x16_bf16 v[40:55], v[68:71], v[56:59], v[40:55]
    ds_read_b128 v[56:59], v86 offset:32768
    ds_read_b64_tr_b16 v[64:65], v94 offset:49152
    ds_read_b64_tr_b16 v[66:67], v94 offset:50176
    ds_read_b64_tr_b16 v[68:69], v95 offset:49152
    ds_read_b64_tr_b16 v[70:71], v95 offset:50176
    s_waitcnt lgkmcnt(5)
    v_mfma_f32_32x32x16_bf16 v[24:39], v[72:75], v[60:63], v[24:39]
    v_mfma_f32_32x32x16_bf16 v[40:55], v[76:79], v[60:63], v[40:55]
    ds_read_b128 v[60:63], v87 offset:32768
    ds_read_b64_tr_b16 v[72:73], v94 offset:53248
    ds_read_b64_tr_b16 v[74:75], v94 offset:54272
    ds_read_b64_tr_b16 v[76:77], v95 offset:53248
    ds_read_b64_tr_b16 v[78:79], v95 offset:54272
    s_waitcnt lgkmcnt(5)
    v_mfma_f32_32x32x16_bf16 v[24:39], v[64:67], v[56:59], v[24:39]
    v_mfma_f32_32x32x16_bf16 v[40:55], v[68:71], v[56:59], v[40:55]
    s_waitcnt lgkmcnt(0)
    v_mfma_f32_32x32x16_bf16 v[24:39], v[72:75], v[60:63], v[24:39]
    v_mfma_f32_32x32x16_bf16 v[40:55], v[76:79], v[60:63], v[40:55]
    s_waitcnt vmcnt(24)
    s_barrier
    s_add_u32 m0, s27, 98304
    s_add_u32 s26, s24, 0
    buffer_load_dwordx4 v10, s[4:7], s26 offen lds
    s_add_u32 m0, s27, 102400
    s_add_u32 s26, s24, 131072
    buffer_load_dwordx4 v10, s[4:7], s26 offen lds
    s_add_u32 m0, s27, 106496
    s_add_u32 s26, s25, 0
    buffer_load_dwordx4 v11, s[8:11], s26 offen lds
    s_add_u32 m0, s27, 110592
    s_add_u32 s26, s25, 28672
    buffer_load_dwordx4 v11, s[8:11], s26 offen lds
    s_add_u32 m0, s27, 114688
    s_add_u32 s26, s25, 57344
    buffer_load_dwordx4 v11, s[8:11], s26 offen lds
    s_add_u32 m0, s27, 118784
    s_add_u32 s26, s25, 86016
    buffer_load_dwordx4 v11, s[8:11], s26 offen lds
    s_add_u32 s24, s24, 128
    s_add_u32 s25, s25, 114688
    ds_read_b128 v[56:59], v84 offset:57344
    ds_read_b64_tr_b16 v[64:65], v96 offset:0
    ds_read_b64_tr_b16 v[66:67], v96 offset:1024
    ds_read_b64_tr_b16 v[68:69], v97 offset:0
    ds_read_b64_tr_b16 v[70:71], v97 offset:1024
    ds_read_b128 v[60:63], v85 offset:57344
    ds_read_b64_tr_b16 v[72:73], v96 offset:4096
    ds_read_b64_tr_b16 v[74:75], v96 offset:5120
    ds_read_b64_tr_b16 v[76:77], v97 offset:4096
    ds_read_b64_tr_b16 v[78:79], v97 offset:5120
    s_waitcnt lgkmcnt(5)
    v_mfma_f32_32x32x16_bf16 v[24:39], v[64:67], v[56:59], v[24:39]
    v_mfma_f32_32x32x16_bf16 v[40:55], v[68:71], v[56:59], v[40:55]
    ds_read_b128 v[56:59], v86 offset:57344
    ds_read_b64_tr_b16 v[64:65], v96 offset:8192
    ds_read_b64_tr_b16 v[66:67], v96 offset:9216
    ds_read_b64_tr_b16 v[68:69], v97 offset:8192
    ds_read_b64_tr_b16 v[70:71], v97 offset:9216
    s_waitcnt lgkmcnt(5)
    v_mfma_f32_32x32x16_bf16 v[24:39], v[72:75], v[60:63], v[24:39]
    v_mfma_f32_32x32x16_bf16 v[40:55], v[76:79], v[60:63], v[40:55]
    ds_read_b128 v[60:63], v87 offset:57344
    ds_read_b64_tr_b16 v[72:73], v96 offset:12288
    ds_read_b64_tr_b16 v[74:75], v96 offset:13312
    ds_read_b64_tr_b16 v[76:77], v97 offset:12288
    ds_read_b64_tr_b16 v[78:79], v97 offset:13312
    s_waitcnt lgkmcnt(5)
    v_mfma_f32_32x32x16_bf16 v[24:39], v[64:67], v[56:59], v[24:39]
    v_mfma_f32_32x32x16_bf16 v[40:55], v[68:71], v[56:59], v[40:55]
    s_waitcnt lgkmcnt(0)
    v_mfma_f32_32x32x16_bf16 v[24:39], v[72:75], v[60:63], v[24:39]
    v_mfma_f32_32x32x16_bf16 v[40:55], v[76:79], v[60:63], v[40:55]
    s_waitcnt vmcnt(24)
    s_barrier
    s_add_u32 m0, s27, 122880
    s_add_u32 s26, s24, 0
    buffer_load_dwordx4 v10, s[4:7], s26 offen lds
    s_add_u32 m0, s27, 126976
    s_add_u32 s26, s24, 131072
    buffer_load_dwordx4 v10, s[4:7], s26 offen lds
    s_add_u32 m0, s27, 131072
    s_add_u32 s26, s25, 0
    buffer_load_dwordx4 v11, s[8:11], s26 offen lds
    s_add_u32 m0, s27, 135168
    s_add_u32 s26, s25, 28672
    buffer_load_dwordx4 v11, s[8:11], s26 offen lds
    s_add_u32 m0, s27, 139264
    s_add_u32 s26, s25, 57344
    buffer_load_dwordx4 v11, s[8:11], s26 offen lds
    s_add_u32 m0, s27, 143360
    s_add_u32 s26, s25, 86016
    buffer_load_dwordx4 v11, s[8:11], s26 offen lds
    s_add_u32 s24, s24, 128
    s_add_u32 s25, s25, 114688
    ds_read_b128 v[56:59], v80 offset:0
    ds_read_b64_tr_b16 v[64:65], v92 offset:8192
    ds_read_b64_tr_b16 v[66:67], v92 offset:9216
    ds_read_b64_tr_b16 v[68:69], v93 offset:8192
    ds_read_b64_tr_b16 v[70:71], v93 offset:9216
    ds_read_b128 v[60:63], v81 offset:0
    ds_read_b64_tr_b16 v[72:73], v92 offset:12288
    ds_read_b64_tr_b16 v[74:75], v92 offset:13312
    ds_read_b64_tr_b16 v[76:77], v93 offset:12288
    ds_read_b64_tr_b16 v[78:79], v93 offset:13312
    s_waitcnt lgkmcnt(5)
    v_mfma_f32_32x32x16_bf16 v[24:39], v[64:67], v[56:59], v[24:39]
    v_mfma_f32_32x32x16_bf16 v[40:55], v[68:71], v[56:59], v[40:55]
    ds_read_b128 v[56:59], v82 offset:0
    ds_read_b64_tr_b16 v[64:65], v92 offset:16384
    ds_read_b64_tr_b16 v[66:67], v92 offset:17408
    ds_read_b64_tr_b16 v[68:69], v93 offset:16384
    ds_read_b64_tr_b16 v[70:71], v93 offset:17408
    s_waitcnt lgkmcnt(5)
    v_mfma_f32_32x32x16_bf16 v[24:39], v[72:75], v[60:63], v[24:39]
    v_mfma_f32_32x32x16_bf16 v[40:55], v[76:79], v[60:63], v[40:55]
    ds_read_b128 v[60:63], v83 offset:0
    ds_read_b64_tr_b16 v[72:73], v92 offset:20480
    ds_read_b64_tr_b16 v[74:75], v92 offset:21504
    ds_read_b64_tr_b16 v[76:77], v93 offset:20480
    ds_read_b64_tr_b16 v[78:79], v93 offset:21504
    s_waitcnt lgkmcnt(5)
    v_mfma_f32_32x32x16_bf16 v[24:39], v[64:67], v[56:59], v[24:39]
    v_mfma_f32_32x32x16_bf16 v[40:55], v[68:71], v[56:59], v[40:55]
    s_waitcnt lgkmcnt(0)
    v_mfma_f32_32x32x16_bf16 v[24:39], v[72:75], v[60:63], v[24:39]
    v_mfma_f32_32x32x16_bf16 v[40:55], v[76:79], v[60:63], v[40:55]
    s_waitcnt vmcnt(24)
    s_barrier
    s_add_u32 m0, s27, 0
    s_add_u32 s26, s24, 0
    buffer_load_dwordx4 v10, s[4:7], s26 offen lds
    s_add_u32 m0, s27, 4096
    s_add_u32 s26, s24, 131072
    buffer_load_dwordx4 v10, s[4:7], s26 offen lds
    s_add_u32 m0, s27, 8192
    s_add_u32 s26, s25, 0
    buffer_load_dwordx4 v11, s[8:11], s26 offen lds
    s_add_u32 m0, s27, 12288
    s_add_u32 s26, s25, 28672
    buffer_load_dwordx4 v11, s[8:11], s26 offen lds
    s_add_u32 m0, s27, 16384
    s_add_u32 s26, s25, 57344
    buffer_load_dwordx4 v11, s[8:11], s26 offen lds
    s_add_u32 m0, s27, 20480
    s_add_u32 s26, s25, 86016
    buffer_load_dwordx4 v11, s[8:11], s26 offen lds
    s_add_u32 s24, s24, 128
    s_add_u32 s25, s25, 114688
    ds_read_b128 v[56:59], v80 offset:24576
    ds_read_b64_tr_b16 v[64:65], v92 offset:32768
    ds_read_b64_tr_b16 v[66:67], v92 offset:33792
    ds_read_b64_tr_b16 v[68:69], v93 offset:32768
    ds_read_b64_tr_b16 v[70:71], v93 offset:33792
    ds_read_b128 v[60:63], v81 offset:24576
    ds_read_b64_tr_b16 v[72:73], v92 offset:36864
    ds_read_b64_tr_b16 v[74:75], v92 offset:37888
    ds_read_b64_tr_b16 v[76:77], v93 offset:36864
    ds_read_b64_tr_b16 v[78:79], v93 offset:37888
    s_waitcnt lgkmcnt(5)
    v_mfma_f32_32x32x16_bf16 v[24:39], v[64:67], v[56:59], v[24:39]
    v_mfma_f32_32x32x16_bf16 v[40:55], v[68:71], v[56:59], v[40:55]
    ds_read_b128 v[56:59], v82 offset:24576
    ds_read_b64_tr_b16 v[64:65], v92 offset:40960
    ds_read_b64_tr_b16 v[66:67], v92 offset:41984
    ds_read_b64_tr_b16 v[68:69], v93 offset:40960
    ds_read_b64_tr_b16 v[70:71], v93 offset:41984
    s_waitcnt lgkmcnt(5)
    v_mfma_f32_32x32x16_bf16 v[24:39], v[72:75], v[60:63], v[24:39]
    v_mfma_f32_32x32x16_bf16 v[40:55], v[76:79], v[60:63], v[40:55]
    ds_read_b128 v[60:63], v83 offset:24576
    ds_read_b64_tr_b16 v[72:73], v92 offset:45056
    ds_read_b64_tr_b16 v[74:75], v92 offset:46080
    ds_read_b64_tr_b16 v[76:77], v93 offset:45056
    ds_read_b64_tr_b16 v[78:79], v93 offset:46080
    s_waitcnt lgkmcnt(5)
    v_mfma_f32_32x32x16_bf16 v[24:39], v[64:67], v[56:59], v[24:39]
    v_mfma_f32_32x32x16_bf16 v[40:55], v[68:71], v[56:59], v[40:55]
    s_waitcnt lgkmcnt(0)
    v_mfma_f32_32x32x16_bf16 v[24:39], v[72:75], v[60:63], v[24:39]
    v_mfma_f32_32x32x16_bf16 v[40:55], v[76:79], v[60:63], v[40:55]
    s_waitcnt vmcnt(24)
    s_barrier
    s_add_u32 m0, s27, 24576
    s_add_u32 s26, s24, 0
    buffer_load_dwordx4 v10, s[4:7], s26 offen lds
    s_add_u32 m0, s27, 28672
    s_add_u32 s26, s24, 131072
    buffer_load_dwordx4 v10, s[4:7], s26 offen lds
    s_add_u32 m0, s27, 32768
    s_add_u32 s26, s25, 0
    buffer_load_dwordx4 v11, s[8:11], s26 offen lds
    s_add_u32 m0, s27, 36864
    s_add_u32 s26, s25, 28672
    buffer_load_dwordx4 v11, s[8:11], s26 offen lds
    s_add_u32 m0, s27, 40960
    s_add_u32 s26, s25, 57344
    buffer_load_dwordx4 v11, s[8:11], s26 offen lds
    s_add_u32 m0, s27, 45056
    s_add_u32 s26, s25, 86016
    buffer_load_dwordx4 v11, s[8:11], s26 offen lds
    s_add_u32 s24, s24, 128
    s_add_u32 s25, s25, 114688
    ds_read_b128 v[56:59], v80 offset:49152
    ds_read_b64_tr_b16 v[64:65], v92 offset:57344
    ds_read_b64_tr_b16 v[66:67], v92 offset:58368
    ds_read_b64_tr_b16 v[68:69], v93 offset:57344
    ds_read_b64_tr_b16 v[70:71], v93 offset:58368
    ds_read_b128 v[60:63], v81 offset:49152
    ds_read_b64_tr_b16 v[72:73], v92 offset:61440
    ds_read_b64_tr_b16 v[74:75], v92 offset:62464
    ds_read_b64_tr_b16 v[76:77], v93 offset:61440
    ds_read_b64_tr_b16 v[78:79], v93 offset:62464
    s_waitcnt lgkmcnt(5)
    v_mfma_f32_32x32x16_bf16 v[24:39], v[64:67], v[56:59], v[24:39]
    v_mfma_f32_32x32x16_bf16 v[40:55], v[68:71], v[56:59], v[40:55]
    ds_read_b128 v[56:59], v82 offset:49152
    ds_read_b64_tr_b16 v[64:65], v94 offset:0
    ds_read_b64_tr_b16 v[66:67], v94 offset:1024
    ds_read_b64_tr_b16 v[68:69], v95 offset:0
    ds_read_b64_tr_b16 v[70:71], v95 offset:1024
    s_waitcnt lgkmcnt(5)
    v_mfma_f32_32x32x16_bf16 v[24:39], v[72:75], v[60:63], v[24:39]
    v_mfma_f32_32x32x16_bf16 v[40:55], v[76:79], v[60:63], v[40:55]
    ds_read_b128 v[60:63], v83 offset:49152
    ds_read_b64_tr_b16 v[72:73], v94 offset:4096
    ds_read_b64_tr_b16 v[74:75], v94 offset:5120
    ds_read_b64_tr_b16 v[76:77], v95 offset:4096
    ds_read_b64_tr_b16 v[78:79], v95 offset:5120
    s_waitcnt lgkmcnt(5)
    v_mfma_f32_32x32x16_bf16 v[24:39], v[64:67], v[56:59], v[24:39]
    v_mfma_f32_32x32x16_bf16 v[40:55], v[68:71], v[56:59], v[40:55]
    s_waitcnt lgkmcnt(0)
    v_mfma_f32_32x32x16_bf16 v[24:39], v[72:75], v[60:63], v[24:39]
    v_mfma_f32_32x32x16_bf16 v[40:55], v[76:79], v[60:63], v[40:55]
    s_waitcnt vmcnt(24)
    s_barrier
    s_add_u32 m0, s27, 49152
    s_add_u32 s26, s24, 0
    buffer_load_dwordx4 v10, s[4:7], s26 offen lds
    s_add_u32 m0, s27, 53248
    s_add_u32 s26, s24, 131072
    buffer_load_dwordx4 v10, s[4:7], s26 offen lds
    s_add_u32 m0, s27, 57344
    s_add_u32 s26, s25, 0
    buffer_load_dwordx4 v11, s[8:11], s26 offen lds
    s_add_u32 m0, s27, 61440
    s_add_u32 s26, s25, 28672
    buffer_load_dwordx4 v11, s[8:11], s26 offen lds
    s_add_u32 m0, s27, 65536
    s_add_u32 s26, s25, 57344
    buffer_load_dwordx4 v11, s[8:11], s26 offen lds
    s_add_u32 m0, s27, 69632
    s_add_u32 s26, s25, 86016
    buffer_load_dwordx4 v11, s[8:11], s26 offen lds
    s_add_u32 s24, s24, 128
    s_add_u32 s25, s25, 114688
    ds_read_b128 v[56:59], v84 offset:8192
    ds_read_b64_tr_b16 v[64:65], v94 offset:16384
    ds_read_b64_tr_b16 v[66:67], v94 offset:17408
    ds_read_b64_tr_b16 v[68:69], v95 offset:16384
    ds_read_b64_tr_b16 v[70:71], v95 offset:17408
    ds_read_b128 v[60:63], v85 offset:8192
    ds_read_b64_tr_b16 v[72:73], v94 offset:20480
    ds_read_b64_tr_b16 v[74:75], v94 offset:21504
    ds_read_b64_tr_b16 v[76:77], v95 offset:20480
    ds_read_b64_tr_b16 v[78:79], v95 offset:21504
    s_waitcnt lgkmcnt(5)
    v_mfma_f32_32x32x16_bf16 v[24:39], v[64:67], v[56:59], v[24:39]
    v_mfma_f32_32x32x16_bf16 v[40:55], v[68:71], v[56:59], v[40:55]
    ds_read_b128 v[56:59], v86 offset:8192
    ds_read_b64_tr_b16 v[64:65], v94 offset:24576
    ds_read_b64_tr_b16 v[66:67], v94 offset:25600
    ds_read_b64_tr_b16 v[68:69], v95 offset:24576
    ds_read_b64_tr_b16 v[70:71], v95 offset:25600
    s_waitcnt lgkmcnt(5)
    v_mfma_f32_32x32x16_bf16 v[24:39], v[72:75], v[60:63], v[24:39]
    v_mfma_f32_32x32x16_bf16 v[40:55], v[76:79], v[60:63], v[40:55]
    ds_read_b128 v[60:63], v87 offset:8192
    ds_read_b64_tr_b16 v[72:73], v94 offset:28672
    ds_read_b64_tr_b16 v[74:75], v94 offset:29696
    ds_read_b64_tr_b16 v[76:77], v95 offset:28672
    ds_read_b64_tr_b16 v[78:79], v95 offset:29696
    s_waitcnt lgkmcnt(5)
    v_mfma_f32_32x32x16_bf16 v[24:39], v[64:67], v[56:59], v[24:39]
    v_mfma_f32_32x32x16_bf16 v[40:55], v[68:71], v[56:59], v[40:55]
    s_waitcnt lgkmcnt(0)
    v_mfma_f32_32x32x16_bf16 v[24:39], v[72:75], v[60:63], v[24:39]
    v_mfma_f32_32x32x16_bf16 v[40:55], v[76:79], v[60:63], v[40:55]
    s_waitcnt vmcnt(24)
    s_barrier
    s_add_u32 m0, s27, 73728
    s_add_u32 s26, s24, 0
    buffer_load_dwordx4 v10, s[4:7], s26 offen lds
    s_add_u32 m0, s27, 77824
    s_add_u32 s26, s24, 131072
    buffer_load_dwordx4 v10, s[4:7], s26 offen lds
    s_add_u32 m0, s27, 81920
    s_add_u32 s26, s25, 0
    buffer_load_dwordx4 v11, s[8:11], s26 offen lds
    s_add_u32 m0, s27, 86016
    s_add_u32 s26, s25, 28672
    buffer_load_dwordx4 v11, s[8:11], s26 offen lds
    s_add_u32 m0, s27, 90112
    s_add_u32 s26, s25, 57344
    buffer_load_dwordx4 v11, s[8:11], s26 offen lds
    s_add_u32 m0, s27, 94208
    s_add_u32 s26, s25, 86016
    buffer_load_dwordx4 v11, s[8:11], s26 offen lds
    s_add_u32 s24, s24, 128
    s_add_u32 s25, s25, 114688
    ds_read_b128 v[56:59], v84 offset:32768
    ds_read_b64_tr_b16 v[64:65], v94 offset:40960
    ds_read_b64_tr_b16 v[66:67], v94 offset:41984
    ds_read_b64_tr_b16 v[68:69], v95 offset:40960
    ds_read_b64_tr_b16 v[70:71], v95 offset:41984
    ds_read_b128 v[60:63], v85 offset:32768
    ds_read_b64_tr_b16 v[72:73], v94 offset:45056
    ds_read_b64_tr_b16 v[74:75], v94 offset:46080
    ds_read_b64_tr_b16 v[76:77], v95 offset:45056
    ds_read_b64_tr_b16 v[78:79], v95 offset:46080
    s_waitcnt lgkmcnt(5)
    v_mfma_f32_32x32x16_bf16 v[24:39], v[64:67], v[56:59], v[24:39]
    v_mfma_f32_32x32x16_bf16 v[40:55], v[68:71], v[56:59], v[40:55]
    ds_read_b128 v[56:59], v86 offset:32768
    ds_read_b64_tr_b16 v[64:65], v94 offset:49152
    ds_read_b64_tr_b16 v[66:67], v94 offset:50176
    ds_read_b64_tr_b16 v[68:69], v95 offset:49152
    ds_read_b64_tr_b16 v[70:71], v95 offset:50176
    s_waitcnt lgkmcnt(5)
    v_mfma_f32_32x32x16_bf16 v[24:39], v[72:75], v[60:63], v[24:39]
    v_mfma_f32_32x32x16_bf16 v[40:55], v[76:79], v[60:63], v[40:55]
    ds_read_b128 v[60:63], v87 offset:32768
    ds_read_b64_tr_b16 v[72:73], v94 offset:53248
    ds_read_b64_tr_b16 v[74:75], v94 offset:54272
    ds_read_b64_tr_b16 v[76:77], v95 offset:53248
    ds_read_b64_tr_b16 v[78:79], v95 offset:54272
    s_waitcnt lgkmcnt(5)
    v_mfma_f32_32x32x16_bf16 v[24:39], v[64:67], v[56:59], v[24:39]
    v_mfma_f32_32x32x16_bf16 v[40:55], v[68:71], v[56:59], v[40:55]
    s_waitcnt lgkmcnt(0)
    v_mfma_f32_32x32x16_bf16 v[24:39], v[72:75], v[60:63], v[24:39]
    v_mfma_f32_32x32x16_bf16 v[40:55], v[76:79], v[60:63], v[40:55]
    s_waitcnt vmcnt(24)
    s_barrier
    s_add_u32 m0, s27, 98304
    s_add_u32 s26, s24, 0
    buffer_load_dwordx4 v10, s[4:7], s26 offen lds
    s_add_u32 m0, s27, 102400
    s_add_u32 s26, s24, 131072
    buffer_load_dwordx4 v10, s[4:7], s26 offen lds
    s_add_u32 m0, s27, 106496
    s_add_u32 s26, s25, 0
    buffer_load_dwordx4 v11, s[8:11], s26 offen lds
    s_add_u32 m0, s27, 110592
    s_add_u32 s26, s25, 28672
    buffer_load_dwordx4 v11, s[8:11], s26 offen lds
    s_add_u32 m0, s27, 114688
    s_add_u32 s26, s25, 57344
    buffer_load_dwordx4 v11, s[8:11], s26 offen lds
    s_add_u32 m0, s27, 118784
    s_add_u32 s26, s25, 86016
    buffer_load_dwordx4 v11, s[8:11], s26 offen lds
    s_add_u32 s24, s24, 128
    s_add_u32 s25, s25, 114688
    ds_read_b128 v[56:59], v84 offset:57344
    ds_read_b64_tr_b16 v[64:65], v96 offset:0
    ds_read_b64_tr_b16 v[66:67], v96 offset:1024
    ds_read_b64_tr_b16 v[68:69], v97 offset:0
    ds_read_b64_tr_b16 v[70:71], v97 offset:1024
    ds_read_b128 v[60:63], v85 offset:57344
    ds_read_b64_tr_b16 v[72:73], v96 offset:4096
    ds_read_b64_tr_b16 v[74:75], v96 offset:5120
    ds_read_b64_tr_b16 v[76:77], v97 offset:4096
    ds_read_b64_tr_b16 v[78:79], v97 offset:5120
    s_waitcnt lgkmcnt(5)
    v_mfma_f32_32x32x16_bf16 v[24:39], v[64:67], v[56:59], v[24:39]
    v_mfma_f32_32x32x16_bf16 v[40:55], v[68:71], v[56:59], v[40:55]
    ds_read_b128 v[56:59], v86 offset:57344
    ds_read_b64_tr_b16 v[64:65], v96 offset:8192
    ds_read_b64_tr_b16 v[66:67], v96 offset:9216
    ds_read_b64_tr_b16 v[68:69], v97 offset:8192
    ds_read_b64_tr_b16 v[70:71], v97 offset:9216
    s_waitcnt lgkmcnt(5)
    v_mfma_f32_32x32x16_bf16 v[24:39], v[72:75], v[60:63], v[24:39]
    v_mfma_f32_32x32x16_bf16 v[40:55], v[76:79], v[60:63], v[40:55]
    ds_read_b128 v[60:63], v87 offset:57344
    ds_read_b64_tr_b16 v[72:73], v96 offset:12288
    ds_read_b64_tr_b16 v[74:75], v96 offset:13312
    ds_read_b64_tr_b16 v[76:77], v97 offset:12288
    ds_read_b64_tr_b16 v[78:79], v97 offset:13312
    s_waitcnt lgkmcnt(5)
    v_mfma_f32_32x32x16_bf16 v[24:39], v[64:67], v[56:59], v[24:39]
    v_mfma_f32_32x32x16_bf16 v[40:55], v[68:71], v[56:59], v[40:55]
    s_waitcnt lgkmcnt(0)
    v_mfma_f32_32x32x16_bf16 v[24:39], v[72:75], v[60:63], v[24:39]
    v_mfma_f32_32x32x16_bf16 v[40:55], v[76:79], v[60:63], v[40:55]
    s_waitcnt vmcnt(24)
    s_barrier
    s_add_u32 m0, s27, 122880
    s_add_u32 s26, s24, 0
    buffer_load_dwordx4 v10, s[4:7], s26 offen lds
    s_add_u32 m0, s27, 126976
    s_add_u32 s26, s24, 131072
    buffer_load_dwordx4 v10, s[4:7], s26 offen lds
    s_add_u32 m0, s27, 131072
    s_add_u32 s26, s25, 0
    buffer_load_dwordx4 v11, s[8:11], s26 offen lds
    s_add_u32 m0, s27, 135168
    s_add_u32 s26, s25, 28672
    buffer_load_dwordx4 v11, s[8:11], s26 offen lds
    s_add_u32 m0, s27, 139264
    s_add_u32 s26, s25, 57344
    buffer_load_dwordx4 v11, s[8:11], s26 offen lds
    s_add_u32 m0, s27, 143360
    s_add_u32 s26, s25, 86016
    buffer_load_dwordx4 v11, s[8:11], s26 offen lds
    s_add_u32 s24, s24, 128
    s_add_u32 s25, s25, 114688
    ds_read_b128 v[56:59], v80 offset:0
    ds_read_b64_tr_b16 v[64:65], v92 offset:8192
    ds_read_b64_tr_b16 v[66:67], v92 offset:9216
    ds_read_b64_tr_b16 v[68:69], v93 offset:8192
    ds_read_b64_tr_b16 v[70:71], v93 offset:9216
    ds_read_b128 v[60:63], v81 offset:0
    ds_read_b64_tr_b16 v[72:73], v92 offset:12288
    ds_read_b64_tr_b16 v[74:75], v92 offset:13312
    ds_read_b64_tr_b16 v[76:77], v93 offset:12288
    ds_read_b64_tr_b16 v[78:79], v93 offset:13312
    s_waitcnt lgkmcnt(5)
    v_mfma_f32_32x32x16_bf16 v[24:39], v[64:67], v[56:59], v[24:39]
    v_mfma_f32_32x32x16_bf16 v[40:55], v[68:71], v[56:59], v[40:55]
    ds_read_b128 v[56:59], v82 offset:0
    ds_read_b64_tr_b16 v[64:65], v92 offset:16384
    ds_read_b64_tr_b16 v[66:67], v92 offset:17408
    ds_read_b64_tr_b16 v[68:69], v93 offset:16384
    ds_read_b64_tr_b16 v[70:71], v93 offset:17408
    s_waitcnt lgkmcnt(5)
    v_mfma_f32_32x32x16_bf16 v[24:39], v[72:75], v[60:63], v[24:39]
    v_mfma_f32_32x32x16_bf16 v[40:55], v[76:79], v[60:63], v[40:55]
    ds_read_b128 v[60:63], v83 offset:0
    ds_read_b64_tr_b16 v[72:73], v92 offset:20480
    ds_read_b64_tr_b16 v[74:75], v92 offset:21504
    ds_read_b64_tr_b16 v[76:77], v93 offset:20480
    ds_read_b64_tr_b16 v[78:79], v93 offset:21504
    s_waitcnt lgkmcnt(5)
    v_mfma_f32_32x32x16_bf16 v[24:39], v[64:67], v[56:59], v[24:39]
    v_mfma_f32_32x32x16_bf16 v[40:55], v[68:71], v[56:59], v[40:55]
    s_waitcnt lgkmcnt(0)
    v_mfma_f32_32x32x16_bf16 v[24:39], v[72:75], v[60:63], v[24:39]
    v_mfma_f32_32x32x16_bf16 v[40:55], v[76:79], v[60:63], v[40:55]
    s_waitcnt vmcnt(24)
    s_barrier
    s_add_u32 m0, s27, 0
    s_add_u32 s26, s24, 0
    buffer_load_dwordx4 v10, s[4:7], s26 offen lds
    s_add_u32 m0, s27, 4096
    s_add_u32 s26, s24, 131072
    buffer_load_dwordx4 v10, s[4:7], s26 offen lds
    s_add_u32 m0, s27, 8192
    s_add_u32 s26, s25, 0
    buffer_load_dwordx4 v11, s[8:11], s26 offen lds
    s_add_u32 m0, s27, 12288
    s_add_u32 s26, s25, 28672
    buffer_load_dwordx4 v11, s[8:11], s26 offen lds
    s_add_u32 m0, s27, 16384
    s_add_u32 s26, s25, 57344
    buffer_load_dwordx4 v11, s[8:11], s26 offen lds
    s_add_u32 m0, s27, 20480
    s_add_u32 s26, s25, 86016
    buffer_load_dwordx4 v11, s[8:11], s26 offen lds
    s_add_u32 s24, s24, 128
    s_add_u32 s25, s25, 114688
    ds_read_b128 v[56:59], v80 offset:24576
    ds_read_b64_tr_b16 v[64:65], v92 offset:32768
    ds_read_b64_tr_b16 v[66:67], v92 offset:33792
    ds_read_b64_tr_b16 v[68:69], v93 offset:32768
    ds_read_b64_tr_b16 v[70:71], v93 offset:33792
    ds_read_b128 v[60:63], v81 offset:24576
    ds_read_b64_tr_b16 v[72:73], v92 offset:36864
    ds_read_b64_tr_b16 v[74:75], v92 offset:37888
    ds_read_b64_tr_b16 v[76:77], v93 offset:36864
    ds_read_b64_tr_b16 v[78:79], v93 offset:37888
    s_waitcnt lgkmcnt(5)
    v_mfma_f32_32x32x16_bf16 v[24:39], v[64:67], v[56:59], v[24:39]
    v_mfma_f32_32x32x16_bf16 v[40:55], v[68:71], v[56:59], v[40:55]
    ds_read_b128 v[56:59], v82 offset:24576
    ds_read_b64_tr_b16 v[64:65], v92 offset:40960
    ds_read_b64_tr_b16 v[66:67], v92 offset:41984
    ds_read_b64_tr_b16 v[68:69], v93 offset:40960
    ds_read_b64_tr_b16 v[70:71], v93 offset:41984
    s_waitcnt lgkmcnt(5)
    v_mfma_f32_32x32x16_bf16 v[24:39], v[72:75], v[60:63], v[24:39]
    v_mfma_f32_32x32x16_bf16 v[40:55], v[76:79], v[60:63], v[40:55]
    ds_read_b128 v[60:63], v83 offset:24576
    ds_read_b64_tr_b16 v[72:73], v92 offset:45056
    ds_read_b64_tr_b16 v[74:75], v92 offset:46080
    ds_read_b64_tr_b16 v[76:77], v93 offset:45056
    ds_read_b64_tr_b16 v[78:79], v93 offset:46080
    s_waitcnt lgkmcnt(5)
    v_mfma_f32_32x32x16_bf16 v[24:39], v[64:67], v[56:59], v[24:39]
    v_mfma_f32_32x32x16_bf16 v[40:55], v[68:71], v[56:59], v[40:55]
    s_waitcnt lgkmcnt(0)
    v_mfma_f32_32x32x16_bf16 v[24:39], v[72:75], v[60:63], v[24:39]
    v_mfma_f32_32x32x16_bf16 v[40:55], v[76:79], v[60:63], v[40:55]
    s_waitcnt vmcnt(24)
    s_barrier
    s_add_u32 m0, s27, 24576
    s_add_u32 s26, s24, 0
    buffer_load_dwordx4 v10, s[4:7], s26 offen lds
    s_add_u32 m0, s27, 28672
    s_add_u32 s26, s24, 131072
    buffer_load_dwordx4 v10, s[4:7], s26 offen lds
    s_add_u32 m0, s27, 32768
    s_add_u32 s26, s25, 0
    buffer_load_dwordx4 v11, s[8:11], s26 offen lds
    s_add_u32 m0, s27, 36864
    s_add_u32 s26, s25, 28672
    buffer_load_dwordx4 v11, s[8:11], s26 offen lds
    s_add_u32 m0, s27, 40960
    s_add_u32 s26, s25, 57344
    buffer_load_dwordx4 v11, s[8:11], s26 offen lds
    s_add_u32 m0, s27, 45056
    s_add_u32 s26, s25, 86016
    buffer_load_dwordx4 v11, s[8:11], s26 offen lds
    s_add_u32 s24, s24, 128
    s_add_u32 s25, s25, 114688
    ds_read_b128 v[56:59], v80 offset:49152
    ds_read_b64_tr_b16 v[64:65], v92 offset:57344
    ds_read_b64_tr_b16 v[66:67], v92 offset:58368
    ds_read_b64_tr_b16 v[68:69], v93 offset:57344
    ds_read_b64_tr_b16 v[70:71], v93 offset:58368
    ds_read_b128 v[60:63], v81 offset:49152
    ds_read_b64_tr_b16 v[72:73], v92 offset:61440
    ds_read_b64_tr_b16 v[74:75], v92 offset:62464
    ds_read_b64_tr_b16 v[76:77], v93 offset:61440
    ds_read_b64_tr_b16 v[78:79], v93 offset:62464
    s_waitcnt lgkmcnt(5)
    v_mfma_f32_32x32x16_bf16 v[24:39], v[64:67], v[56:59], v[24:39]
    v_mfma_f32_32x32x16_bf16 v[40:55], v[68:71], v[56:59], v[40:55]
    ds_read_b128 v[56:59], v82 offset:49152
    ds_read_b64_tr_b16 v[64:65], v94 offset:0
    ds_read_b64_tr_b16 v[66:67], v94 offset:1024
    ds_read_b64_tr_b16 v[68:69], v95 offset:0
    ds_read_b64_tr_b16 v[70:71], v95 offset:1024
    s_waitcnt lgkmcnt(5)
    v_mfma_f32_32x32x16_bf16 v[24:39], v[72:75], v[60:63], v[24:39]
    v_mfma_f32_32x32x16_bf16 v[40:55], v[76:79], v[60:63], v[40:55]
    ds_read_b128 v[60:63], v83 offset:49152
    ds_read_b64_tr_b16 v[72:73], v94 offset:4096
    ds_read_b64_tr_b16 v[74:75], v94 offset:5120
    ds_read_b64_tr_b16 v[76:77], v95 offset:4096
    ds_read_b64_tr_b16 v[78:79], v95 offset:5120
    s_waitcnt lgkmcnt(5)
    v_mfma_f32_32x32x16_bf16 v[24:39], v[64:67], v[56:59], v[24:39]
    v_mfma_f32_32x32x16_bf16 v[40:55], v[68:71], v[56:59], v[40:55]
    s_waitcnt lgkmcnt(0)
    v_mfma_f32_32x32x16_bf16 v[24:39], v[72:75], v[60:63], v[24:39]
    v_mfma_f32_32x32x16_bf16 v[40:55], v[76:79], v[60:63], v[40:55]
    s_waitcnt vmcnt(24)
    s_barrier
    ds_read_b128 v[56:59], v84 offset:8192
    ds_read_b64_tr_b16 v[64:65], v94 offset:16384
    ds_read_b64_tr_b16 v[66:67], v94 offset:17408
    ds_read_b64_tr_b16 v[68:69], v95 offset:16384
    ds_read_b64_tr_b16 v[70:71], v95 offset:17408
    ds_read_b128 v[60:63], v85 offset:8192
    ds_read_b64_tr_b16 v[72:73], v94 offset:20480
    ds_read_b64_tr_b16 v[74:75], v94 offset:21504
    ds_read_b64_tr_b16 v[76:77], v95 offset:20480
    ds_read_b64_tr_b16 v[78:79], v95 offset:21504
    s_waitcnt lgkmcnt(5)
    v_mfma_f32_32x32x16_bf16 v[24:39], v[64:67], v[56:59], v[24:39]
    v_mfma_f32_32x32x16_bf16 v[40:55], v[68:71], v[56:59], v[40:55]
    ds_read_b128 v[56:59], v86 offset:8192
    ds_read_b64_tr_b16 v[64:65], v94 offset:24576
    ds_read_b64_tr_b16 v[66:67], v94 offset:25600
    ds_read_b64_tr_b16 v[68:69], v95 offset:24576
    ds_read_b64_tr_b16 v[70:71], v95 offset:25600
    s_waitcnt lgkmcnt(5)
    v_mfma_f32_32x32x16_bf16 v[24:39], v[72:75], v[60:63], v[24:39]
    v_mfma_f32_32x32x16_bf16 v[40:55], v[76:79], v[60:63], v[40:55]
    ds_read_b128 v[60:63], v87 offset:8192
    ds_read_b64_tr_b16 v[72:73], v94 offset:28672
    ds_read_b64_tr_b16 v[74:75], v94 offset:29696
    ds_read_b64_tr_b16 v[76:77], v95 offset:28672
    ds_read_b64_tr_b16 v[78:79], v95 offset:29696
    s_waitcnt lgkmcnt(5)
    v_mfma_f32_32x32x16_bf16 v[24:39], v[64:67], v[56:59], v[24:39]
    v_mfma_f32_32x32x16_bf16 v[40:55], v[68:71], v[56:59], v[40:55]
    s_waitcnt lgkmcnt(0)
    v_mfma_f32_32x32x16_bf16 v[24:39], v[72:75], v[60:63], v[24:39]
    v_mfma_f32_32x32x16_bf16 v[40:55], v[76:79], v[60:63], v[40:55]
    s_waitcnt vmcnt(18)
    s_barrier
    ds_read_b128 v[56:59], v84 offset:32768
    ds_read_b64_tr_b16 v[64:65], v94 offset:40960
    ds_read_b64_tr_b16 v[66:67], v94 offset:41984
    ds_read_b64_tr_b16 v[68:69], v95 offset:40960
    ds_read_b64_tr_b16 v[70:71], v95 offset:41984
    ds_read_b128 v[60:63], v85 offset:32768
    ds_read_b64_tr_b16 v[72:73], v94 offset:45056
    ds_read_b64_tr_b16 v[74:75], v94 offset:46080
    ds_read_b64_tr_b16 v[76:77], v95 offset:45056
    ds_read_b64_tr_b16 v[78:79], v95 offset:46080
    s_waitcnt lgkmcnt(5)
    v_mfma_f32_32x32x16_bf16 v[24:39], v[64:67], v[56:59], v[24:39]
    v_mfma_f32_32x32x16_bf16 v[40:55], v[68:71], v[56:59], v[40:55]
    ds_read_b128 v[56:59], v86 offset:32768
    ds_read_b64_tr_b16 v[64:65], v94 offset:49152
    ds_read_b64_tr_b16 v[66:67], v94 offset:50176
    ds_read_b64_tr_b16 v[68:69], v95 offset:49152
    ds_read_b64_tr_b16 v[70:71], v95 offset:50176
    s_waitcnt lgkmcnt(5)
    v_mfma_f32_32x32x16_bf16 v[24:39], v[72:75], v[60:63], v[24:39]
    v_mfma_f32_32x32x16_bf16 v[40:55], v[76:79], v[60:63], v[40:55]
    ds_read_b128 v[60:63], v87 offset:32768
    ds_read_b64_tr_b16 v[72:73], v94 offset:53248
    ds_read_b64_tr_b16 v[74:75], v94 offset:54272
    ds_read_b64_tr_b16 v[76:77], v95 offset:53248
    ds_read_b64_tr_b16 v[78:79], v95 offset:54272
    s_waitcnt lgkmcnt(5)
    v_mfma_f32_32x32x16_bf16 v[24:39], v[64:67], v[56:59], v[24:39]
    v_mfma_f32_32x32x16_bf16 v[40:55], v[68:71], v[56:59], v[40:55]
    s_waitcnt lgkmcnt(0)
    v_mfma_f32_32x32x16_bf16 v[24:39], v[72:75], v[60:63], v[24:39]
    v_mfma_f32_32x32x16_bf16 v[40:55], v[76:79], v[60:63], v[40:55]
    s_waitcnt vmcnt(12)
    s_barrier
    ds_read_b128 v[56:59], v84 offset:57344
    ds_read_b64_tr_b16 v[64:65], v96 offset:0
    ds_read_b64_tr_b16 v[66:67], v96 offset:1024
    ds_read_b64_tr_b16 v[68:69], v97 offset:0
    ds_read_b64_tr_b16 v[70:71], v97 offset:1024
    ds_read_b128 v[60:63], v85 offset:57344
    ds_read_b64_tr_b16 v[72:73], v96 offset:4096
    ds_read_b64_tr_b16 v[74:75], v96 offset:5120
    ds_read_b64_tr_b16 v[76:77], v97 offset:4096
    ds_read_b64_tr_b16 v[78:79], v97 offset:5120
    s_waitcnt lgkmcnt(5)
    v_mfma_f32_32x32x16_bf16 v[24:39], v[64:67], v[56:59], v[24:39]
    v_mfma_f32_32x32x16_bf16 v[40:55], v[68:71], v[56:59], v[40:55]
    ds_read_b128 v[56:59], v86 offset:57344
    ds_read_b64_tr_b16 v[64:65], v96 offset:8192
    ds_read_b64_tr_b16 v[66:67], v96 offset:9216
    ds_read_b64_tr_b16 v[68:69], v97 offset:8192
    ds_read_b64_tr_b16 v[70:71], v97 offset:9216
    s_waitcnt lgkmcnt(5)
    v_mfma_f32_32x32x16_bf16 v[24:39], v[72:75], v[60:63], v[24:39]
    v_mfma_f32_32x32x16_bf16 v[40:55], v[76:79], v[60:63], v[40:55]
    ds_read_b128 v[60:63], v87 offset:57344
    ds_read_b64_tr_b16 v[72:73], v96 offset:12288
    ds_read_b64_tr_b16 v[74:75], v96 offset:13312
    ds_read_b64_tr_b16 v[76:77], v97 offset:12288
    ds_read_b64_tr_b16 v[78:79], v97 offset:13312
    s_waitcnt lgkmcnt(5)
    v_mfma_f32_32x32x16_bf16 v[24:39], v[64:67], v[56:59], v[24:39]
    v_mfma_f32_32x32x16_bf16 v[40:55], v[68:71], v[56:59], v[40:55]
    s_waitcnt lgkmcnt(0)
    v_mfma_f32_32x32x16_bf16 v[24:39], v[72:75], v[60:63], v[24:39]
    v_mfma_f32_32x32x16_bf16 v[40:55], v[76:79], v[60:63], v[40:55]
    s_waitcnt vmcnt(6)
    s_barrier
    ds_read_b128 v[56:59], v80 offset:0
    ds_read_b64_tr_b16 v[64:65], v92 offset:8192
    ds_read_b64_tr_b16 v[66:67], v92 offset:9216
    ds_read_b64_tr_b16 v[68:69], v93 offset:8192
    ds_read_b64_tr_b16 v[70:71], v93 offset:9216
    ds_read_b128 v[60:63], v81 offset:0
    ds_read_b64_tr_b16 v[72:73], v92 offset:12288
    ds_read_b64_tr_b16 v[74:75], v92 offset:13312
    ds_read_b64_tr_b16 v[76:77], v93 offset:12288
    ds_read_b64_tr_b16 v[78:79], v93 offset:13312
    s_waitcnt lgkmcnt(5)
    v_mfma_f32_32x32x16_bf16 v[24:39], v[64:67], v[56:59], v[24:39]
    v_mfma_f32_32x32x16_bf16 v[40:55], v[68:71], v[56:59], v[40:55]
    ds_read_b128 v[56:59], v82 offset:0
    ds_read_b64_tr_b16 v[64:65], v92 offset:16384
    ds_read_b64_tr_b16 v[66:67], v92 offset:17408
    ds_read_b64_tr_b16 v[68:69], v93 offset:16384
    ds_read_b64_tr_b16 v[70:71], v93 offset:17408
    s_waitcnt lgkmcnt(5)
    v_mfma_f32_32x32x16_bf16 v[24:39], v[72:75], v[60:63], v[24:39]
    v_mfma_f32_32x32x16_bf16 v[40:55], v[76:79], v[60:63], v[40:55]
    ds_read_b128 v[60:63], v83 offset:0
    ds_read_b64_tr_b16 v[72:73], v92 offset:20480
    ds_read_b64_tr_b16 v[74:75], v92 offset:21504
    ds_read_b64_tr_b16 v[76:77], v93 offset:20480
    ds_read_b64_tr_b16 v[78:79], v93 offset:21504
    s_waitcnt lgkmcnt(5)
    v_mfma_f32_32x32x16_bf16 v[24:39], v[64:67], v[56:59], v[24:39]
    v_mfma_f32_32x32x16_bf16 v[40:55], v[68:71], v[56:59], v[40:55]
    s_waitcnt lgkmcnt(0)
    v_mfma_f32_32x32x16_bf16 v[24:39], v[72:75], v[60:63], v[24:39]
    v_mfma_f32_32x32x16_bf16 v[40:55], v[76:79], v[60:63], v[40:55]
    s_waitcnt vmcnt(0)
    s_barrier
    ds_read_b128 v[56:59], v80 offset:24576
    ds_read_b64_tr_b16 v[64:65], v92 offset:32768
    ds_read_b64_tr_b16 v[66:67], v92 offset:33792
    ds_read_b64_tr_b16 v[68:69], v93 offset:32768
    ds_read_b64_tr_b16 v[70:71], v93 offset:33792
    ds_read_b128 v[60:63], v81 offset:24576
    ds_read_b64_tr_b16 v[72:73], v92 offset:36864
    ds_read_b64_tr_b16 v[74:75], v92 offset:37888
    ds_read_b64_tr_b16 v[76:77], v93 offset:36864
    ds_read_b64_tr_b16 v[78:79], v93 offset:37888
    s_waitcnt lgkmcnt(5)
    v_mfma_f32_32x32x16_bf16 v[24:39], v[64:67], v[56:59], v[24:39]
    v_mfma_f32_32x32x16_bf16 v[40:55], v[68:71], v[56:59], v[40:55]
    ds_read_b128 v[56:59], v82 offset:24576
    ds_read_b64_tr_b16 v[64:65], v92 offset:40960
    ds_read_b64_tr_b16 v[66:67], v92 offset:41984
    ds_read_b64_tr_b16 v[68:69], v93 offset:40960
    ds_read_b64_tr_b16 v[70:71], v93 offset:41984
    s_waitcnt lgkmcnt(5)
    v_mfma_f32_32x32x16_bf16 v[24:39], v[72:75], v[60:63], v[24:39]
    v_mfma_f32_32x32x16_bf16 v[40:55], v[76:79], v[60:63], v[40:55]
    ds_read_b128 v[60:63], v83 offset:24576
    ds_read_b64_tr_b16 v[72:73], v92 offset:45056
    ds_read_b64_tr_b16 v[74:75], v92 offset:46080
    ds_read_b64_tr_b16 v[76:77], v93 offset:45056
    ds_read_b64_tr_b16 v[78:79], v93 offset:46080
    s_waitcnt lgkmcnt(5)
    v_mfma_f32_32x32x16_bf16 v[24:39], v[64:67], v[56:59], v[24:39]
    v_mfma_f32_32x32x16_bf16 v[40:55], v[68:71], v[56:59], v[40:55]
    s_waitcnt lgkmcnt(0)
    v_mfma_f32_32x32x16_bf16 v[24:39], v[72:75], v[60:63], v[24:39]
    v_mfma_f32_32x32x16_bf16 v[40:55], v[76:79], v[60:63], v[40:55]
    v_and_b32 v12, 31, v1
    s_mul_i32 s23, s21, 32
    s_add_u32 s23, s23, s19
    v_add_u32 v12, s23, v12
    v_lshrrev_b32 v13, 5, v1
    v_lshlrev_b32 v13, 2, v13
    s_mul_i32 s23, s22, 64
    s_add_u32 s23, s23, s20
    v_add_u32 v13, s23, v13
    s_load_dwordx2 s[16:17], s[0:1], 64
    s_load_dwordx2 s[28:29], s[0:1], 112
    s_load_dwordx2 s[12:13], s[0:1], 112
    s_waitcnt lgkmcnt(0)
    s_add_u32 s12, s12, 0x3400000
    s_addc_u32 s13, s13, 0
    s_and_b32 s13, s13, 0xffff
    s_mov_b32 s14, 0x380000
    s_mov_b32 s15, 0x00020000
    s_and_b32 s17, s17, 0xffff
    s_mov_b32 s18, 0x1000
    s_mov_b32 s19, 0x00020000
    s_add_u32 s28, s28, 0x2800000
    s_addc_u32 s29, s29, 0
    s_and_b32 s29, s29, 0xffff
    s_mov_b32 s30, 0x700000
    s_mov_b32 s31, 0x00020000
    v_mul_u32_u24 v14, 1792, v12
    v_lshlrev_b32 v15, 1, v13
    v_add_u32 v14, v14, v15
    v_mul_u32_u24 v16, 3584, v12
    v_add_u32 v16, v16, v15
    v_lshlrev_b32 v17, 1, v12
    s_mov_b32 s23, 0
    s_mov_b32 s24, 0
    buffer_load_ushort v108, v17, s[16:19], 0 offen offset:0
    s_waitcnt vmcnt(0)
    v_lshlrev_b32 v108, 16, v108
    buffer_load_dwordx2 v[106:107], v16, s[28:31], s24 offen offset:0
    v_cvt_pk_bf16_f32 v98, v24, v24
    v_lshlrev_b32 v98, 16, v98
    v_add_f32 v98, v98, v108
    v_cvt_pk_bf16_f32 v98, v98, v98
    v_lshlrev_b32 v98, 16, v98
    v_cvt_pk_bf16_f32 v99, v25, v25
    v_lshlrev_b32 v99, 16, v99
    v_add_f32 v99, v99, v108
    v_cvt_pk_bf16_f32 v99, v99, v99
    v_lshlrev_b32 v99, 16, v99
    v_cvt_pk_bf16_f32 v100, v26, v26
    v_lshlrev_b32 v100, 16, v100
    v_add_f32 v100, v100, v108
    v_cvt_pk_bf16_f32 v100, v100, v100
    v_lshlrev_b32 v100, 16, v100
    v_cvt_pk_bf16_f32 v101, v27, v27
    v_lshlrev_b32 v101, 16, v101
    v_add_f32 v101, v101, v108
    v_cvt_pk_bf16_f32 v101, v101, v101
    v_lshlrev_b32 v101, 16, v101
    s_waitcnt vmcnt(0)
    v_lshlrev_b32 v102, 16, v106
    v_and_b32 v103, 0xffff0000, v106
    v_lshlrev_b32 v104, 16, v107
    v_and_b32 v105, 0xffff0000, v107
    v_mul_f32 v98, v98, v102
    v_mul_f32 v99, v99, v103
    v_mul_f32 v100, v100, v104
    v_mul_f32 v101, v101, v105
    v_cvt_pk_bf16_f32 v98, v98, v99
    v_cvt_pk_bf16_f32 v99, v100, v101
    buffer_store_dwordx2 v[98:99], v14, s[12:15], s23 offen offset:0
    buffer_load_dwordx2 v[106:107], v16, s[28:31], s24 offen offset:16
    v_cvt_pk_bf16_f32 v98, v28, v28
    v_lshlrev_b32 v98, 16, v98
    v_add_f32 v98, v98, v108
    v_cvt_pk_bf16_f32 v98, v98, v98
    v_lshlrev_b32 v98, 16, v98
    v_cvt_pk_bf16_f32 v99, v29, v29
    v_lshlrev_b32 v99, 16, v99
    v_add_f32 v99, v99, v108
    v_cvt_pk_bf16_f32 v99, v99, v99
    v_lshlrev_b32 v99, 16, v99
    v_cvt_pk_bf16_f32 v100, v30, v30
    v_lshlrev_b32 v100, 16, v100
    v_add_f32 v100, v100, v108
    v_cvt_pk_bf16_f32 v100, v100, v100
    v_lshlrev_b32 v100, 16, v100
    v_cvt_pk_bf16_f32 v101, v31, v31
    v_lshlrev_b32 v101, 16, v101
    v_add_f32 v101, v101, v108
    v_cvt_pk_bf16_f32 v101, v101, v101
    v_lshlrev_b32 v101, 16, v101
    s_waitcnt vmcnt(0)
    v_lshlrev_b32 v102, 16, v106
    v_and_b32 v103, 0xffff0000, v106
    v_lshlrev_b32 v104, 16, v107
    v_and_b32 v105, 0xffff0000, v107
    v_mul_f32 v98, v98, v102
    v_mul_f32 v99, v99, v103
    v_mul_f32 v100, v100, v104
    v_mul_f32 v101, v101, v105
    v_cvt_pk_bf16_f32 v98, v98, v99
    v_cvt_pk_bf16_f32 v99, v100, v101
    buffer_store_dwordx2 v[98:99], v14, s[12:15], s23 offen offset:16
    buffer_load_dwordx2 v[106:107], v16, s[28:31], s24 offen offset:32
    v_cvt_pk_bf16_f32 v98, v32, v32
    v_lshlrev_b32 v98, 16, v98
    v_add_f32 v98, v98, v108
    v_cvt_pk_bf16_f32 v98, v98, v98
    v_lshlrev_b32 v98, 16, v98
    v_cvt_pk_bf16_f32 v99, v33, v33
    v_lshlrev_b32 v99, 16, v99
    v_add_f32 v99, v99, v108
    v_cvt_pk_bf16_f32 v99, v99, v99
    v_lshlrev_b32 v99, 16, v99
    v_cvt_pk_bf16_f32 v100, v34, v34
    v_lshlrev_b32 v100, 16, v100
    v_add_f32 v100, v100, v108
    v_cvt_pk_bf16_f32 v100, v100, v100
    v_lshlrev_b32 v100, 16, v100
    v_cvt_pk_bf16_f32 v101, v35, v35
    v_lshlrev_b32 v101, 16, v101
    v_add_f32 v101, v101, v108
    v_cvt_pk_bf16_f32 v101, v101, v101
    v_lshlrev_b32 v101, 16, v101
    s_waitcnt vmcnt(0)
    v_lshlrev_b32 v102, 16, v106
    v_and_b32 v103, 0xffff0000, v106
    v_lshlrev_b32 v104, 16, v107
    v_and_b32 v105, 0xffff0000, v107
    v_mul_f32 v98, v98, v102
    v_mul_f32 v99, v99, v103
    v_mul_f32 v100, v100, v104
    v_mul_f32 v101, v101, v105
    v_cvt_pk_bf16_f32 v98, v98, v99
    v_cvt_pk_bf16_f32 v99, v100, v101
    buffer_store_dwordx2 v[98:99], v14, s[12:15], s23 offen offset:32
    buffer_load_dwordx2 v[106:107], v16, s[28:31], s24 offen offset:48
    v_cvt_pk_bf16_f32 v98, v36, v36
    v_lshlrev_b32 v98, 16, v98
    v_add_f32 v98, v98, v108
    v_cvt_pk_bf16_f32 v98, v98, v98
    v_lshlrev_b32 v98, 16, v98
    v_cvt_pk_bf16_f32 v99, v37, v37
    v_lshlrev_b32 v99, 16, v99
    v_add_f32 v99, v99, v108
    v_cvt_pk_bf16_f32 v99, v99, v99
    v_lshlrev_b32 v99, 16, v99
    v_cvt_pk_bf16_f32 v100, v38, v38
    v_lshlrev_b32 v100, 16, v100
    v_add_f32 v100, v100, v108
    v_cvt_pk_bf16_f32 v100, v100, v100
    v_lshlrev_b32 v100, 16, v100
    v_cvt_pk_bf16_f32 v101, v39, v39
    v_lshlrev_b32 v101, 16, v101
    v_add_f32 v101, v101, v108
    v_cvt_pk_bf16_f32 v101, v101, v101
    v_lshlrev_b32 v101, 16, v101
    s_waitcnt vmcnt(0)
    v_lshlrev_b32 v102, 16, v106
    v_and_b32 v103, 0xffff0000, v106
    v_lshlrev_b32 v104, 16, v107
    v_and_b32 v105, 0xffff0000, v107
    v_mul_f32 v98, v98, v102
    v_mul_f32 v99, v99, v103
    v_mul_f32 v100, v100, v104
    v_mul_f32 v101, v101, v105
    v_cvt_pk_bf16_f32 v98, v98, v99
    v_cvt_pk_bf16_f32 v99, v100, v101
    buffer_store_dwordx2 v[98:99], v14, s[12:15], s23 offen offset:48
    buffer_load_dwordx2 v[106:107], v16, s[28:31], s24 offen offset:64
    v_cvt_pk_bf16_f32 v98, v40, v40
    v_lshlrev_b32 v98, 16, v98
    v_add_f32 v98, v98, v108
    v_cvt_pk_bf16_f32 v98, v98, v98
    v_lshlrev_b32 v98, 16, v98
    v_cvt_pk_bf16_f32 v99, v41, v41
    v_lshlrev_b32 v99, 16, v99
    v_add_f32 v99, v99, v108
    v_cvt_pk_bf16_f32 v99, v99, v99
    v_lshlrev_b32 v99, 16, v99
    v_cvt_pk_bf16_f32 v100, v42, v42
    v_lshlrev_b32 v100, 16, v100
    v_add_f32 v100, v100, v108
    v_cvt_pk_bf16_f32 v100, v100, v100
    v_lshlrev_b32 v100, 16, v100
    v_cvt_pk_bf16_f32 v101, v43, v43
    v_lshlrev_b32 v101, 16, v101
    v_add_f32 v101, v101, v108
    v_cvt_pk_bf16_f32 v101, v101, v101
    v_lshlrev_b32 v101, 16, v101
    s_waitcnt vmcnt(0)
    v_lshlrev_b32 v102, 16, v106
    v_and_b32 v103, 0xffff0000, v106
    v_lshlrev_b32 v104, 16, v107
    v_and_b32 v105, 0xffff0000, v107
    v_mul_f32 v98, v98, v102
    v_mul_f32 v99, v99, v103
    v_mul_f32 v100, v100, v104
    v_mul_f32 v101, v101, v105
    v_cvt_pk_bf16_f32 v98, v98, v99
    v_cvt_pk_bf16_f32 v99, v100, v101
    buffer_store_dwordx2 v[98:99], v14, s[12:15], s23 offen offset:64
    buffer_load_dwordx2 v[106:107], v16, s[28:31], s24 offen offset:80
    v_cvt_pk_bf16_f32 v98, v44, v44
    v_lshlrev_b32 v98, 16, v98
    v_add_f32 v98, v98, v108
    v_cvt_pk_bf16_f32 v98, v98, v98
    v_lshlrev_b32 v98, 16, v98
    v_cvt_pk_bf16_f32 v99, v45, v45
    v_lshlrev_b32 v99, 16, v99
    v_add_f32 v99, v99, v108
    v_cvt_pk_bf16_f32 v99, v99, v99
    v_lshlrev_b32 v99, 16, v99
    v_cvt_pk_bf16_f32 v100, v46, v46
    v_lshlrev_b32 v100, 16, v100
    v_add_f32 v100, v100, v108
    v_cvt_pk_bf16_f32 v100, v100, v100
    v_lshlrev_b32 v100, 16, v100
    v_cvt_pk_bf16_f32 v101, v47, v47
    v_lshlrev_b32 v101, 16, v101
    v_add_f32 v101, v101, v108
    v_cvt_pk_bf16_f32 v101, v101, v101
    v_lshlrev_b32 v101, 16, v101
    s_waitcnt vmcnt(0)
    v_lshlrev_b32 v102, 16, v106
    v_and_b32 v103, 0xffff0000, v106
    v_lshlrev_b32 v104, 16, v107
    v_and_b32 v105, 0xffff0000, v107
    v_mul_f32 v98, v98, v102
    v_mul_f32 v99, v99, v103
    v_mul_f32 v100, v100, v104
    v_mul_f32 v101, v101, v105
    v_cvt_pk_bf16_f32 v98, v98, v99
    v_cvt_pk_bf16_f32 v99, v100, v101
    buffer_store_dwordx2 v[98:99], v14, s[12:15], s23 offen offset:80
    buffer_load_dwordx2 v[106:107], v16, s[28:31], s24 offen offset:96
    v_cvt_pk_bf16_f32 v98, v48, v48
    v_lshlrev_b32 v98, 16, v98
    v_add_f32 v98, v98, v108
    v_cvt_pk_bf16_f32 v98, v98, v98
    v_lshlrev_b32 v98, 16, v98
    v_cvt_pk_bf16_f32 v99, v49, v49
    v_lshlrev_b32 v99, 16, v99
    v_add_f32 v99, v99, v108
    v_cvt_pk_bf16_f32 v99, v99, v99
    v_lshlrev_b32 v99, 16, v99
    v_cvt_pk_bf16_f32 v100, v50, v50
    v_lshlrev_b32 v100, 16, v100
    v_add_f32 v100, v100, v108
    v_cvt_pk_bf16_f32 v100, v100, v100
    v_lshlrev_b32 v100, 16, v100
    v_cvt_pk_bf16_f32 v101, v51, v51
    v_lshlrev_b32 v101, 16, v101
    v_add_f32 v101, v101, v108
    v_cvt_pk_bf16_f32 v101, v101, v101
    v_lshlrev_b32 v101, 16, v101
    s_waitcnt vmcnt(0)
    v_lshlrev_b32 v102, 16, v106
    v_and_b32 v103, 0xffff0000, v106
    v_lshlrev_b32 v104, 16, v107
    v_and_b32 v105, 0xffff0000, v107
    v_mul_f32 v98, v98, v102
    v_mul_f32 v99, v99, v103
    v_mul_f32 v100, v100, v104
    v_mul_f32 v101, v101, v105
    v_cvt_pk_bf16_f32 v98, v98, v99
    v_cvt_pk_bf16_f32 v99, v100, v101
    buffer_store_dwordx2 v[98:99], v14, s[12:15], s23 offen offset:96
    buffer_load_dwordx2 v[106:107], v16, s[28:31], s24 offen offset:112
    v_cvt_pk_bf16_f32 v98, v52, v52
    v_lshlrev_b32 v98, 16, v98
    v_add_f32 v98, v98, v108
    v_cvt_pk_bf16_f32 v98, v98, v98
    v_lshlrev_b32 v98, 16, v98
    v_cvt_pk_bf16_f32 v99, v53, v53
    v_lshlrev_b32 v99, 16, v99
    v_add_f32 v99, v99, v108
    v_cvt_pk_bf16_f32 v99, v99, v99
    v_lshlrev_b32 v99, 16, v99
    v_cvt_pk_bf16_f32 v100, v54, v54
    v_lshlrev_b32 v100, 16, v100
    v_add_f32 v100, v100, v108
    v_cvt_pk_bf16_f32 v100, v100, v100
    v_lshlrev_b32 v100, 16, v100
    v_cvt_pk_bf16_f32 v101, v55, v55
    v_lshlrev_b32 v101, 16, v101
    v_add_f32 v101, v101, v108
    v_cvt_pk_bf16_f32 v101, v101, v101
    v_lshlrev_b32 v101, 16, v101
    s_waitcnt vmcnt(0)
    v_lshlrev_b32 v102, 16, v106
    v_and_b32 v103, 0xffff0000, v106
    v_lshlrev_b32 v104, 16, v107
    v_and_b32 v105, 0xffff0000, v107
    v_mul_f32 v98, v98, v102
    v_mul_f32 v99, v99, v103
    v_mul_f32 v100, v100, v104
    v_mul_f32 v101, v101, v105
    v_cvt_pk_bf16_f32 v98, v98, v99
    v_cvt_pk_bf16_f32 v99, v100, v101
    buffer_store_dwordx2 v[98:99], v14, s[12:15], s23 offen offset:112
    s_nop 3
.Lend_gemmsp_kernel:
    s_endpgm
.globl gemmout_kernel
.p2align 8
.type gemmout_kernel,@function
gemmout_kernel:
    s_cmp_ge_u32 s2, 256
    s_cbranch_scc1 .Lend_gemmout_kernel
    s_load_dwordx2 s[4:5], s[0:1], 112
    s_load_dwordx2 s[8:9], s[0:1], 72
    v_and_b32 v1, 63, v0
    v_lshrrev_b32 v12, 6, v0
    s_nop 0
    v_readfirstlane_b32 s3, v12
    s_mov_b32 s29, 0
    s_mov_b32 s16, s2
    s_mul_hi_u32 s17, s16, 0x20000001
    s_mul_i32 s18, s17, 8
    s_sub_u32 s18, s16, s18
    s_mul_i32 s19, s17, 64
    s_mul_i32 s20, s18, 64
    s_and_b32 s21, s3, 1
    s_lshr_b32 s22, s3, 1
    s_waitcnt lgkmcnt(0)
    s_add_u32 s4, s4, 0x3400000
    s_addc_u32 s5, s5, 0
    s_and_b32 s5, s5, 0xffff
    s_mov_b32 s6, 0x380000
    s_mov_b32 s7, 0x00020000
    s_and_b32 s9, s9, 0xffff
    s_mov_b32 s10, 0xe0000
    s_mov_b32 s11, 0x00020000
    v_lshrrev_b32 v12, 3, v1
    v_mul_u32_u24 v10, 1792, v12
    v_lshrrev_b32 v13, 4, v1
    s_and_b32 s23, s3, 1
    s_lshl_b32 s23, s23, 2
    v_add_u32 v13, s23, v13
    v_and_b32 v13, 7, v13
    v_and_b32 v14, 7, v1
    v_xor_b32 v14, v14, v13
    v_lshlrev_b32 v14, 4, v14
    v_add_u32 v10, v10, v14
    v_lshrrev_b32 v12, 3, v1
    v_mul_u32_u24 v11, 1024, v12
    v_lshrrev_b32 v13, 1, v12
    v_and_b32 v13, 1, v13
    v_lshlrev_b32 v13, 2, v13
    v_and_b32 v14, 7, v1
    v_xor_b32 v14, v14, v13
    v_lshlrev_b32 v14, 4, v14
    v_add_u32 v11, v11, v14
    s_lshl_b32 s23, s3, 3
    s_add_u32 s23, s23, s19
    s_mul_i32 s24, s23, 1792
    s_mul_i32 s25, s3, 8192
    s_lshl_b32 s23, s20, 1
    s_add_u32 s25, s25, s23
    s_lshl_b32 s27, s3, 10
    s_add_u32 m0, s27, 0
    s_add_u32 s26, s24, 0
    buffer_load_dwordx4 v10, s[4:7], s26 offen lds
    s_add_u32 m0, s27, 4096
    s_add_u32 s26, s24, 57344
    buffer_load_dwordx4 v10, s[4:7], s26 offen lds
    s_add_u32 m0, s27, 8192
    s_add_u32 s26, s25, 0
    buffer_load_dwordx4 v11, s[8:11], s26 offen lds
    s_add_u32 m0, s27, 12288
    s_add_u32 s26, s25, 32768
    buffer_load_dwordx4 v11, s[8:11], s26 offen lds
    s_add_u32 s24, s24, 128
    s_add_u32 s25, s25, 65536
    s_add_u32 m0, s27, 16384
    s_add_u32 s26, s24, 0
    buffer_load_dwordx4 v10, s[4:7], s26 offen lds
    s_add_u32 m0, s27, 20480
    s_add_u32 s26, s24, 57344
    buffer_load_dwordx4 v10, s[4:7], s26 offen lds
    s_add_u32 m0, s27, 24576
    s_add_u32 s26, s25, 0
    buffer_load_dwordx4 v11, s[8:11], s26 offen lds
    s_add_u32 m0, s27, 28672
    s_add_u32 s26, s25, 32768
    buffer_load_dwordx4 v11, s[8:11], s26 offen lds
    s_add_u32 s24, s24, 128
    s_add_u32 s25, s25, 65536
    s_add_u32 m0, s27, 32768
    s_add_u32 s26, s24, 0
    buffer_load_dwordx4 v10, s[4:7], s26 offen lds
    s_add_u32 m0, s27, 36864
    s_add_u32 s26, s24, 57344
    buffer_load_dwordx4 v10, s[4:7], s26 offen lds
    s_add_u32 m0, s27, 40960
    s_add_u32 s26, s25, 0
    buffer_load_dwordx4 v11, s[8:11], s26 offen lds
    s_add_u32 m0, s27, 45056
    s_add_u32 s26, s25, 32768
    buffer_load_dwordx4 v11, s[8:11], s26 offen lds
    s_add_u32 s24, s24, 128
    s_add_u32 s25, s25, 65536
    s_add_u32 m0, s27, 49152
    s_add_u32 s26, s24, 0
    buffer_load_dwordx4 v10, s[4:7], s26 offen lds
    s_add_u32 m0, s27, 53248
    s_add_u32 s26, s24, 57344
    buffer_load_dwordx4 v10, s[4:7], s26 offen lds
    s_add_u32 m0, s27, 57344
    s_add_u32 s26, s25, 0
    buffer_load_dwordx4 v11, s[8:11], s26 offen lds
    s_add_u32 m0, s27, 61440
    s_add_u32 s26, s25, 32768
    buffer_load_dwordx4 v11, s[8:11], s26 offen lds
    s_add_u32 s24, s24, 128
    s_add_u32 s25, s25, 65536
    s_add_u32 m0, s27, 65536
    s_add_u32 s26, s24, 0
    buffer_load_dwordx4 v10, s[4:7], s26 offen lds
    s_add_u32 m0, s27, 69632
    s_add_u32 s26, s24, 57344
    buffer_load_dwordx4 v10, s[4:7], s26 offen lds
    s_add_u32 m0, s27, 73728
    s_add_u32 s26, s25, 0
    buffer_load_dwordx4 v11, s[8:11], s26 offen lds
    s_add_u32 m0, s27, 77824
    s_add_u32 s26, s25, 32768
    buffer_load_dwordx4 v11, s[8:11], s26 offen lds
    s_add_u32 s24, s24, 128
    s_add_u32 s25, s25, 65536
    s_add_u32 m0, s27, 81920
    s_add_u32 s26, s24, 0
    buffer_load_dwordx4 v10, s[4:7], s26 offen lds
    s_add_u32 m0, s27, 86016
    s_add_u32 s26, s24, 57344
    buffer_load_dwordx4 v10, s[4:7], s26 offen lds
    s_add_u32 m0, s27, 90112
    s_add_u32 s26, s25, 0
    buffer_load_dwordx4 v11, s[8:11], s26 offen lds
    s_add_u32 m0, s27, 94208
    s_add_u32 s26, s25, 32768
    buffer_load_dwordx4 v11, s[8:11], s26 offen lds
    s_add_u32 s24, s24, 128
    s_add_u32 s25, s25, 65536
    s_add_u32 m0, s27, 98304
    s_add_u32 s26, s24, 0
    buffer_load_dwordx4 v10, s[4:7], s26 offen lds
    s_add_u32 m0, s27, 102400
    s_add_u32 s26, s24, 57344
    buffer_load_dwordx4 v10, s[4:7], s26 offen lds
    s_add_u32 m0, s27, 106496
    s_add_u32 s26, s25, 0
    buffer_load_dwordx4 v11, s[8:11], s26 offen lds
    s_add_u32 m0, s27, 110592
    s_add_u32 s26, s25, 32768
    buffer_load_dwordx4 v11, s[8:11], s26 offen lds
    s_add_u32 s24, s24, 128
    s_add_u32 s25, s25, 65536
    v_and_b32 v12, 31, v1
    s_mul_i32 s23, s21, 32
    v_add_u32 v12, s23, v12
    v_lshrrev_b32 v13, 1, v12
    v_and_b32 v13, 7, v13
    v_lshrrev_b32 v14, 5, v1
    v_lshlrev_b32 v12, 7, v12
    v_add_u32 v15, 0, v14
    v_xor_b32 v15, v15, v13
    v_lshlrev_b32 v15, 4, v15
    v_add_u32 v56, v12, v15
    v_add_u32 v15, 2, v14
    v_xor_b32 v15, v15, v13
    v_lshlrev_b32 v15, 4, v15
    v_add_u32 v57, v12, v15
    v_add_u32 v15, 4, v14
    v_xor_b32 v15, v15, v13
    v_lshlrev_b32 v15, 4, v15
    v_add_u32 v58, v12, v15
    v_add_u32 v15, 6, v14
    v_xor_b32 v15, v15, v13
    v_lshlrev_b32 v15, 4, v15
    v_add_u32 v59, v12, v15
    v_lshrrev_b32 v12, 2, v1
    v_and_b32 v12, 3, v12
    v_lshrrev_b32 v13, 5, v1
    v_lshlrev_b32 v13, 3, v13
    v_add_u32 v13, v13, v12
    v_mul_u32_u24 v13, 128, v13
    v_lshrrev_b32 v14, 4, v1
    v_and_b32 v14, 1, v14
    v_lshlrev_b32 v14, 1, v14
    v_and_b32 v15, 3, v1
    v_lshrrev_b32 v16, 1, v15
    v_add_u32 v14, v14, v16
    v_and_b32 v15, 1, v15
    v_lshlrev_b32 v15, 3, v15
    v_add_u32 v13, v13, v15
    v_lshrrev_b32 v12, 1, v12
    v_lshlrev_b32 v12, 2, v12
    s_mul_i32 s23, s22, 4
    s_add_u32 s23, s23, 0
    v_add_u32 v15, s23, v14
    v_xor_b32 v15, v15, v12
    v_lshlrev_b32 v15, 4, v15
    v_add_u32 v64, v13, v15
    v_add_u32 v60, 0x10000, v56
    v_add_u32 v61, 0x10000, v57
    v_add_u32 v62, 0x10000, v58
    v_add_u32 v63, 0x10000, v59
    v_add_u32 v65, 0x10000, v64
    s_waitcnt vmcnt(24)
    s_barrier
    s_add_u32 m0, s27, 114688
    s_add_u32 s26, s24, 0
    buffer_load_dwordx4 v10, s[4:7], s26 offen lds
    s_add_u32 m0, s27, 118784
    s_add_u32 s26, s24, 57344
    buffer_load_dwordx4 v10, s[4:7], s26 offen lds
    s_add_u32 m0, s27, 122880
    s_add_u32 s26, s25, 0
    buffer_load_dwordx4 v11, s[8:11], s26 offen lds
    s_add_u32 m0, s27, 126976
    s_add_u32 s26, s25, 32768
    buffer_load_dwordx4 v11, s[8:11], s26 offen lds
    s_add_u32 s24, s24, 128
    s_add_u32 s25, s25, 65536
    ds_read_b128 v[40:43], v56 offset:0
    ds_read_b64_tr_b16 v[48:49], v64 offset:8192
    ds_read_b64_tr_b16 v[50:51], v64 offset:8704
    ds_read_b128 v[44:47], v57 offset:0
    ds_read_b64_tr_b16 v[52:53], v64 offset:10240
    ds_read_b64_tr_b16 v[54:55], v64 offset:10752
    s_waitcnt lgkmcnt(3)
    v_mfma_f32_32x32x16_bf16 v[24:39], v[48:51], v[40:43], 0
    ds_read_b128 v[40:43], v58 offset:0
    ds_read_b64_tr_b16 v[48:49], v64 offset:12288
    ds_read_b64_tr_b16 v[50:51], v64 offset:12800
    s_waitcnt lgkmcnt(3)
    v_mfma_f32_32x32x16_bf16 v[24:39], v[52:55], v[44:47], v[24:39]
    ds_read_b128 v[44:47], v59 offset:0
    ds_read_b64_tr_b16 v[52:53], v64 offset:14336
    ds_read_b64_tr_b16 v[54:55], v64 offset:14848
    s_waitcnt lgkmcnt(3)
    v_mfma_f32_32x32x16_bf16 v[24:39], v[48:51], v[40:43], v[24:39]
    s_waitcnt lgkmcnt(0)
    v_mfma_f32_32x32x16_bf16 v[24:39], v[52:55], v[44:47], v[24:39]
    s_waitcnt vmcnt(24)
    s_barrier
    s_add_u32 m0, s27, 0
    s_add_u32 s26, s24, 0
    buffer_load_dwordx4 v10, s[4:7], s26 offen lds
    s_add_u32 m0, s27, 4096
    s_add_u32 s26, s24, 57344
    buffer_load_dwordx4 v10, s[4:7], s26 offen lds
    s_add_u32 m0, s27, 8192
    s_add_u32 s26, s25, 0
    buffer_load_dwordx4 v11, s[8:11], s26 offen lds
    s_add_u32 m0, s27, 12288
    s_add_u32 s26, s25, 32768
    buffer_load_dwordx4 v11, s[8:11], s26 offen lds
    s_add_u32 s24, s24, 128
    s_add_u32 s25, s25, 65536
    ds_read_b128 v[40:43], v56 offset:16384
    ds_read_b64_tr_b16 v[48:49], v64 offset:24576
    ds_read_b64_tr_b16 v[50:51], v64 offset:25088
    ds_read_b128 v[44:47], v57 offset:16384
    ds_read_b64_tr_b16 v[52:53], v64 offset:26624
    ds_read_b64_tr_b16 v[54:55], v64 offset:27136
    s_waitcnt lgkmcnt(3)
    v_mfma_f32_32x32x16_bf16 v[24:39], v[48:51], v[40:43], v[24:39]
    ds_read_b128 v[40:43], v58 offset:16384
    ds_read_b64_tr_b16 v[48:49], v64 offset:28672
    ds_read_b64_tr_b16 v[50:51], v64 offset:29184
    s_waitcnt lgkmcnt(3)
    v_mfma_f32_32x32x16_bf16 v[24:39], v[52:55], v[44:47], v[24:39]
    ds_read_b128 v[44:47], v59 offset:16384
    ds_read_b64_tr_b16 v[52:53], v64 offset:30720
    ds_read_b64_tr_b16 v[54:55], v64 offset:31232
    s_waitcnt lgkmcnt(3)
    v_mfma_f32_32x32x16_bf16 v[24:39], v[48:51], v[40:43], v[24:39]
    s_waitcnt lgkmcnt(0)
    v_mfma_f32_32x32x16_bf16 v[24:39], v[52:55], v[44:47], v[24:39]
    s_waitcnt vmcnt(24)
    s_barrier
    s_add_u32 m0, s27, 16384
    s_add_u32 s26, s24, 0
    buffer_load_dwordx4 v10, s[4:7], s26 offen lds
    s_add_u32 m0, s27, 20480
    s_add_u32 s26, s24, 57344
    buffer_load_dwordx4 v10, s[4:7], s26 offen lds
    s_add_u32 m0, s27, 24576
    s_add_u32 s26, s25, 0
    buffer_load_dwordx4 v11, s[8:11], s26 offen lds
    s_add_u32 m0, s27, 28672
    s_add_u32 s26, s25, 32768
    buffer_load_dwordx4 v11, s[8:11], s26 offen lds
    s_add_u32 s24, s24, 128
    s_add_u32 s25, s25, 65536
    ds_read_b128 v[40:43], v56 offset:32768
    ds_read_b64_tr_b16 v[48:49], v64 offset:40960
    ds_read_b64_tr_b16 v[50:51], v64 offset:41472
    ds_read_b128 v[44:47], v57 offset:32768
    ds_read_b64_tr_b16 v[52:53], v64 offset:43008
    ds_read_b64_tr_b16 v[54:55], v64 offset:43520
    s_waitcnt lgkmcnt(3)
    v_mfma_f32_32x32x16_bf16 v[24:39], v[48:51], v[40:43], v[24:39]
    ds_read_b128 v[40:43], v58 offset:32768
    ds_read_b64_tr_b16 v[48:49], v64 offset:45056
    ds_read_b64_tr_b16 v[50:51], v64 offset:45568
    s_waitcnt lgkmcnt(3)
    v_mfma_f32_32x32x16_bf16 v[24:39], v[52:55], v[44:47], v[24:39]
    ds_read_b128 v[44:47], v59 offset:32768
    ds_read_b64_tr_b16 v[52:53], v64 offset:47104
    ds_read_b64_tr_b16 v[54:55], v64 offset:47616
    s_waitcnt lgkmcnt(3)
    v_mfma_f32_32x32x16_bf16 v[24:39], v[48:51], v[40:43], v[24:39]
    s_waitcnt lgkmcnt(0)
    v_mfma_f32_32x32x16_bf16 v[24:39], v[52:55], v[44:47], v[24:39]
    s_waitcnt vmcnt(24)
    s_barrier
    s_add_u32 m0, s27, 32768
    s_add_u32 s26, s24, 0
    buffer_load_dwordx4 v10, s[4:7], s26 offen lds
    s_add_u32 m0, s27, 36864
    s_add_u32 s26, s24, 57344
    buffer_load_dwordx4 v10, s[4:7], s26 offen lds
    s_add_u32 m0, s27, 40960
    s_add_u32 s26, s25, 0
    buffer_load_dwordx4 v11, s[8:11], s26 offen lds
    s_add_u32 m0, s27, 45056
    s_add_u32 s26, s25, 32768
    buffer_load_dwordx4 v11, s[8:11], s26 offen lds
    s_add_u32 s24, s24, 128
    s_add_u32 s25, s25, 65536
    ds_read_b128 v[40:43], v56 offset:49152
    ds_read_b64_tr_b16 v[48:49], v64 offset:57344
    ds_read_b64_tr_b16 v[50:51], v64 offset:57856
    ds_read_b128 v[44:47], v57 offset:49152
    ds_read_b64_tr_b16 v[52:53], v64 offset:59392
    ds_read_b64_tr_b16 v[54:55], v64 offset:59904
    s_waitcnt lgkmcnt(3)
    v_mfma_f32_32x32x16_bf16 v[24:39], v[48:51], v[40:43], v[24:39]
    ds_read_b128 v[40:43], v58 offset:49152
    ds_read_b64_tr_b16 v[48:49], v64 offset:61440
    ds_read_b64_tr_b16 v[50:51], v64 offset:61952
    s_waitcnt lgkmcnt(3)
    v_mfma_f32_32x32x16_bf16 v[24:39], v[52:55], v[44:47], v[24:39]
    ds_read_b128 v[44:47], v59 offset:49152
    ds_read_b64_tr_b16 v[52:53], v64 offset:63488
    ds_read_b64_tr_b16 v[54:55], v64 offset:64000
    s_waitcnt lgkmcnt(3)
    v_mfma_f32_32x32x16_bf16 v[24:39], v[48:51], v[40:43], v[24:39]
    s_waitcnt lgkmcnt(0)
    v_mfma_f32_32x32x16_bf16 v[24:39], v[52:55], v[44:47], v[24:39]
    s_waitcnt vmcnt(24)
    s_barrier
    s_add_u32 m0, s27, 49152
    s_add_u32 s26, s24, 0
    buffer_load_dwordx4 v10, s[4:7], s26 offen lds
    s_add_u32 m0, s27, 53248
    s_add_u32 s26, s24, 57344
    buffer_load_dwordx4 v10, s[4:7], s26 offen lds
    s_add_u32 m0, s27, 57344
    s_add_u32 s26, s25, 0
    buffer_load_dwordx4 v11, s[8:11], s26 offen lds
    s_add_u32 m0, s27, 61440
    s_add_u32 s26, s25, 32768
    buffer_load_dwordx4 v11, s[8:11], s26 offen lds
    s_add_u32 s24, s24, 128
    s_add_u32 s25, s25, 65536
    ds_read_b128 v[40:43], v60 offset:0
    ds_read_b64_tr_b16 v[48:49], v65 offset:8192
    ds_read_b64_tr_b16 v[50:51], v65 offset:8704
    ds_read_b128 v[44:47], v61 offset:0
    ds_read_b64_tr_b16 v[52:53], v65 offset:10240
    ds_read_b64_tr_b16 v[54:55], v65 offset:10752
    s_waitcnt lgkmcnt(3)
    v_mfma_f32_32x32x16_bf16 v[24:39], v[48:51], v[40:43], v[24:39]
    ds_read_b128 v[40:43], v62 offset:0
    ds_read_b64_tr_b16 v[48:49], v65 offset:12288
    ds_read_b64_tr_b16 v[50:51], v65 offset:12800
    s_waitcnt lgkmcnt(3)
    v_mfma_f32_32x32x16_bf16 v[24:39], v[52:55], v[44:47], v[24:39]
    ds_read_b128 v[44:47], v63 offset:0
    ds_read_b64_tr_b16 v[52:53], v65 offset:14336
    ds_read_b64_tr_b16 v[54:55], v65 offset:14848
    s_waitcnt lgkmcnt(3)
    v_mfma_f32_32x32x16_bf16 v[24:39], v[48:51], v[40:43], v[24:39]
    s_waitcnt lgkmcnt(0)
    v_mfma_f32_32x32x16_bf16 v[24:39], v[52:55], v[44:47], v[24:39]
    s_waitcnt vmcnt(24)
    s_barrier
    s_add_u32 m0, s27, 65536
    s_add_u32 s26, s24, 0
    buffer_load_dwordx4 v10, s[4:7], s26 offen lds
    s_add_u32 m0, s27, 69632
    s_add_u32 s26, s24, 57344
    buffer_load_dwordx4 v10, s[4:7], s26 offen lds
    s_add_u32 m0, s27, 73728
    s_add_u32 s26, s25, 0
    buffer_load_dwordx4 v11, s[8:11], s26 offen lds
    s_add_u32 m0, s27, 77824
    s_add_u32 s26, s25, 32768
    buffer_load_dwordx4 v11, s[8:11], s26 offen lds
    s_add_u32 s24, s24, 128
    s_add_u32 s25, s25, 65536
    ds_read_b128 v[40:43], v60 offset:16384
    ds_read_b64_tr_b16 v[48:49], v65 offset:24576
    ds_read_b64_tr_b16 v[50:51], v65 offset:25088
    ds_read_b128 v[44:47], v61 offset:16384
    ds_read_b64_tr_b16 v[52:53], v65 offset:26624
    ds_read_b64_tr_b16 v[54:55], v65 offset:27136
    s_waitcnt lgkmcnt(3)
    v_mfma_f32_32x32x16_bf16 v[24:39], v[48:51], v[40:43], v[24:39]
    ds_read_b128 v[40:43], v62 offset:16384
    ds_read_b64_tr_b16 v[48:49], v65 offset:28672
    ds_read_b64_tr_b16 v[50:51], v65 offset:29184
    s_waitcnt lgkmcnt(3)
    v_mfma_f32_32x32x16_bf16 v[24:39], v[52:55], v[44:47], v[24:39]
    ds_read_b128 v[44:47], v63 offset:16384
    ds_read_b64_tr_b16 v[52:53], v65 offset:30720
    ds_read_b64_tr_b16 v[54:55], v65 offset:31232
    s_waitcnt lgkmcnt(3)
    v_mfma_f32_32x32x16_bf16 v[24:39], v[48:51], v[40:43], v[24:39]
    s_waitcnt lgkmcnt(0)
    v_mfma_f32_32x32x16_bf16 v[24:39], v[52:55], v[44:47], v[24:39]
    s_waitcnt vmcnt(24)
    s_barrier
    s_add_u32 m0, s27, 81920
    s_add_u32 s26, s24, 0
    buffer_load_dwordx4 v10, s[4:7], s26 offen lds
    s_add_u32 m0, s27, 86016
    s_add_u32 s26, s24, 57344
    buffer_load_dwordx4 v10, s[4:7], s26 offen lds
    s_add_u32 m0, s27, 90112
    s_add_u32 s26, s25, 0
    buffer_load_dwordx4 v11, s[8:11], s26 offen lds
    s_add_u32 m0, s27, 94208
    s_add_u32 s26, s25, 32768
    buffer_load_dwordx4 v11, s[8:11], s26 offen lds
    s_add_u32 s24, s24, 128
    s_add_u32 s25, s25, 65536
    ds_read_b128 v[40:43], v60 offset:32768
    ds_read_b64_tr_b16 v[48:49], v65 offset:40960
    ds_read_b64_tr_b16 v[50:51], v65 offset:41472
    ds_read_b128 v[44:47], v61 offset:32768
    ds_read_b64_tr_b16 v[52:53], v65 offset:43008
    ds_read_b64_tr_b16 v[54:55], v65 offset:43520
    s_waitcnt lgkmcnt(3)
    v_mfma_f32_32x32x16_bf16 v[24:39], v[48:51], v[40:43], v[24:39]
    ds_read_b128 v[40:43], v62 offset:32768
    ds_read_b64_tr_b16 v[48:49], v65 offset:45056
    ds_read_b64_tr_b16 v[50:51], v65 offset:45568
    s_waitcnt lgkmcnt(3)
    v_mfma_f32_32x32x16_bf16 v[24:39], v[52:55], v[44:47], v[24:39]
    ds_read_b128 v[44:47], v63 offset:32768
    ds_read_b64_tr_b16 v[52:53], v65 offset:47104
    ds_read_b64_tr_b16 v[54:55], v65 offset:47616
    s_waitcnt lgkmcnt(3)
    v_mfma_f32_32x32x16_bf16 v[24:39], v[48:51], v[40:43], v[24:39]
    s_waitcnt lgkmcnt(0)
    v_mfma_f32_32x32x16_bf16 v[24:39], v[52:55], v[44:47], v[24:39]
    s_waitcnt vmcnt(24)
    s_barrier
    ds_read_b128 v[40:43], v60 offset:49152
    ds_read_b64_tr_b16 v[48:49], v65 offset:57344
    ds_read_b64_tr_b16 v[50:51], v65 offset:57856
    ds_read_b128 v[44:47], v61 offset:49152
    ds_read_b64_tr_b16 v[52:53], v65 offset:59392
    ds_read_b64_tr_b16 v[54:55], v65 offset:59904
    s_waitcnt lgkmcnt(3)
    v_mfma_f32_32x32x16_bf16 v[24:39], v[48:51], v[40:43], v[24:39]
    ds_read_b128 v[40:43], v62 offset:49152
    ds_read_b64_tr_b16 v[48:49], v65 offset:61440
    ds_read_b64_tr_b16 v[50:51], v65 offset:61952
    s_waitcnt lgkmcnt(3)
    v_mfma_f32_32x32x16_bf16 v[24:39], v[52:55], v[44:47], v[24:39]
    ds_read_b128 v[44:47], v63 offset:49152
    ds_read_b64_tr_b16 v[52:53], v65 offset:63488
    ds_read_b64_tr_b16 v[54:55], v65 offset:64000
    s_waitcnt lgkmcnt(3)
    v_mfma_f32_32x32x16_bf16 v[24:39], v[48:51], v[40:43], v[24:39]
    s_waitcnt lgkmcnt(0)
    v_mfma_f32_32x32x16_bf16 v[24:39], v[52:55], v[44:47], v[24:39]
    s_waitcnt vmcnt(20)
    s_barrier
    ds_read_b128 v[40:43], v56 offset:0
    ds_read_b64_tr_b16 v[48:49], v64 offset:8192
    ds_read_b64_tr_b16 v[50:51], v64 offset:8704
    ds_read_b128 v[44:47], v57 offset:0
    ds_read_b64_tr_b16 v[52:53], v64 offset:10240
    ds_read_b64_tr_b16 v[54:55], v64 offset:10752
    s_waitcnt lgkmcnt(3)
    v_mfma_f32_32x32x16_bf16 v[24:39], v[48:51], v[40:43], v[24:39]
    ds_read_b128 v[40:43], v58 offset:0
    ds_read_b64_tr_b16 v[48:49], v64 offset:12288
    ds_read_b64_tr_b16 v[50:51], v64 offset:12800
    s_waitcnt lgkmcnt(3)
    v_mfma_f32_32x32x16_bf16 v[24:39], v[52:55], v[44:47], v[24:39]
    ds_read_b128 v[44:47], v59 offset:0
    ds_read_b64_tr_b16 v[52:53], v64 offset:14336
    ds_read_b64_tr_b16 v[54:55], v64 offset:14848
    s_waitcnt lgkmcnt(3)
    v_mfma_f32_32x32x16_bf16 v[24:39], v[48:51], v[40:43], v[24:39]
    s_waitcnt lgkmcnt(0)
    v_mfma_f32_32x32x16_bf16 v[24:39], v[52:55], v[44:47], v[24:39]
    s_waitcnt vmcnt(16)
    s_barrier
    ds_read_b128 v[40:43], v56 offset:16384
    ds_read_b64_tr_b16 v[48:49], v64 offset:24576
    ds_read_b64_tr_b16 v[50:51], v64 offset:25088
    ds_read_b128 v[44:47], v57 offset:16384
    ds_read_b64_tr_b16 v[52:53], v64 offset:26624
    ds_read_b64_tr_b16 v[54:55], v64 offset:27136
    s_waitcnt lgkmcnt(3)
    v_mfma_f32_32x32x16_bf16 v[24:39], v[48:51], v[40:43], v[24:39]
    ds_read_b128 v[40:43], v58 offset:16384
    ds_read_b64_tr_b16 v[48:49], v64 offset:28672
    ds_read_b64_tr_b16 v[50:51], v64 offset:29184
    s_waitcnt lgkmcnt(3)
    v_mfma_f32_32x32x16_bf16 v[24:39], v[52:55], v[44:47], v[24:39]
    ds_read_b128 v[44:47], v59 offset:16384
    ds_read_b64_tr_b16 v[52:53], v64 offset:30720
    ds_read_b64_tr_b16 v[54:55], v64 offset:31232
    s_waitcnt lgkmcnt(3)
    v_mfma_f32_32x32x16_bf16 v[24:39], v[48:51], v[40:43], v[24:39]
    s_waitcnt lgkmcnt(0)
    v_mfma_f32_32x32x16_bf16 v[24:39], v[52:55], v[44:47], v[24:39]
    s_waitcnt vmcnt(12)
    s_barrier
    ds_read_b128 v[40:43], v56 offset:32768
    ds_read_b64_tr_b16 v[48:49], v64 offset:40960
    ds_read_b64_tr_b16 v[50:51], v64 offset:41472
    ds_read_b128 v[44:47], v57 offset:32768
    ds_read_b64_tr_b16 v[52:53], v64 offset:43008
    ds_read_b64_tr_b16 v[54:55], v64 offset:43520
    s_waitcnt lgkmcnt(3)
    v_mfma_f32_32x32x16_bf16 v[24:39], v[48:51], v[40:43], v[24:39]
    ds_read_b128 v[40:43], v58 offset:32768
    ds_read_b64_tr_b16 v[48:49], v64 offset:45056
    ds_read_b64_tr_b16 v[50:51], v64 offset:45568
    s_waitcnt lgkmcnt(3)
    v_mfma_f32_32x32x16_bf16 v[24:39], v[52:55], v[44:47], v[24:39]
    ds_read_b128 v[44:47], v59 offset:32768
    ds_read_b64_tr_b16 v[52:53], v64 offset:47104
    ds_read_b64_tr_b16 v[54:55], v64 offset:47616
    s_waitcnt lgkmcnt(3)
    v_mfma_f32_32x32x16_bf16 v[24:39], v[48:51], v[40:43], v[24:39]
    s_waitcnt lgkmcnt(0)
    v_mfma_f32_32x32x16_bf16 v[24:39], v[52:55], v[44:47], v[24:39]
    s_waitcnt vmcnt(8)
    s_barrier
    ds_read_b128 v[40:43], v56 offset:49152
    ds_read_b64_tr_b16 v[48:49], v64 offset:57344
    ds_read_b64_tr_b16 v[50:51], v64 offset:57856
    ds_read_b128 v[44:47], v57 offset:49152
    ds_read_b64_tr_b16 v[52:53], v64 offset:59392
    ds_read_b64_tr_b16 v[54:55], v64 offset:59904
    s_waitcnt lgkmcnt(3)
    v_mfma_f32_32x32x16_bf16 v[24:39], v[48:51], v[40:43], v[24:39]
    ds_read_b128 v[40:43], v58 offset:49152
    ds_read_b64_tr_b16 v[48:49], v64 offset:61440
    ds_read_b64_tr_b16 v[50:51], v64 offset:61952
    s_waitcnt lgkmcnt(3)
    v_mfma_f32_32x32x16_bf16 v[24:39], v[52:55], v[44:47], v[24:39]
    ds_read_b128 v[44:47], v59 offset:49152
    ds_read_b64_tr_b16 v[52:53], v64 offset:63488
    ds_read_b64_tr_b16 v[54:55], v64 offset:64000
    s_waitcnt lgkmcnt(3)
    v_mfma_f32_32x32x16_bf16 v[24:39], v[48:51], v[40:43], v[24:39]
    s_waitcnt lgkmcnt(0)
    v_mfma_f32_32x32x16_bf16 v[24:39], v[52:55], v[44:47], v[24:39]
    s_waitcnt vmcnt(4)
    s_barrier
    ds_read_b128 v[40:43], v60 offset:0
    ds_read_b64_tr_b16 v[48:49], v65 offset:8192
    ds_read_b64_tr_b16 v[50:51], v65 offset:8704
    ds_read_b128 v[44:47], v61 offset:0
    ds_read_b64_tr_b16 v[52:53], v65 offset:10240
    ds_read_b64_tr_b16 v[54:55], v65 offset:10752
    s_waitcnt lgkmcnt(3)
    v_mfma_f32_32x32x16_bf16 v[24:39], v[48:51], v[40:43], v[24:39]
    ds_read_b128 v[40:43], v62 offset:0
    ds_read_b64_tr_b16 v[48:49], v65 offset:12288
    ds_read_b64_tr_b16 v[50:51], v65 offset:12800
    s_waitcnt lgkmcnt(3)
    v_mfma_f32_32x32x16_bf16 v[24:39], v[52:55], v[44:47], v[24:39]
    ds_read_b128 v[44:47], v63 offset:0
    ds_read_b64_tr_b16 v[52:53], v65 offset:14336
    ds_read_b64_tr_b16 v[54:55], v65 offset:14848
    s_waitcnt lgkmcnt(3)
    v_mfma_f32_32x32x16_bf16 v[24:39], v[48:51], v[40:43], v[24:39]
    s_waitcnt lgkmcnt(0)
    v_mfma_f32_32x32x16_bf16 v[24:39], v[52:55], v[44:47], v[24:39]
    s_waitcnt vmcnt(0)
    s_barrier
    ds_read_b128 v[40:43], v60 offset:16384
    ds_read_b64_tr_b16 v[48:49], v65 offset:24576
    ds_read_b64_tr_b16 v[50:51], v65 offset:25088
    ds_read_b128 v[44:47], v61 offset:16384
    ds_read_b64_tr_b16 v[52:53], v65 offset:26624
    ds_read_b64_tr_b16 v[54:55], v65 offset:27136
    s_waitcnt lgkmcnt(3)
    v_mfma_f32_32x32x16_bf16 v[24:39], v[48:51], v[40:43], v[24:39]
    ds_read_b128 v[40:43], v62 offset:16384
    ds_read_b64_tr_b16 v[48:49], v65 offset:28672
    ds_read_b64_tr_b16 v[50:51], v65 offset:29184
    s_waitcnt lgkmcnt(3)
    v_mfma_f32_32x32x16_bf16 v[24:39], v[52:55], v[44:47], v[24:39]
    ds_read_b128 v[44:47], v63 offset:16384
    ds_read_b64_tr_b16 v[52:53], v65 offset:30720
    ds_read_b64_tr_b16 v[54:55], v65 offset:31232
    s_waitcnt lgkmcnt(3)
    v_mfma_f32_32x32x16_bf16 v[24:39], v[48:51], v[40:43], v[24:39]
    s_waitcnt lgkmcnt(0)
    v_mfma_f32_32x32x16_bf16 v[24:39], v[52:55], v[44:47], v[24:39]
    v_and_b32 v12, 31, v1
    s_mul_i32 s23, s21, 32
    s_add_u32 s23, s23, s19
    v_add_u32 v12, s23, v12
    v_lshrrev_b32 v13, 5, v1
    v_lshlrev_b32 v13, 2, v13
    s_mul_i32 s23, s22, 32
    s_add_u32 s23, s23, s20
    v_add_u32 v13, s23, v13
    s_load_dwordx2 s[16:17], s[0:1], 112
    s_load_dwordx2 s[28:29], s[0:1], 112
    s_load_dwordx2 s[12:13], s[0:1], 96
    s_waitcnt lgkmcnt(0)
    s_and_b32 s13, s13, 0xffff
    s_mov_b32 s14, 0x200000
    s_mov_b32 s15, 0x00020000
    s_add_u32 s28, s28, 0x2400000
    s_addc_u32 s29, s29, 0
    s_and_b32 s29, s29, 0xffff
    s_mov_b32 s30, 0x200000
    s_mov_b32 s31, 0x00020000
    s_and_b32 s17, s17, 0xffff
    s_mov_b32 s18, 0x3000
    s_mov_b32 s19, 0x00020000
    v_mul_u32_u24 v14, 1024, v12
    v_lshlrev_b32 v15, 1, v13
    v_add_u32 v14, v14, v15
    v_lshlrev_b32 v15, 2, v13
    s_mov_b32 s24, 10240
    s_mov_b32 s23, 0
    buffer_load_dwordx4 v[70:73], v15, s[16:19], s24 offen offset:0
    buffer_load_dwordx2 v[74:75], v14, s[28:31], s23 offen offset:0
    s_waitcnt vmcnt(0)
    v_cvt_pk_bf16_f32 v66, v24, v24
    v_lshlrev_b32 v66, 16, v66
    v_mul_f32 v66, v66, v70
    v_cvt_pk_bf16_f32 v66, v66, v66
    v_lshlrev_b32 v66, 16, v66
    v_cvt_pk_bf16_f32 v67, v25, v25
    v_lshlrev_b32 v67, 16, v67
    v_mul_f32 v67, v67, v71
    v_cvt_pk_bf16_f32 v67, v67, v67
    v_lshlrev_b32 v67, 16, v67
    v_cvt_pk_bf16_f32 v68, v26, v26
    v_lshlrev_b32 v68, 16, v68
    v_mul_f32 v68, v68, v72
    v_cvt_pk_bf16_f32 v68, v68, v68
    v_lshlrev_b32 v68, 16, v68
    v_cvt_pk_bf16_f32 v69, v27, v27
    v_lshlrev_b32 v69, 16, v69
    v_mul_f32 v69, v69, v73
    v_cvt_pk_bf16_f32 v69, v69, v69
    v_lshlrev_b32 v69, 16, v69
    v_lshlrev_b32 v70, 16, v74
    v_and_b32 v71, 0xffff0000, v74
    v_lshlrev_b32 v72, 16, v75
    v_and_b32 v73, 0xffff0000, v75
    v_add_f32 v66, v66, v70
    v_add_f32 v67, v67, v71
    v_add_f32 v68, v68, v72
    v_add_f32 v69, v69, v73
    v_cvt_pk_bf16_f32 v66, v66, v67
    v_cvt_pk_bf16_f32 v67, v68, v69
    buffer_store_dwordx2 v[66:67], v14, s[12:15], s23 offen offset:0
    buffer_load_dwordx4 v[70:73], v15, s[16:19], s24 offen offset:32
    buffer_load_dwordx2 v[74:75], v14, s[28:31], s23 offen offset:16
    s_waitcnt vmcnt(0)
    v_cvt_pk_bf16_f32 v66, v28, v28
    v_lshlrev_b32 v66, 16, v66
    v_mul_f32 v66, v66, v70
    v_cvt_pk_bf16_f32 v66, v66, v66
    v_lshlrev_b32 v66, 16, v66
    v_cvt_pk_bf16_f32 v67, v29, v29
    v_lshlrev_b32 v67, 16, v67
    v_mul_f32 v67, v67, v71
    v_cvt_pk_bf16_f32 v67, v67, v67
    v_lshlrev_b32 v67, 16, v67
    v_cvt_pk_bf16_f32 v68, v30, v30
    v_lshlrev_b32 v68, 16, v68
    v_mul_f32 v68, v68, v72
    v_cvt_pk_bf16_f32 v68, v68, v68
    v_lshlrev_b32 v68, 16, v68
    v_cvt_pk_bf16_f32 v69, v31, v31
    v_lshlrev_b32 v69, 16, v69
    v_mul_f32 v69, v69, v73
    v_cvt_pk_bf16_f32 v69, v69, v69
    v_lshlrev_b32 v69, 16, v69
    v_lshlrev_b32 v70, 16, v74
    v_and_b32 v71, 0xffff0000, v74
    v_lshlrev_b32 v72, 16, v75
    v_and_b32 v73, 0xffff0000, v75
    v_add_f32 v66, v66, v70
    v_add_f32 v67, v67, v71
    v_add_f32 v68, v68, v72
    v_add_f32 v69, v69, v73
    v_cvt_pk_bf16_f32 v66, v66, v67
    v_cvt_pk_bf16_f32 v67, v68, v69
    buffer_store_dwordx2 v[66:67], v14, s[12:15], s23 offen offset:16
    buffer_load_dwordx4 v[70:73], v15, s[16:19], s24 offen offset:64
    buffer_load_dwordx2 v[74:75], v14, s[28:31], s23 offen offset:32
    s_waitcnt vmcnt(0)
    v_cvt_pk_bf16_f32 v66, v32, v32
    v_lshlrev_b32 v66, 16, v66
    v_mul_f32 v66, v66, v70
    v_cvt_pk_bf16_f32 v66, v66, v66
    v_lshlrev_b32 v66, 16, v66
    v_cvt_pk_bf16_f32 v67, v33, v33
    v_lshlrev_b32 v67, 16, v67
    v_mul_f32 v67, v67, v71
    v_cvt_pk_bf16_f32 v67, v67, v67
    v_lshlrev_b32 v67, 16, v67
    v_cvt_pk_bf16_f32 v68, v34, v34
    v_lshlrev_b32 v68, 16, v68
    v_mul_f32 v68, v68, v72
    v_cvt_pk_bf16_f32 v68, v68, v68
    v_lshlrev_b32 v68, 16, v68
    v_cvt_pk_bf16_f32 v69, v35, v35
    v_lshlrev_b32 v69, 16, v69
    v_mul_f32 v69, v69, v73
    v_cvt_pk_bf16_f32 v69, v69, v69
    v_lshlrev_b32 v69, 16, v69
    v_lshlrev_b32 v70, 16, v74
    v_and_b32 v71, 0xffff0000, v74
    v_lshlrev_b32 v72, 16, v75
    v_and_b32 v73, 0xffff0000, v75
    v_add_f32 v66, v66, v70
    v_add_f32 v67, v67, v71
    v_add_f32 v68, v68, v72
    v_add_f32 v69, v69, v73
    v_cvt_pk_bf16_f32 v66, v66, v67
    v_cvt_pk_bf16_f32 v67, v68, v69
    buffer_store_dwordx2 v[66:67], v14, s[12:15], s23 offen offset:32
    buffer_load_dwordx4 v[70:73], v15, s[16:19], s24 offen offset:96
    buffer_load_dwordx2 v[74:75], v14, s[28:31], s23 offen offset:48
    s_waitcnt vmcnt(0)
    v_cvt_pk_bf16_f32 v66, v36, v36
    v_lshlrev_b32 v66, 16, v66
    v_mul_f32 v66, v66, v70
    v_cvt_pk_bf16_f32 v66, v66, v66
    v_lshlrev_b32 v66, 16, v66
    v_cvt_pk_bf16_f32 v67, v37, v37
    v_lshlrev_b32 v67, 16, v67
    v_mul_f32 v67, v67, v71
    v_cvt_pk_bf16_f32 v67, v67, v67
    v_lshlrev_b32 v67, 16, v67
    v_cvt_pk_bf16_f32 v68, v38, v38
    v_lshlrev_b32 v68, 16, v68
    v_mul_f32 v68, v68, v72
    v_cvt_pk_bf16_f32 v68, v68, v68
    v_lshlrev_b32 v68, 16, v68
    v_cvt_pk_bf16_f32 v69, v39, v39
    v_lshlrev_b32 v69, 16, v69
    v_mul_f32 v69, v69, v73
    v_cvt_pk_bf16_f32 v69, v69, v69
    v_lshlrev_b32 v69, 16, v69
    v_lshlrev_b32 v70, 16, v74
    v_and_b32 v71, 0xffff0000, v74
    v_lshlrev_b32 v72, 16, v75
    v_and_b32 v73, 0xffff0000, v75
    v_add_f32 v66, v66, v70
    v_add_f32 v67, v67, v71
    v_add_f32 v68, v68, v72
    v_add_f32 v69, v69, v73
    v_cvt_pk_bf16_f32 v66, v66, v67
    v_cvt_pk_bf16_f32 v67, v68, v69
    buffer_store_dwordx2 v[66:67], v14, s[12:15], s23 offen offset:48
    s_nop 3
.Lend_gemmout_kernel:
    s_endpgm
.section .rodata,"a"
.p2align 6
.amdhsa_kernel mod_kernel
  .amdhsa_next_free_vgpr 168
  .amdhsa_next_free_sgpr 102
  .amdhsa_accum_offset 168
  .amdhsa_group_segment_fixed_size 0
  .amdhsa_kernarg_size 120
  .amdhsa_user_sgpr_count 2
  .amdhsa_user_sgpr_kernarg_segment_ptr 1
  .amdhsa_system_sgpr_workgroup_id_x 1
.end_amdhsa_kernel
.p2align 6
.amdhsa_kernel ln1_kernel
  .amdhsa_next_free_vgpr 64
  .amdhsa_next_free_sgpr 102
  .amdhsa_accum_offset 64
  .amdhsa_group_segment_fixed_size 0
  .amdhsa_kernarg_size 120
  .amdhsa_user_sgpr_count 2
  .amdhsa_user_sgpr_kernarg_segment_ptr 1
  .amdhsa_system_sgpr_workgroup_id_x 1
.end_amdhsa_kernel
.p2align 6
.amdhsa_kernel gemmq_kernel
  .amdhsa_next_free_vgpr 168
  .amdhsa_next_free_sgpr 102
  .amdhsa_accum_offset 168
  .amdhsa_group_segment_fixed_size 0
  .amdhsa_kernarg_size 120
  .amdhsa_user_sgpr_count 2
  .amdhsa_user_sgpr_kernarg_segment_ptr 1
  .amdhsa_system_sgpr_workgroup_id_x 1
.end_amdhsa_kernel
.p2align 6
.amdhsa_kernel attn_kernel
  .amdhsa_next_free_vgpr 256
  .amdhsa_next_free_sgpr 102
  .amdhsa_accum_offset 256
  .amdhsa_group_segment_fixed_size 0
  .amdhsa_kernarg_size 120
  .amdhsa_user_sgpr_count 2
  .amdhsa_user_sgpr_kernarg_segment_ptr 1
  .amdhsa_system_sgpr_workgroup_id_x 1
.end_amdhsa_kernel
.p2align 6
.amdhsa_kernel gemmo_kernel
  .amdhsa_next_free_vgpr 104
  .amdhsa_next_free_sgpr 102
  .amdhsa_accum_offset 104
  .amdhsa_group_segment_fixed_size 0
  .amdhsa_kernarg_size 120
  .amdhsa_user_sgpr_count 2
  .amdhsa_user_sgpr_kernarg_segment_ptr 1
  .amdhsa_system_sgpr_workgroup_id_x 1
.end_amdhsa_kernel
.p2align 6
.amdhsa_kernel ln2_kernel
  .amdhsa_next_free_vgpr 64
  .amdhsa_next_free_sgpr 102
  .amdhsa_accum_offset 64
  .amdhsa_group_segment_fixed_size 0
  .amdhsa_kernarg_size 120
  .amdhsa_user_sgpr_count 2
  .amdhsa_user_sgpr_kernarg_segment_ptr 1
  .amdhsa_system_sgpr_workgroup_id_x 1
.end_amdhsa_kernel
.p2align 6
.amdhsa_kernel gemmin_kernel
  .amdhsa_next_free_vgpr 160
  .amdhsa_next_free_sgpr 102
  .amdhsa_accum_offset 160
  .amdhsa_group_segment_fixed_size 0
  .amdhsa_kernarg_size 120
  .amdhsa_user_sgpr_count 2
  .amdhsa_user_sgpr_kernarg_segment_ptr 1
  .amdhsa_system_sgpr_workgroup_id_x 1
.end_amdhsa_kernel
.p2align 6
.amdhsa_kernel ln3_kernel
  .amdhsa_next_free_vgpr 64
  .amdhsa_next_free_sgpr 102
  .amdhsa_accum_offset 64
  .amdhsa_group_segment_fixed_size 0
  .amdhsa_kernarg_size 120
  .amdhsa_user_sgpr_count 2
  .amdhsa_user_sgpr_kernarg_segment_ptr 1
  .amdhsa_system_sgpr_workgroup_id_x 1
.end_amdhsa_kernel
.p2align 6
.amdhsa_kernel gemmsp_kernel
  .amdhsa_next_free_vgpr 128
  .amdhsa_next_free_sgpr 102
  .amdhsa_accum_offset 128
  .amdhsa_group_segment_fixed_size 0
  .amdhsa_kernarg_size 120
  .amdhsa_user_sgpr_count 2
  .amdhsa_user_sgpr_kernarg_segment_ptr 1
  .amdhsa_system_sgpr_workgroup_id_x 1
.end_amdhsa_kernel
.p2align 6
.amdhsa_kernel gemmout_kernel
  .amdhsa_next_free_vgpr 104
  .amdhsa_next_free_sgpr 102
  .amdhsa_accum_offset 104
  .amdhsa_group_segment_fixed_size 0
  .amdhsa_kernarg_size 120
  .amdhsa_user_sgpr_count 2
  .amdhsa_user_sgpr_kernarg_segment_ptr 1
  .amdhsa_system_sgpr_workgroup_id_x 1
.end_amdhsa_kernel
```
